```python
import torch

def _softmax(x, axis=-1):
    return torch.softmax(x, dim=axis)
def _gelu(x):
    return torch.nn.functional.gelu(x, approximate="tanh")
def _silu(x):
    return torch.nn.functional.silu(x)
def _sigmoid(x):
    return torch.sigmoid(x)
def _layernorm(x, axis=-1, eps=1e-5):
    m = x.mean(dim=axis, keepdim=True)
    v = x.var(dim=axis, keepdim=True, unbiased=False)
    return (x - m) / torch.sqrt(v + eps)
def _scatter_add(tgt, idx, src, axis=0):
    return tgt.clone().index_add_(axis, idx, src)
def _segment_sum(src, seg, n):
    out = torch.zeros((n,) + src.shape[1:], dtype=src.dtype)
    return out.index_add_(0, seg, src)
def _pad(x, pw):
    flat = tuple(v for pair in reversed(pw) for v in pair)
    return torch.nn.functional.pad(x, flat)

kernel_name = 'interleave_layers__grouped_kv_mqa__glu_gated_geglu__prompt'

def setup_inputs():

    _w = (lambda a: (lambda t: t.to(torch.bfloat16) if t.is_floating_point() else t)(torch.as_tensor(a)))
    def _A_setup():
        B, S, D, H = 1, 2048, 640, 32
        Dh = D // H
        return {
            "x": _w((lambda *s: torch.randn(*s, dtype=torch.bfloat16) * 0.05)(B, S, D)),
            "wq": _w((lambda *s: torch.randn(*s, dtype=torch.bfloat16) * 0.05)(D, H * Dh)),
            "wk": _w((lambda *s: torch.randn(*s, dtype=torch.bfloat16) * 0.05)(D, Dh)),
            "wv": _w((lambda *s: torch.randn(*s, dtype=torch.bfloat16) * 0.05)(D, Dh)),
            "wo": _w((lambda *s: torch.randn(*s, dtype=torch.bfloat16) * 0.05)(H * Dh, D)),
        }
    _A_in = _A_setup()

    def _B_setup():
        B, S, Dm, Df = 1, 2048, 640, 1536
        return {
            "x": _w((lambda *s: torch.randn(*s, dtype=torch.bfloat16) * 0.05)(B, S, Dm)),
            "w_gate": _w((lambda *s: torch.randn(*s, dtype=torch.bfloat16) * 0.8)(Dm, Df) * (Dm ** -0.5)),
            "w_up": _w((lambda *s: torch.randn(*s, dtype=torch.bfloat16) * 0.8)(Dm, Df) * (Dm ** -0.5)),
            "w_down": _w((lambda *s: torch.randn(*s, dtype=torch.bfloat16) * 0.8)(Df, Dm) * (Df ** -0.5)),
        }
    _B_in = _B_setup()

    return {
        "A_x": _A_in["x"],
        "A_wq": _A_in["wq"],
        "A_wk": _A_in["wk"],
        "A_wv": _A_in["wv"],
        "A_wo": _A_in["wo"],
        "B_x": _B_in["x"],
        "B_w_gate": _B_in["w_gate"],
        "B_w_up": _B_in["w_up"],
        "B_w_down": _B_in["w_down"],
    }

def reference(A_x, A_wq, A_wk, A_wv, A_wo, B_x, B_w_gate, B_w_up, B_w_down):
    def _A_ref(x, wq, wk, wv, wo):
        B, S, D = x.shape
        H = 32
        Dh = D // H
        q = (lambda x, *d: x.permute(*d))((x @ wq).reshape(B, S, H, Dh), 0, 2, 1, 3)
        k = x @ wk
        v = x @ wv
        scores = torch.einsum("bhqd,bkd->bhqk", q, k) * (Dh ** -0.5)
        p = _softmax(scores, axis=-1)
        o = torch.einsum("bhqk,bkd->bhqd", p, v)
        return (lambda x, *d: x.permute(*d))(o, 0, 2, 1, 3).reshape(B, S, H * Dh) @ wo

    def _B_ref(x, w_gate, w_up, w_down):
        g = torch.einsum("bsd,df->bsf", x, w_gate)
        u = torch.einsum("bsd,df->bsf", x, w_up)
        h = _gelu(g) * u
        return torch.einsum("bsf,fd->bsd", h, w_down)

    x = A_x
    x = x + _A_ref(_layernorm(x, axis=-1), A_wq, A_wk, A_wv, A_wo)
    x = x + _B_ref(_layernorm(x, axis=-1), B_w_gate, B_w_up, B_w_down)
    x = x + _A_ref(_layernorm(x, axis=-1), A_wq, A_wk, A_wv, A_wo)
    x = x + _B_ref(_layernorm(x, axis=-1), B_w_gate, B_w_up, B_w_down)
    return x
```

```asm
; @launch kernel=prep_kernel grid=(240,1,1) block=(320,1,1) lds=46080
; @launch kernel=main_kernel grid=(256,1,1) block=(512,1,1) lds=163840
.amdgcn_target "amdgcn-amd-amdhsa--gfx950"

.text
.globl prep_kernel
.p2align 8
.type prep_kernel,@function
prep_kernel:
    s_cmp_ge_u32 s2, 240
    s_cbranch_scc0 prep_kernel_go
    s_endpgm
prep_kernel_go:
    s_load_dwordx2 s[12:13], s[0:1], 88
    s_mov_b32 s14, 268435456
    s_mov_b32 s15, 0x00020000
    v_lshrrev_b32 v5, 6, v0
    v_and_b32 v0, 63, v0
    v_readfirstlane_b32 s3, v5
    v_lshlrev_b32 v2, 4, v0
    v_and_b32 v6, 15, v0
    v_lshrrev_b32 v7, 4, v0
    s_mov_b32 s11, 0x00020000
    s_cmp_ge_u32 s2, 188
    s_cbranch_scc1 prep_kernel_xc
    s_cmp_ge_u32 s2, 184
    s_cbranch_scc1 prep_kernel_kv
    v_and_b32 v8, 3, v0
    v_and_b32 v9, 60, v0
    v_lshlrev_b32 v9, 1, v9
    s_mov_b32 s32, s3
    s_movk_i32 s24, 1280
    s_movk_i32 s33, 1280
    s_mov_b32 s25, 52
    s_mov_b32 s26, 5
    s_movk_i32 s28, 5120
    s_mov_b32 s30, 0
    s_cmp_ge_u32 s2, 136
    s_cbranch_scc1 prep_kernel_wd
    s_bfe_u32 s34, s2, 0x20001
    s_lshr_b32 s35, s2, 3
    s_cmp_lt_u32 s2, 96
    s_cbranch_scc1 prep_kernel_wgu
    s_mul_i32 s31, s34, 5
    s_add_u32 s31, s31, s35
    s_sub_u32 s31, s31, 12
    s_bitcmp1_b32 s2, 0
    s_cbranch_scc1 prep_kernel_wo
    s_mov_b32 s30, 1
    s_branch prep_kernel_wq
    prep_kernel_wgu:
    s_mov_b32 s30, 1
    s_mov_b32 s10, 1966080
    s_movk_i32 s24, 3072
    s_movk_i32 s33, 3072
    s_mov_b32 s25, 43
    s_mov_b32 s26, 6
    s_mov_b32 s27, 245760
    s_movk_i32 s28, 12288
    s_mul_i32 s31, s34, 12
    s_add_u32 s31, s31, s35
    v_lshrrev_b32 v10, 1, v7
    v_mul_u32_u24 v2, 6144, v10
    v_and_b32 v10, 1, v7
    v_lshl_add_u32 v2, v10, 9, v2
    v_lshl_add_u32 v2, v6, 4, v2
    s_bitcmp1_b32 s2, 0
    s_cbranch_scc1 prep_kernel_wu
    s_load_dwordx2 s[8:9], s[0:1], 48
    s_mov_b32 s29, 2097152
    s_branch prep_kernel_go2
prep_kernel_wu:
    s_load_dwordx2 s[8:9], s[0:1], 56
    s_mov_b32 s29, 2097408
    s_branch prep_kernel_go2
prep_kernel_wq:
    s_load_dwordx2 s[8:9], s[0:1], 8
    s_mov_b32 s10, 819200
    s_mov_b32 s25, 0
    s_mov_b32 s27, 0
    s_mov_b32 s28, 45056
    s_cmp_lt_u32 s31, 2
    s_cselect_b32 s29, 2, 4
    s_lshl_b32 s29, s29, 10
    s_add_u32 s29, s29, 0
    s_branch prep_kernel_go2
prep_kernel_wo:
    s_load_dwordx2 s[8:9], s[0:1], 32
    s_mov_b32 s10, 819200
    s_mov_b32 s27, 102400
    s_mov_b32 s29, 1048576
    s_branch prep_kernel_go2
prep_kernel_wd:
    s_load_dwordx2 s[8:9], s[0:1], 64
    s_mov_b32 s10, 1966080
    s_mov_b32 s27, 245760
    s_mov_b32 s29, 6291456
    s_sub_u32 s32, s2, 136
    s_and_b32 s31, s32, 3
    s_mul_i32 s31, s31, 5
    s_add_u32 s31, s31, s3
    s_lshr_b32 s32, s32, 2
    s_movk_i32 s33, 6400
    v_and_b32 v10, 4, v0
    v_and_b32 v9, 56, v0
    v_lshl_add_u32 v9, v9, 1, v10
prep_kernel_go2:
    v_mul_lo_u32 v1, s24, v9
    v_lshl_add_u32 v1, v8, 4, v1
    s_mul_i32 s20, s32, s24
    s_lshl_b32 s20, s20, 7
    s_lshl_b32 s21, s31, 6
    s_add_u32 s20, s20, s21
    s_waitcnt lgkmcnt(0)
    buffer_load_dwordx4 v[16:19], v1, s[8:11], s20 offen
    s_add_u32 s20, s20, s24
    buffer_load_dwordx4 v[20:23], v1, s[8:11], s20 offen
    s_add_u32 s20, s20, s24
    buffer_load_dwordx4 v[24:27], v1, s[8:11], s20 offen
    s_add_u32 s20, s20, s24
    buffer_load_dwordx4 v[28:31], v1, s[8:11], s20 offen
    s_add_u32 s20, s20, s33
    buffer_load_dwordx4 v[32:35], v1, s[8:11], s20 offen
    s_add_u32 s20, s20, s24
    buffer_load_dwordx4 v[36:39], v1, s[8:11], s20 offen
    s_add_u32 s20, s20, s24
    buffer_load_dwordx4 v[40:43], v1, s[8:11], s20 offen
    s_add_u32 s20, s20, s24
    buffer_load_dwordx4 v[44:47], v1, s[8:11], s20 offen
    s_add_u32 s20, s20, s24
    s_mul_i32 s4, s3, 8704
    v_lshrrev_b32 v10, 1, v8
    v_lshlrev_b32 v10, 4, v10
    v_lshrrev_b32 v11, 2, v0
    v_add_u32 v10, v10, v11
    v_mul_u32_u24 v3, 272, v10
    v_and_b32 v10, 1, v0
    v_lshl_add_u32 v3, v10, 7, v3
    v_add_u32 v3, s4, v3
    v_mul_u32_u24 v4, 272, v7
    v_lshl_add_u32 v4, v6, 4, v4
    v_add_u32 v4, s4, v4
    s_lshl_b32 s4, s32, 2
    s_mul_i32 s4, s4, s28
    s_add_u32 s29, s29, s4
    s_lshl_b32 s31, s31, 1
    s_add_u32 s4, s31, 0
    s_mul_i32 s5, s4, s25
    s_lshr_b32 s5, s5, 8
    s_mul_i32 s6, s5, s26
    s_sub_u32 s4, s4, s6
    s_lshl_b32 s4, s4, 10
    s_mul_i32 s5, s5, s27
    s_add_u32 s36, s29, s4
    s_add_u32 s36, s36, s5
    s_add_u32 s37, s36, s28
    s_add_u32 s38, s37, s28
    s_add_u32 s39, s38, s28
    s_add_u32 s4, s31, 1
    s_mul_i32 s5, s4, s25
    s_lshr_b32 s5, s5, 8
    s_mul_i32 s6, s5, s26
    s_sub_u32 s4, s4, s6
    s_lshl_b32 s4, s4, 10
    s_mul_i32 s5, s5, s27
    s_add_u32 s40, s29, s4
    s_add_u32 s40, s40, s5
    s_add_u32 s41, s40, s28
    s_add_u32 s42, s41, s28
    s_add_u32 s43, s42, s28
    s_mov_b32 s4, 0x05040100
    s_mov_b32 s5, 0x07060302
    s_cmp_eq_u32 s30, 1
    s_cbranch_scc1 prep_kernel_cen
    s_waitcnt vmcnt(0)
    v_perm_b32 v48, v20, v16, s4
    v_perm_b32 v49, v28, v24, s4
    v_perm_b32 v50, v36, v32, s4
    v_perm_b32 v51, v44, v40, s4
    ds_write_b128 v3, v[48:51] offset:0
    v_perm_b32 v52, v20, v16, s5
    v_perm_b32 v53, v28, v24, s5
    v_perm_b32 v54, v36, v32, s5
    v_perm_b32 v55, v44, v40, s5
    ds_write_b128 v3, v[52:55] offset:16
    v_perm_b32 v56, v21, v17, s4
    v_perm_b32 v57, v29, v25, s4
    v_perm_b32 v58, v37, v33, s4
    v_perm_b32 v59, v45, v41, s4
    ds_write_b128 v3, v[56:59] offset:32
    v_perm_b32 v60, v21, v17, s5
    v_perm_b32 v61, v29, v25, s5
    v_perm_b32 v62, v37, v33, s5
    v_perm_b32 v63, v45, v41, s5
    ds_write_b128 v3, v[60:63] offset:48
    v_perm_b32 v64, v22, v18, s4
    v_perm_b32 v65, v30, v26, s4
    v_perm_b32 v66, v38, v34, s4
    v_perm_b32 v67, v46, v42, s4
    ds_write_b128 v3, v[64:67] offset:64
    v_perm_b32 v68, v22, v18, s5
    v_perm_b32 v69, v30, v26, s5
    v_perm_b32 v70, v38, v34, s5
    v_perm_b32 v71, v46, v42, s5
    ds_write_b128 v3, v[68:71] offset:80
    v_perm_b32 v72, v23, v19, s4
    v_perm_b32 v73, v31, v27, s4
    v_perm_b32 v74, v39, v35, s4
    v_perm_b32 v75, v47, v43, s4
    ds_write_b128 v3, v[72:75] offset:96
    v_perm_b32 v76, v23, v19, s5
    v_perm_b32 v77, v31, v27, s5
    v_perm_b32 v78, v39, v35, s5
    v_perm_b32 v79, v47, v43, s5
    ds_write_b128 v3, v[76:79] offset:112
    s_branch prep_kernel_out
prep_kernel_cen:
    s_waitcnt vmcnt(7)
    v_lshlrev_b32 v48, 16, v16
    v_and_b32 v49, 0xffff0000, v16
    v_lshlrev_b32 v50, 16, v17
    v_and_b32 v51, 0xffff0000, v17
    v_lshlrev_b32 v52, 16, v18
    v_and_b32 v53, 0xffff0000, v18
    v_lshlrev_b32 v54, 16, v19
    v_and_b32 v55, 0xffff0000, v19
    s_waitcnt vmcnt(6)
    v_lshlrev_b32 v56, 16, v20
    v_and_b32 v57, 0xffff0000, v20
    v_lshlrev_b32 v58, 16, v21
    v_and_b32 v59, 0xffff0000, v21
    v_lshlrev_b32 v60, 16, v22
    v_and_b32 v61, 0xffff0000, v22
    v_lshlrev_b32 v62, 16, v23
    v_and_b32 v63, 0xffff0000, v23
    v_pk_add_f32 v[8:9], v[48:49], v[56:57]
    v_pk_add_f32 v[10:11], v[50:51], v[58:59]
    v_pk_add_f32 v[12:13], v[52:53], v[60:61]
    v_pk_add_f32 v[14:15], v[54:55], v[62:63]
    s_waitcnt vmcnt(5)
    v_lshlrev_b32 v64, 16, v24
    v_and_b32 v65, 0xffff0000, v24
    v_lshlrev_b32 v66, 16, v25
    v_and_b32 v67, 0xffff0000, v25
    v_lshlrev_b32 v68, 16, v26
    v_and_b32 v69, 0xffff0000, v26
    v_lshlrev_b32 v70, 16, v27
    v_and_b32 v71, 0xffff0000, v27
    v_pk_add_f32 v[8:9], v[8:9], v[64:65]
    v_pk_add_f32 v[10:11], v[10:11], v[66:67]
    v_pk_add_f32 v[12:13], v[12:13], v[68:69]
    v_pk_add_f32 v[14:15], v[14:15], v[70:71]
    s_waitcnt vmcnt(4)
    v_lshlrev_b32 v72, 16, v28
    v_and_b32 v73, 0xffff0000, v28
    v_lshlrev_b32 v74, 16, v29
    v_and_b32 v75, 0xffff0000, v29
    v_lshlrev_b32 v76, 16, v30
    v_and_b32 v77, 0xffff0000, v30
    v_lshlrev_b32 v78, 16, v31
    v_and_b32 v79, 0xffff0000, v31
    v_pk_add_f32 v[8:9], v[8:9], v[72:73]
    v_pk_add_f32 v[10:11], v[10:11], v[74:75]
    v_pk_add_f32 v[12:13], v[12:13], v[76:77]
    v_pk_add_f32 v[14:15], v[14:15], v[78:79]
    s_waitcnt vmcnt(3)
    v_lshlrev_b32 v80, 16, v32
    v_and_b32 v81, 0xffff0000, v32
    v_lshlrev_b32 v82, 16, v33
    v_and_b32 v83, 0xffff0000, v33
    v_lshlrev_b32 v84, 16, v34
    v_and_b32 v85, 0xffff0000, v34
    v_lshlrev_b32 v86, 16, v35
    v_and_b32 v87, 0xffff0000, v35
    v_pk_add_f32 v[8:9], v[8:9], v[80:81]
    v_pk_add_f32 v[10:11], v[10:11], v[82:83]
    v_pk_add_f32 v[12:13], v[12:13], v[84:85]
    v_pk_add_f32 v[14:15], v[14:15], v[86:87]
    s_waitcnt vmcnt(2)
    v_lshlrev_b32 v88, 16, v36
    v_and_b32 v89, 0xffff0000, v36
    v_lshlrev_b32 v90, 16, v37
    v_and_b32 v91, 0xffff0000, v37
    v_lshlrev_b32 v92, 16, v38
    v_and_b32 v93, 0xffff0000, v38
    v_lshlrev_b32 v94, 16, v39
    v_and_b32 v95, 0xffff0000, v39
    v_pk_add_f32 v[8:9], v[8:9], v[88:89]
    v_pk_add_f32 v[10:11], v[10:11], v[90:91]
    v_pk_add_f32 v[12:13], v[12:13], v[92:93]
    v_pk_add_f32 v[14:15], v[14:15], v[94:95]
    s_waitcnt vmcnt(1)
    v_lshlrev_b32 v96, 16, v40
    v_and_b32 v97, 0xffff0000, v40
    v_lshlrev_b32 v98, 16, v41
    v_and_b32 v99, 0xffff0000, v41
    v_lshlrev_b32 v100, 16, v42
    v_and_b32 v101, 0xffff0000, v42
    v_lshlrev_b32 v102, 16, v43
    v_and_b32 v103, 0xffff0000, v43
    v_pk_add_f32 v[8:9], v[8:9], v[96:97]
    v_pk_add_f32 v[10:11], v[10:11], v[98:99]
    v_pk_add_f32 v[12:13], v[12:13], v[100:101]
    v_pk_add_f32 v[14:15], v[14:15], v[102:103]
    s_waitcnt vmcnt(0)
    v_lshlrev_b32 v104, 16, v44
    v_and_b32 v105, 0xffff0000, v44
    v_lshlrev_b32 v106, 16, v45
    v_and_b32 v107, 0xffff0000, v45
    v_lshlrev_b32 v108, 16, v46
    v_and_b32 v109, 0xffff0000, v46
    v_lshlrev_b32 v110, 16, v47
    v_and_b32 v111, 0xffff0000, v47
    v_pk_add_f32 v[8:9], v[8:9], v[104:105]
    v_pk_add_f32 v[10:11], v[10:11], v[106:107]
    v_pk_add_f32 v[12:13], v[12:13], v[108:109]
    v_pk_add_f32 v[14:15], v[14:15], v[110:111]
    s_nop 1
    v_add_f32_dpp v8, v8, v8 row_ror:8 row_mask:0xf bank_mask:0xf
    v_add_f32_dpp v9, v9, v9 row_ror:8 row_mask:0xf bank_mask:0xf
    v_add_f32_dpp v10, v10, v10 row_ror:8 row_mask:0xf bank_mask:0xf
    v_add_f32_dpp v11, v11, v11 row_ror:8 row_mask:0xf bank_mask:0xf
    v_add_f32_dpp v12, v12, v12 row_ror:8 row_mask:0xf bank_mask:0xf
    v_add_f32_dpp v13, v13, v13 row_ror:8 row_mask:0xf bank_mask:0xf
    v_add_f32_dpp v14, v14, v14 row_ror:8 row_mask:0xf bank_mask:0xf
    v_add_f32_dpp v15, v15, v15 row_ror:8 row_mask:0xf bank_mask:0xf
    v_add_f32_dpp v8, v8, v8 row_ror:4 row_mask:0xf bank_mask:0xf
    v_add_f32_dpp v9, v9, v9 row_ror:4 row_mask:0xf bank_mask:0xf
    v_add_f32_dpp v10, v10, v10 row_ror:4 row_mask:0xf bank_mask:0xf
    v_add_f32_dpp v11, v11, v11 row_ror:4 row_mask:0xf bank_mask:0xf
    v_add_f32_dpp v12, v12, v12 row_ror:4 row_mask:0xf bank_mask:0xf
    v_add_f32_dpp v13, v13, v13 row_ror:4 row_mask:0xf bank_mask:0xf
    v_add_f32_dpp v14, v14, v14 row_ror:4 row_mask:0xf bank_mask:0xf
    v_add_f32_dpp v15, v15, v15 row_ror:4 row_mask:0xf bank_mask:0xf
    v_mov_b32 v16, v8
    v_mov_b32 v17, v9
    v_mov_b32 v18, v10
    v_mov_b32 v19, v11
    v_mov_b32 v20, v12
    v_mov_b32 v21, v13
    v_mov_b32 v22, v14
    v_mov_b32 v23, v15
    v_permlane16_swap_b32 v8, v16
    v_permlane16_swap_b32 v9, v17
    v_permlane16_swap_b32 v10, v18
    v_permlane16_swap_b32 v11, v19
    v_permlane16_swap_b32 v12, v20
    v_permlane16_swap_b32 v13, v21
    v_permlane16_swap_b32 v14, v22
    v_permlane16_swap_b32 v15, v23
    v_add_f32 v8, v8, v16
    v_add_f32 v9, v9, v17
    v_add_f32 v10, v10, v18
    v_add_f32 v11, v11, v19
    v_add_f32 v12, v12, v20
    v_add_f32 v13, v13, v21
    v_add_f32 v14, v14, v22
    v_add_f32 v15, v15, v23
    v_mov_b32 v16, v8
    v_mov_b32 v17, v9
    v_mov_b32 v18, v10
    v_mov_b32 v19, v11
    v_mov_b32 v20, v12
    v_mov_b32 v21, v13
    v_mov_b32 v22, v14
    v_mov_b32 v23, v15
    v_permlane32_swap_b32 v8, v16
    v_permlane32_swap_b32 v9, v17
    v_permlane32_swap_b32 v10, v18
    v_permlane32_swap_b32 v11, v19
    v_permlane32_swap_b32 v12, v20
    v_permlane32_swap_b32 v13, v21
    v_permlane32_swap_b32 v14, v22
    v_permlane32_swap_b32 v15, v23
    v_add_f32 v8, v8, v16
    v_add_f32 v9, v9, v17
    v_add_f32 v10, v10, v18
    v_add_f32 v11, v11, v19
    v_add_f32 v12, v12, v20
    v_add_f32 v13, v13, v21
    v_add_f32 v14, v14, v22
    v_add_f32 v15, v15, v23
    v_and_b32 v1, 3, v0
    v_lshlrev_b32 v1, 5, v1
    v_add_u32 v1, 43520, v1
    s_lshl_b32 s4, s3, 8
    v_add_u32 v5, s4, v1
    s_mov_b64 exec, 0xf
    ds_write_b128 v5, v[8:11]
    ds_write_b128 v5, v[12:15] offset:16
    s_mov_b64 exec, -1
    s_waitcnt lgkmcnt(0)
    s_barrier
    ds_read_b128 v[16:19], v1 offset:0
    ds_read_b128 v[20:23], v1 offset:16
    ds_read_b128 v[24:27], v1 offset:256
    ds_read_b128 v[28:31], v1 offset:272
    ds_read_b128 v[32:35], v1 offset:512
    ds_read_b128 v[36:39], v1 offset:528
    ds_read_b128 v[40:43], v1 offset:768
    ds_read_b128 v[44:47], v1 offset:784
    s_waitcnt lgkmcnt(0)
    v_pk_mov_b32 v[8:9], v[16:17], v[16:17] op_sel:[0,1]
    v_pk_mov_b32 v[10:11], v[18:19], v[18:19] op_sel:[0,1]
    v_pk_mov_b32 v[12:13], v[20:21], v[20:21] op_sel:[0,1]
    v_pk_mov_b32 v[14:15], v[22:23], v[22:23] op_sel:[0,1]
    v_pk_add_f32 v[8:9], v[8:9], v[24:25]
    v_pk_add_f32 v[10:11], v[10:11], v[26:27]
    v_pk_add_f32 v[12:13], v[12:13], v[28:29]
    v_pk_add_f32 v[14:15], v[14:15], v[30:31]
    v_pk_add_f32 v[8:9], v[8:9], v[32:33]
    v_pk_add_f32 v[10:11], v[10:11], v[34:35]
    v_pk_add_f32 v[12:13], v[12:13], v[36:37]
    v_pk_add_f32 v[14:15], v[14:15], v[38:39]
    v_pk_add_f32 v[8:9], v[8:9], v[40:41]
    v_pk_add_f32 v[10:11], v[10:11], v[42:43]
    v_pk_add_f32 v[12:13], v[12:13], v[44:45]
    v_pk_add_f32 v[14:15], v[14:15], v[46:47]
    ds_read_b128 v[16:19], v1 offset:1024
    ds_read_b128 v[20:23], v1 offset:1040
    s_waitcnt lgkmcnt(0)
    v_pk_add_f32 v[8:9], v[8:9], v[16:17]
    v_pk_add_f32 v[10:11], v[10:11], v[18:19]
    v_pk_add_f32 v[12:13], v[12:13], v[20:21]
    v_pk_add_f32 v[14:15], v[14:15], v[22:23]
    v_mul_f32 v8, 0xbacccccd, v8
    v_mul_f32 v9, 0xbacccccd, v9
    v_mul_f32 v10, 0xbacccccd, v10
    v_mul_f32 v11, 0xbacccccd, v11
    v_mul_f32 v12, 0xbacccccd, v12
    v_mul_f32 v13, 0xbacccccd, v13
    v_mul_f32 v14, 0xbacccccd, v14
    v_mul_f32 v15, 0xbacccccd, v15
    v_pk_add_f32 v[48:49], v[48:49], v[8:9]
    v_pk_add_f32 v[50:51], v[50:51], v[10:11]
    v_pk_add_f32 v[52:53], v[52:53], v[12:13]
    v_pk_add_f32 v[54:55], v[54:55], v[14:15]
    v_pk_add_f32 v[56:57], v[56:57], v[8:9]
    v_pk_add_f32 v[58:59], v[58:59], v[10:11]
    v_pk_add_f32 v[60:61], v[60:61], v[12:13]
    v_pk_add_f32 v[62:63], v[62:63], v[14:15]
    v_pk_add_f32 v[64:65], v[64:65], v[8:9]
    v_pk_add_f32 v[66:67], v[66:67], v[10:11]
    v_pk_add_f32 v[68:69], v[68:69], v[12:13]
    v_pk_add_f32 v[70:71], v[70:71], v[14:15]
    v_pk_add_f32 v[72:73], v[72:73], v[8:9]
    v_pk_add_f32 v[74:75], v[74:75], v[10:11]
    v_pk_add_f32 v[76:77], v[76:77], v[12:13]
    v_pk_add_f32 v[78:79], v[78:79], v[14:15]
    v_pk_add_f32 v[80:81], v[80:81], v[8:9]
    v_pk_add_f32 v[82:83], v[82:83], v[10:11]
    v_pk_add_f32 v[84:85], v[84:85], v[12:13]
    v_pk_add_f32 v[86:87], v[86:87], v[14:15]
    v_pk_add_f32 v[88:89], v[88:89], v[8:9]
    v_pk_add_f32 v[90:91], v[90:91], v[10:11]
    v_pk_add_f32 v[92:93], v[92:93], v[12:13]
    v_pk_add_f32 v[94:95], v[94:95], v[14:15]
    v_pk_add_f32 v[96:97], v[96:97], v[8:9]
    v_pk_add_f32 v[98:99], v[98:99], v[10:11]
    v_pk_add_f32 v[100:101], v[100:101], v[12:13]
    v_pk_add_f32 v[102:103], v[102:103], v[14:15]
    v_pk_add_f32 v[104:105], v[104:105], v[8:9]
    v_pk_add_f32 v[106:107], v[106:107], v[10:11]
    v_pk_add_f32 v[108:109], v[108:109], v[12:13]
    v_pk_add_f32 v[110:111], v[110:111], v[14:15]
    v_cvt_pk_bf16_f32 v16, v48, v56
    v_cvt_pk_bf16_f32 v17, v64, v72
    v_cvt_pk_bf16_f32 v18, v80, v88
    v_cvt_pk_bf16_f32 v19, v96, v104
    ds_write_b128 v3, v[16:19] offset:0
    v_cvt_pk_bf16_f32 v20, v49, v57
    v_cvt_pk_bf16_f32 v21, v65, v73
    v_cvt_pk_bf16_f32 v22, v81, v89
    v_cvt_pk_bf16_f32 v23, v97, v105
    ds_write_b128 v3, v[20:23] offset:16
    v_cvt_pk_bf16_f32 v24, v50, v58
    v_cvt_pk_bf16_f32 v25, v66, v74
    v_cvt_pk_bf16_f32 v26, v82, v90
    v_cvt_pk_bf16_f32 v27, v98, v106
    ds_write_b128 v3, v[24:27] offset:32
    v_cvt_pk_bf16_f32 v28, v51, v59
    v_cvt_pk_bf16_f32 v29, v67, v75
    v_cvt_pk_bf16_f32 v30, v83, v91
    v_cvt_pk_bf16_f32 v31, v99, v107
    ds_write_b128 v3, v[28:31] offset:48
    v_cvt_pk_bf16_f32 v32, v52, v60
    v_cvt_pk_bf16_f32 v33, v68, v76
    v_cvt_pk_bf16_f32 v34, v84, v92
    v_cvt_pk_bf16_f32 v35, v100, v108
    ds_write_b128 v3, v[32:35] offset:64
    v_cvt_pk_bf16_f32 v36, v53, v61
    v_cvt_pk_bf16_f32 v37, v69, v77
    v_cvt_pk_bf16_f32 v38, v85, v93
    v_cvt_pk_bf16_f32 v39, v101, v109
    ds_write_b128 v3, v[36:39] offset:80
    v_cvt_pk_bf16_f32 v40, v54, v62
    v_cvt_pk_bf16_f32 v41, v70, v78
    v_cvt_pk_bf16_f32 v42, v86, v94
    v_cvt_pk_bf16_f32 v43, v102, v110
    ds_write_b128 v3, v[40:43] offset:96
    v_cvt_pk_bf16_f32 v44, v55, v63
    v_cvt_pk_bf16_f32 v45, v71, v79
    v_cvt_pk_bf16_f32 v46, v87, v95
    v_cvt_pk_bf16_f32 v47, v103, v111
    ds_write_b128 v3, v[44:47] offset:112
prep_kernel_out:
    s_waitcnt lgkmcnt(0)
    ds_read_b128 v[48:51], v4 offset:0
    ds_read_b128 v[52:55], v4 offset:1088
    ds_read_b128 v[56:59], v4 offset:2176
    ds_read_b128 v[60:63], v4 offset:3264
    ds_read_b128 v[64:67], v4 offset:4352
    ds_read_b128 v[68:71], v4 offset:5440
    ds_read_b128 v[72:75], v4 offset:6528
    ds_read_b128 v[76:79], v4 offset:7616
    s_waitcnt lgkmcnt(7)
    buffer_store_dwordx4 v[48:51], v2, s[12:15], s36 offen
    s_waitcnt lgkmcnt(6)
    buffer_store_dwordx4 v[52:55], v2, s[12:15], s37 offen
    s_waitcnt lgkmcnt(5)
    buffer_store_dwordx4 v[56:59], v2, s[12:15], s38 offen
    s_waitcnt lgkmcnt(4)
    buffer_store_dwordx4 v[60:63], v2, s[12:15], s39 offen
    s_waitcnt lgkmcnt(3)
    buffer_store_dwordx4 v[64:67], v2, s[12:15], s40 offen
    s_waitcnt lgkmcnt(2)
    buffer_store_dwordx4 v[68:71], v2, s[12:15], s41 offen
    s_waitcnt lgkmcnt(1)
    buffer_store_dwordx4 v[72:75], v2, s[12:15], s42 offen
    s_waitcnt lgkmcnt(0)
    buffer_store_dwordx4 v[76:79], v2, s[12:15], s43 offen
    s_endpgm
prep_kernel_kv:
    s_lshl_b32 s4, s3, 8
    v_lshlrev_b32 v4, 2, v0
    v_add_u32 v3, s4, v4
    s_and_b32 s17, s2, 1
    s_mul_i32 s21, s3, 176
    s_add_u32 s21, s21, s17
    s_lshl_b32 s21, s21, 10
    s_add_u32 s21, s21, 0
    s_cmp_lt_u32 s2, 186
    s_cbranch_scc1 prep_kernel_kvk
    s_add_u32 s21, s21, 6144
    s_load_dwordx2 s[8:9], s[0:1], 24
    s_branch prep_kernel_kv2
prep_kernel_kvk:
    s_load_dwordx2 s[8:9], s[0:1], 16
prep_kernel_kv2:
    s_mov_b32 s10, 25600
    s_mul_i32 s20, s3, 5120
    s_lshl_b32 s4, s17, 4
    v_add_u32 v6, s4, v6
    v_mul_u32_u24 v1, 320, v7
    v_lshl_add_u32 v1, v6, 1, v1
    v_mov_b32 v8, 0x7fff0000
    v_cmp_gt_u32 vcc, 20, v6
    s_nop 1
    v_cndmask_b32 v1, v8, v1, vcc
    v_mov_b32 v16, 0
    v_mov_b32 v17, 0
    v_mov_b32 v18, 0
    v_mov_b32 v19, 0
    v_mov_b32 v20, 0
    v_mov_b32 v21, 0
    v_mov_b32 v22, 0
    v_mov_b32 v23, 0
    v_mov_b32 v24, 0
    v_mov_b32 v25, 0
    v_mov_b32 v26, 0
    v_mov_b32 v27, 0
    v_mov_b32 v28, 0
    v_mov_b32 v29, 0
    v_mov_b32 v30, 0
    v_mov_b32 v31, 0
    v_mov_b32 v32, 0
    v_mov_b32 v33, 0
    v_mov_b32 v34, 0
    v_mov_b32 v35, 0
    v_mov_b32 v36, 0
    v_mov_b32 v37, 0
    v_mov_b32 v38, 0
    v_mov_b32 v39, 0
    v_mov_b32 v40, 0
    v_mov_b32 v41, 0
    v_mov_b32 v42, 0
    v_mov_b32 v43, 0
    v_mov_b32 v44, 0
    v_mov_b32 v45, 0
    v_mov_b32 v46, 0
    v_mov_b32 v47, 0
    s_waitcnt lgkmcnt(0)
    s_add_u32 s22, s20, 0
    buffer_load_short_d16_hi v16, v1, s[8:11], s22 offen
    s_add_u32 s22, s20, 40
    buffer_load_short_d16_hi v17, v1, s[8:11], s22 offen
    s_add_u32 s22, s20, 80
    buffer_load_short_d16_hi v18, v1, s[8:11], s22 offen
    s_add_u32 s22, s20, 120
    buffer_load_short_d16_hi v19, v1, s[8:11], s22 offen
    s_add_u32 s22, s20, 160
    buffer_load_short_d16_hi v20, v1, s[8:11], s22 offen
    s_add_u32 s22, s20, 200
    buffer_load_short_d16_hi v21, v1, s[8:11], s22 offen
    s_add_u32 s22, s20, 240
    buffer_load_short_d16_hi v22, v1, s[8:11], s22 offen
    s_add_u32 s22, s20, 280
    buffer_load_short_d16_hi v23, v1, s[8:11], s22 offen
    s_add_u32 s22, s20, 1280
    buffer_load_short_d16_hi v24, v1, s[8:11], s22 offen
    s_add_u32 s22, s20, 1320
    buffer_load_short_d16_hi v25, v1, s[8:11], s22 offen
    s_add_u32 s22, s20, 1360
    buffer_load_short_d16_hi v26, v1, s[8:11], s22 offen
    s_add_u32 s22, s20, 1400
    buffer_load_short_d16_hi v27, v1, s[8:11], s22 offen
    s_add_u32 s22, s20, 1440
    buffer_load_short_d16_hi v28, v1, s[8:11], s22 offen
    s_add_u32 s22, s20, 1480
    buffer_load_short_d16_hi v29, v1, s[8:11], s22 offen
    s_add_u32 s22, s20, 1520
    buffer_load_short_d16_hi v30, v1, s[8:11], s22 offen
    s_add_u32 s22, s20, 1560
    buffer_load_short_d16_hi v31, v1, s[8:11], s22 offen
    s_add_u32 s22, s20, 2560
    buffer_load_short_d16_hi v32, v1, s[8:11], s22 offen
    s_add_u32 s22, s20, 2600
    buffer_load_short_d16_hi v33, v1, s[8:11], s22 offen
    s_add_u32 s22, s20, 2640
    buffer_load_short_d16_hi v34, v1, s[8:11], s22 offen
    s_add_u32 s22, s20, 2680
    buffer_load_short_d16_hi v35, v1, s[8:11], s22 offen
    s_add_u32 s22, s20, 2720
    buffer_load_short_d16_hi v36, v1, s[8:11], s22 offen
    s_add_u32 s22, s20, 2760
    buffer_load_short_d16_hi v37, v1, s[8:11], s22 offen
    s_add_u32 s22, s20, 2800
    buffer_load_short_d16_hi v38, v1, s[8:11], s22 offen
    s_add_u32 s22, s20, 2840
    buffer_load_short_d16_hi v39, v1, s[8:11], s22 offen
    s_add_u32 s22, s20, 3840
    buffer_load_short_d16_hi v40, v1, s[8:11], s22 offen
    s_add_u32 s22, s20, 3880
    buffer_load_short_d16_hi v41, v1, s[8:11], s22 offen
    s_add_u32 s22, s20, 3920
    buffer_load_short_d16_hi v42, v1, s[8:11], s22 offen
    s_add_u32 s22, s20, 3960
    buffer_load_short_d16_hi v43, v1, s[8:11], s22 offen
    s_add_u32 s22, s20, 4000
    buffer_load_short_d16_hi v44, v1, s[8:11], s22 offen
    s_add_u32 s22, s20, 4040
    buffer_load_short_d16_hi v45, v1, s[8:11], s22 offen
    s_add_u32 s22, s20, 4080
    buffer_load_short_d16_hi v46, v1, s[8:11], s22 offen
    s_add_u32 s22, s20, 4120
    buffer_load_short_d16_hi v47, v1, s[8:11], s22 offen
    s_waitcnt vmcnt(0)
    v_add_f32 v5, v16, v17
    v_add_f32 v6, v18, v19
    v_add_f32 v5, v5, v20
    v_add_f32 v6, v6, v21
    v_add_f32 v5, v5, v22
    v_add_f32 v6, v6, v23
    v_add_f32 v5, v5, v24
    v_add_f32 v6, v6, v25
    v_add_f32 v5, v5, v26
    v_add_f32 v6, v6, v27
    v_add_f32 v5, v5, v28
    v_add_f32 v6, v6, v29
    v_add_f32 v5, v5, v30
    v_add_f32 v6, v6, v31
    v_add_f32 v5, v5, v32
    v_add_f32 v6, v6, v33
    v_add_f32 v5, v5, v34
    v_add_f32 v6, v6, v35
    v_add_f32 v5, v5, v36
    v_add_f32 v6, v6, v37
    v_add_f32 v5, v5, v38
    v_add_f32 v6, v6, v39
    v_add_f32 v5, v5, v40
    v_add_f32 v6, v6, v41
    v_add_f32 v5, v5, v42
    v_add_f32 v6, v6, v43
    v_add_f32 v5, v5, v44
    v_add_f32 v6, v6, v45
    v_add_f32 v5, v5, v46
    v_add_f32 v6, v6, v47
    v_add_f32 v5, v5, v6
    v_mov_b32 v6, v5
    s_nop 1
    v_permlane32_swap_b32 v5, v6
    s_nop 1
    v_add_f32 v5, v5, v6
    v_mov_b32 v6, v5
    s_nop 1
    v_permlane16_swap_b32 v5, v6
    s_nop 1
    v_add_f32 v5, v5, v6
    ds_write_b32 v3, v5
    s_waitcnt lgkmcnt(0)
    s_barrier
    ds_read_b32 v6, v4 offset:0
    ds_read_b32 v7, v4 offset:256
    ds_read_b32 v8, v4 offset:512
    ds_read_b32 v9, v4 offset:768
    ds_read_b32 v10, v4 offset:1024
    s_waitcnt lgkmcnt(0)
    v_add_f32 v6, v6, v7
    v_add_f32 v6, v6, v8
    v_add_f32 v6, v6, v9
    v_add_f32 v6, v6, v10
    v_mul_f32 v6, 0x3acccccd, v6
    v_sub_f32 v16, v16, v6
    v_sub_f32 v17, v17, v6
    v_sub_f32 v18, v18, v6
    v_sub_f32 v19, v19, v6
    v_sub_f32 v20, v20, v6
    v_sub_f32 v21, v21, v6
    v_sub_f32 v22, v22, v6
    v_sub_f32 v23, v23, v6
    v_sub_f32 v24, v24, v6
    v_sub_f32 v25, v25, v6
    v_sub_f32 v26, v26, v6
    v_sub_f32 v27, v27, v6
    v_sub_f32 v28, v28, v6
    v_sub_f32 v29, v29, v6
    v_sub_f32 v30, v30, v6
    v_sub_f32 v31, v31, v6
    v_sub_f32 v32, v32, v6
    v_sub_f32 v33, v33, v6
    v_sub_f32 v34, v34, v6
    v_sub_f32 v35, v35, v6
    v_sub_f32 v36, v36, v6
    v_sub_f32 v37, v37, v6
    v_sub_f32 v38, v38, v6
    v_sub_f32 v39, v39, v6
    v_sub_f32 v40, v40, v6
    v_sub_f32 v41, v41, v6
    v_sub_f32 v42, v42, v6
    v_sub_f32 v43, v43, v6
    v_sub_f32 v44, v44, v6
    v_sub_f32 v45, v45, v6
    v_sub_f32 v46, v46, v6
    v_sub_f32 v47, v47, v6
    v_cvt_pk_bf16_f32 v16, v16, v17
    v_cvt_pk_bf16_f32 v17, v18, v19
    v_cvt_pk_bf16_f32 v18, v20, v21
    v_cvt_pk_bf16_f32 v19, v22, v23
    s_add_u32 s22, s21, 0
    buffer_store_dwordx4 v[16:19], v2, s[12:15], s22 offen
    v_cvt_pk_bf16_f32 v24, v24, v25
    v_cvt_pk_bf16_f32 v25, v26, v27
    v_cvt_pk_bf16_f32 v26, v28, v29
    v_cvt_pk_bf16_f32 v27, v30, v31
    s_add_u32 s22, s21, 45056
    buffer_store_dwordx4 v[24:27], v2, s[12:15], s22 offen
    v_cvt_pk_bf16_f32 v32, v32, v33
    v_cvt_pk_bf16_f32 v33, v34, v35
    v_cvt_pk_bf16_f32 v34, v36, v37
    v_cvt_pk_bf16_f32 v35, v38, v39
    s_add_u32 s22, s21, 90112
    buffer_store_dwordx4 v[32:35], v2, s[12:15], s22 offen
    v_cvt_pk_bf16_f32 v40, v40, v41
    v_cvt_pk_bf16_f32 v41, v42, v43
    v_cvt_pk_bf16_f32 v42, v44, v45
    v_cvt_pk_bf16_f32 v43, v46, v47
    s_add_u32 s22, s21, 135168
    buffer_store_dwordx4 v[40:43], v2, s[12:15], s22 offen
    s_endpgm
prep_kernel_xc:
    s_load_dwordx2 s[8:9], s[0:1], 0
    s_mov_b32 s10, 2621440
    s_sub_u32 s7, s2, 188
    s_mul_i32 s7, s7, 5
    s_add_u32 s7, s7, s3
    s_cmp_ge_u32 s7, 256
    s_cbranch_scc1 prep_kernel_end
    s_and_b32 s6, s7, 1
    s_lshr_b32 s7, s7, 1
    s_mul_i32 s20, s7, 20480
    s_mul_i32 s4, s6, 640
    s_add_u32 s21, s20, s4
    s_mul_i32 s4, s6, 10240
    s_add_u32 s20, s20, s4
    s_add_u32 s20, s20, 8388608
    s_add_u32 s22, s20, 4096
    s_add_u32 s24, s20, 8192
    v_mul_u32_u24 v1, 1280, v6
    v_lshl_add_u32 v1, v7, 4, v1
    s_waitcnt lgkmcnt(0)
    buffer_load_dwordx4 v[16:19], v1, s[8:11], s21 offen offset:0
    buffer_load_dwordx4 v[20:23], v1, s[8:11], s21 offen offset:64
    buffer_load_dwordx4 v[24:27], v1, s[8:11], s21 offen offset:128
    buffer_load_dwordx4 v[28:31], v1, s[8:11], s21 offen offset:192
    buffer_load_dwordx4 v[32:35], v1, s[8:11], s21 offen offset:256
    buffer_load_dwordx4 v[36:39], v1, s[8:11], s21 offen offset:320
    buffer_load_dwordx4 v[40:43], v1, s[8:11], s21 offen offset:384
    buffer_load_dwordx4 v[44:47], v1, s[8:11], s21 offen offset:448
    buffer_load_dwordx4 v[48:51], v1, s[8:11], s21 offen offset:512
    buffer_load_dwordx4 v[52:55], v1, s[8:11], s21 offen offset:576
    v_mov_b32 v8, 0
    v_mov_b32 v9, 0
    v_mov_b32 v10, 0
    v_mov_b32 v11, 0
    s_lshl_b32 s4, s7, 1
    s_add_u32 s4, s4, s6
    s_cmp_ge_u32 s4, 169
    s_cbranch_scc1 prep_kernel_nofl
    s_lshl_b32 s4, s4, 10
    s_add_u32 s4, s4, 48234496
    buffer_store_dwordx4 v[8:11], v2, s[12:15], s4 offen
prep_kernel_nofl:
    v_mov_b32 v12, 0x3f803f80
    s_waitcnt vmcnt(0)
    buffer_store_dwordx4 v[16:19], v2, s[12:15], s20 offen offset:0
    buffer_store_dwordx4 v[20:23], v2, s[12:15], s20 offen offset:1024
    buffer_store_dwordx4 v[24:27], v2, s[12:15], s20 offen offset:2048
    buffer_store_dwordx4 v[28:31], v2, s[12:15], s20 offen offset:3072
    buffer_store_dwordx4 v[32:35], v2, s[12:15], s22 offen offset:0
    buffer_store_dwordx4 v[36:39], v2, s[12:15], s22 offen offset:1024
    buffer_store_dwordx4 v[40:43], v2, s[12:15], s22 offen offset:2048
    buffer_store_dwordx4 v[44:47], v2, s[12:15], s22 offen offset:3072
    buffer_store_dwordx4 v[48:51], v2, s[12:15], s24 offen offset:0
    buffer_store_dwordx4 v[52:55], v2, s[12:15], s24 offen offset:1024
    v_mov_b32 v60, 0
    v_mov_b32 v61, 0
    v_mov_b32 v62, 0
    v_mov_b32 v63, 0
    v_dot2_f32_bf16 v60, v16, v12, v60
    v_dot2_f32_bf16 v61, v16, v16, v61
    s_nop 1
    v_dot2_f32_bf16 v60, v17, v12, v60
    v_dot2_f32_bf16 v61, v17, v17, v61
    s_nop 1
    v_dot2_f32_bf16 v60, v18, v12, v60
    v_dot2_f32_bf16 v61, v18, v18, v61
    s_nop 1
    v_dot2_f32_bf16 v60, v19, v12, v60
    v_dot2_f32_bf16 v61, v19, v19, v61
    s_nop 1
    v_dot2_f32_bf16 v60, v20, v12, v60
    v_dot2_f32_bf16 v61, v20, v20, v61
    s_nop 1
    v_dot2_f32_bf16 v60, v21, v12, v60
    v_dot2_f32_bf16 v61, v21, v21, v61
    s_nop 1
    v_dot2_f32_bf16 v60, v22, v12, v60
    v_dot2_f32_bf16 v61, v22, v22, v61
    s_nop 1
    v_dot2_f32_bf16 v60, v23, v12, v60
    v_dot2_f32_bf16 v61, v23, v23, v61
    s_nop 1
    v_dot2_f32_bf16 v60, v24, v12, v60
    v_dot2_f32_bf16 v61, v24, v24, v61
    s_nop 1
    v_dot2_f32_bf16 v60, v25, v12, v60
    v_dot2_f32_bf16 v61, v25, v25, v61
    s_nop 1
    v_dot2_f32_bf16 v60, v26, v12, v60
    v_dot2_f32_bf16 v61, v26, v26, v61
    s_nop 1
    v_dot2_f32_bf16 v60, v27, v12, v60
    v_dot2_f32_bf16 v61, v27, v27, v61
    s_nop 1
    v_dot2_f32_bf16 v60, v28, v12, v60
    v_dot2_f32_bf16 v61, v28, v28, v61
    s_nop 1
    v_dot2_f32_bf16 v60, v29, v12, v60
    v_dot2_f32_bf16 v61, v29, v29, v61
    s_nop 1
    v_dot2_f32_bf16 v60, v30, v12, v60
    v_dot2_f32_bf16 v61, v30, v30, v61
    s_nop 1
    v_dot2_f32_bf16 v60, v31, v12, v60
    v_dot2_f32_bf16 v61, v31, v31, v61
    s_nop 1
    v_dot2_f32_bf16 v60, v32, v12, v60
    v_dot2_f32_bf16 v61, v32, v32, v61
    s_nop 1
    v_dot2_f32_bf16 v60, v33, v12, v60
    v_dot2_f32_bf16 v61, v33, v33, v61
    s_nop 1
    v_dot2_f32_bf16 v60, v34, v12, v60
    v_dot2_f32_bf16 v61, v34, v34, v61
    s_nop 1
    v_dot2_f32_bf16 v60, v35, v12, v60
    v_dot2_f32_bf16 v61, v35, v35, v61
    s_nop 1
    v_dot2_f32_bf16 v60, v36, v12, v60
    v_dot2_f32_bf16 v61, v36, v36, v61
    s_nop 1
    v_dot2_f32_bf16 v60, v37, v12, v60
    v_dot2_f32_bf16 v61, v37, v37, v61
    s_nop 1
    v_dot2_f32_bf16 v60, v38, v12, v60
    v_dot2_f32_bf16 v61, v38, v38, v61
    s_nop 1
    v_dot2_f32_bf16 v60, v39, v12, v60
    v_dot2_f32_bf16 v61, v39, v39, v61
    s_nop 1
    v_dot2_f32_bf16 v60, v40, v12, v60
    v_dot2_f32_bf16 v61, v40, v40, v61
    s_nop 1
    v_dot2_f32_bf16 v60, v41, v12, v60
    v_dot2_f32_bf16 v61, v41, v41, v61
    s_nop 1
    v_dot2_f32_bf16 v60, v42, v12, v60
    v_dot2_f32_bf16 v61, v42, v42, v61
    s_nop 1
    v_dot2_f32_bf16 v60, v43, v12, v60
    v_dot2_f32_bf16 v61, v43, v43, v61
    s_nop 1
    v_dot2_f32_bf16 v60, v44, v12, v60
    v_dot2_f32_bf16 v61, v44, v44, v61
    s_nop 1
    v_dot2_f32_bf16 v60, v45, v12, v60
    v_dot2_f32_bf16 v61, v45, v45, v61
    s_nop 1
    v_dot2_f32_bf16 v60, v46, v12, v60
    v_dot2_f32_bf16 v61, v46, v46, v61
    s_nop 1
    v_dot2_f32_bf16 v60, v47, v12, v60
    v_dot2_f32_bf16 v61, v47, v47, v61
    s_nop 1
    v_dot2_f32_bf16 v60, v48, v12, v60
    v_dot2_f32_bf16 v61, v48, v48, v61
    s_nop 1
    v_dot2_f32_bf16 v60, v49, v12, v60
    v_dot2_f32_bf16 v61, v49, v49, v61
    s_nop 1
    v_dot2_f32_bf16 v60, v50, v12, v60
    v_dot2_f32_bf16 v61, v50, v50, v61
    s_nop 1
    v_dot2_f32_bf16 v60, v51, v12, v60
    v_dot2_f32_bf16 v61, v51, v51, v61
    s_nop 1
    v_dot2_f32_bf16 v60, v52, v12, v60
    v_dot2_f32_bf16 v61, v52, v52, v61
    s_nop 1
    v_dot2_f32_bf16 v60, v53, v12, v60
    v_dot2_f32_bf16 v61, v53, v53, v61
    s_nop 1
    v_dot2_f32_bf16 v60, v54, v12, v60
    v_dot2_f32_bf16 v61, v54, v54, v61
    s_nop 1
    v_dot2_f32_bf16 v60, v55, v12, v60
    v_dot2_f32_bf16 v61, v55, v55, v61
    s_nop 1
    s_nop 1
    v_mov_b32 v64, v60
    s_nop 1
    v_permlane32_swap_b32 v60, v64
    s_nop 1
    v_add_f32 v60, v60, v64
    v_mov_b32 v65, v61
    s_nop 1
    v_permlane32_swap_b32 v61, v65
    s_nop 1
    v_add_f32 v61, v61, v65
    v_mov_b32 v64, v60
    s_nop 1
    v_permlane16_swap_b32 v60, v64
    s_nop 1
    v_add_f32 v60, v60, v64
    v_mov_b32 v65, v61
    s_nop 1
    v_permlane16_swap_b32 v61, v65
    s_nop 1
    v_add_f32 v61, v61, v65
    s_lshl_b32 s4, s7, 10
    s_lshl_b32 s5, s6, 5
    s_add_u32 s4, s4, s5
    s_add_u32 s4, s4, 47185920
    v_lshlrev_b32 v3, 6, v6
    s_mov_b64 exec, 0xffff
    buffer_store_dwordx4 v[60:63], v3, s[12:15], s4 offen
    buffer_store_dwordx4 v[8:11], v3, s[12:15], s4 offen offset:16
    s_endpgm
prep_kernel_end:
    s_endpgm
.section .rodata,"a"
.p2align 6
.amdhsa_kernel prep_kernel
  .amdhsa_next_free_vgpr 116
  .amdhsa_next_free_sgpr 102
  .amdhsa_accum_offset 116
  .amdhsa_group_segment_fixed_size 0
  .amdhsa_kernarg_size 96
  .amdhsa_user_sgpr_count 2
  .amdhsa_user_sgpr_kernarg_segment_ptr 1
  .amdhsa_system_sgpr_workgroup_id_x 1
.end_amdhsa_kernel

.text
.globl main_kernel
.p2align 8
.type main_kernel,@function
main_kernel:
    s_cmp_ge_u32 s2, 256
    s_cbranch_scc0 main_kernel_go
    s_endpgm
main_kernel_go:
    s_load_dwordx2 s[8:9], s[0:1], 88
    s_mov_b32 s10, 268435456
    s_mov_b32 s11, 0x00020000
    s_load_dwordx2 s[16:17], s[0:1], 72
    s_mov_b32 s18, 2621440
    s_mov_b32 s19, 0x00020000
    v_lshrrev_b32 v5, 6, v0
    v_and_b32 v0, 63, v0
    v_readfirstlane_b32 s3, v5
    s_mov_b32 s85, s2
    s_mov_b32 s84, 0
    s_and_b32 s4, s85, 7
    s_lshr_b32 s5, s85, 3
    s_lshr_b32 s6, s5, 3
    s_and_b32 s51, s5, 7
    s_lshl_b32 s50, s4, 2
    s_add_u32 s50, s50, s6
    s_lshr_b32 s59, s50, 1
    s_lshl_b32 s59, s59, 8
    s_and_b32 s52, s50, 1
    s_lshl_b32 s52, s52, 5
    s_add_u32 s59, s59, s52
    s_lshl_b32 s52, s51, 2
    s_add_u32 s52, s52, s59
    s_lshr_b32 s53, s4, 1
    s_lshl_b32 s53, s53, 2
    s_add_u32 s53, s53, s6
    s_and_b32 s54, s4, 1
    s_lshl_b32 s54, s54, 3
    s_add_u32 s54, s54, s51
    s_lshl_b32 s55, s53, 6
    s_add_u32 s55, s55, s54
    s_lshl_b32 s55, s55, 2
    s_lshl_b32 s56, s4, 3
    s_lshr_b32 s7, s5, 2
    s_add_u32 s56, s56, s7
    s_and_b32 s57, s5, 3
    s_and_b32 s58, s56, 3
    s_lshl_b32 s58, s58, 2
    s_add_u32 s58, s58, s57
    s_lshl_b32 s58, s58, 2
    s_lshr_b32 s7, s56, 2
    s_lshl_b32 s7, s7, 8
    s_add_u32 s58, s58, s7
    s_lshr_b32 s53, s50, 1
    s_and_b32 s54, s5, 15
    s_lshl_b32 s55, s53, 6
    s_add_u32 s55, s55, s54
    s_lshl_b32 s55, s55, 2
    s_waitcnt lgkmcnt(0)
    s_cmp_lg_u32 s3, 7
    s_cbranch_scc1 main_kernel_dy0
    s_getreg_b32 s86, hwreg(HW_REG_XCC_ID, 0, 4)
    v_mov_b32 v240, 1
    s_lshl_b32 s87, s86, 8
    s_add_u32 s87, s87, 48399360
    s_mov_b64 exec, 1
    buffer_atomic_add v240, off, s[8:11], s87 sc0 sc1
    s_mov_b64 exec, -1
main_kernel_dy0:
    s_cmp_lt_u32 s3, 4
    s_cbranch_scc1 main_kernel_c0
    s_and_b32 s98, s3, 3
    s_mul_i32 s93, s98, 3072
    s_mov_b32 s94, 286000640
    s_mov_b32 s95, 639704086
    s_lshl_b32 s96, s51, 3
    s_lshr_b64 s[94:95], s[94:95], s96
    s_and_b32 s92, s94, 0xff
    s_lshr_b32 s94, s98, 1
    s_mul_i32 s94, s94, 44
    s_add_u32 s92, s92, s94
    s_and_b32 s94, s98, 1
    s_mul_i32 s94, s94, 3
    s_add_u32 s92, s92, s94
    s_lshl_b32 s92, s92, 10
    s_add_u32 s92, s92, 0
    s_and_b32 s7, s3, 3
    s_mov_b32 s20, s92
    s_mov_b32 s21, s93
    v_lshlrev_b32 v1, 4, v0
    v_add_u32 v20, s93, v1
    v_add_u32 v21, 0x10000, v20
    s_add_u32 m0, s21, 0
    s_add_u32 s23, s20, 0
    buffer_load_dwordx4 v1, s[8:11], s23 offen offset:0 lds
    buffer_load_dwordx4 v1, s[8:11], s23 offen offset:1024 lds
    buffer_load_dwordx4 v1, s[8:11], s23 offen offset:2048 lds
    s_add_u32 m0, s21, 12288
    s_add_u32 s23, s20, 90112
    buffer_load_dwordx4 v1, s[8:11], s23 offen offset:0 lds
    buffer_load_dwordx4 v1, s[8:11], s23 offen offset:1024 lds
    buffer_load_dwordx4 v1, s[8:11], s23 offen offset:2048 lds
    s_add_u32 m0, s21, 24576
    s_add_u32 s23, s20, 180224
    buffer_load_dwordx4 v1, s[8:11], s23 offen offset:0 lds
    buffer_load_dwordx4 v1, s[8:11], s23 offen offset:1024 lds
    buffer_load_dwordx4 v1, s[8:11], s23 offen offset:2048 lds
    s_add_u32 m0, s21, 36864
    s_add_u32 s23, s20, 270336
    buffer_load_dwordx4 v1, s[8:11], s23 offen offset:0 lds
    buffer_load_dwordx4 v1, s[8:11], s23 offen offset:1024 lds
    buffer_load_dwordx4 v1, s[8:11], s23 offen offset:2048 lds
    s_add_u32 m0, s21, 49152
    s_add_u32 s23, s20, 360448
    buffer_load_dwordx4 v1, s[8:11], s23 offen offset:0 lds
    buffer_load_dwordx4 v1, s[8:11], s23 offen offset:1024 lds
    buffer_load_dwordx4 v1, s[8:11], s23 offen offset:2048 lds
    s_add_u32 m0, s21, 61440
    s_add_u32 s23, s20, 450560
    buffer_load_dwordx4 v1, s[8:11], s23 offen offset:0 lds
    buffer_load_dwordx4 v1, s[8:11], s23 offen offset:1024 lds
    buffer_load_dwordx4 v1, s[8:11], s23 offen offset:2048 lds
    s_add_u32 m0, s21, 73728
    s_add_u32 s23, s20, 540672
    buffer_load_dwordx4 v1, s[8:11], s23 offen offset:0 lds
    buffer_load_dwordx4 v1, s[8:11], s23 offen offset:1024 lds
    buffer_load_dwordx4 v1, s[8:11], s23 offen offset:2048 lds
    s_add_u32 m0, s21, 86016
    s_add_u32 s23, s20, 630784
    buffer_load_dwordx4 v1, s[8:11], s23 offen offset:0 lds
    buffer_load_dwordx4 v1, s[8:11], s23 offen offset:1024 lds
    buffer_load_dwordx4 v1, s[8:11], s23 offen offset:2048 lds
    s_add_u32 m0, s21, 98304
    s_add_u32 s23, s20, 720896
    buffer_load_dwordx4 v1, s[8:11], s23 offen offset:0 lds
    buffer_load_dwordx4 v1, s[8:11], s23 offen offset:1024 lds
    buffer_load_dwordx4 v1, s[8:11], s23 offen offset:2048 lds
    s_add_u32 m0, s21, 110592
    s_add_u32 s23, s20, 811008
    buffer_load_dwordx4 v1, s[8:11], s23 offen offset:0 lds
    buffer_load_dwordx4 v1, s[8:11], s23 offen offset:1024 lds
    buffer_load_dwordx4 v1, s[8:11], s23 offen offset:2048 lds
    s_waitcnt vmcnt(27)
    s_waitcnt vmcnt(24)
    s_barrier
    s_waitcnt vmcnt(21)
    s_waitcnt vmcnt(18)
    s_barrier
    s_waitcnt vmcnt(15)
    s_waitcnt vmcnt(12)
    s_barrier
    s_waitcnt vmcnt(9)
    s_waitcnt vmcnt(6)
    s_barrier
    s_waitcnt vmcnt(3)
    s_waitcnt vmcnt(0)
    s_barrier
    s_cmp_lg_u32 s3, 7
    s_cbranch_scc1 main_kernel_dy9
    v_lshlrev_b32 v241, 8, v0
    s_mov_b32 s87, 48399360
    s_mov_b32 s45, 0x100000
    s_mov_b64 exec, 0xffff
main_kernel_dy1:
    buffer_load_dword v242, v241, s[8:11], s87 offen sc1
    s_waitcnt vmcnt(0)
    v_readfirstlane_b32 s85, v240
    v_cmp_eq_u32 vcc, 32, v242
    s_lshl_b32 s85, s85, 3
    s_add_u32 s85, s85, s86
    s_cmp_eq_u32 vcc_lo, 255
    s_cbranch_scc1 main_kernel_dy3
    s_mov_b32 s88, 0
    v_readlane_b32 s89, v242, 0
    s_add_u32 s88, s88, s89
    v_readlane_b32 s89, v242, 1
    s_add_u32 s88, s88, s89
    v_readlane_b32 s89, v242, 2
    s_add_u32 s88, s88, s89
    v_readlane_b32 s89, v242, 3
    s_add_u32 s88, s88, s89
    v_readlane_b32 s89, v242, 4
    s_add_u32 s88, s88, s89
    v_readlane_b32 s89, v242, 5
    s_add_u32 s88, s88, s89
    v_readlane_b32 s89, v242, 6
    s_add_u32 s88, s88, s89
    v_readlane_b32 s89, v242, 7
    s_add_u32 s88, s88, s89
    v_readlane_b32 s89, v242, 8
    s_add_u32 s88, s88, s89
    v_readlane_b32 s89, v242, 9
    s_add_u32 s88, s88, s89
    v_readlane_b32 s89, v242, 10
    s_add_u32 s88, s88, s89
    v_readlane_b32 s89, v242, 11
    s_add_u32 s88, s88, s89
    v_readlane_b32 s89, v242, 12
    s_add_u32 s88, s88, s89
    v_readlane_b32 s89, v242, 13
    s_add_u32 s88, s88, s89
    v_readlane_b32 s89, v242, 14
    s_add_u32 s88, s88, s89
    v_readlane_b32 s89, v242, 15
    s_add_u32 s88, s88, s89
    s_sub_u32 s45, s45, 1
    s_cbranch_scc1 main_kernel_dy2
    s_cmp_lt_u32 s88, 256
    s_cbranch_scc1 main_kernel_dy1
main_kernel_dy2:
    s_add_u32 s85, s2, 256
main_kernel_dy3:
    v_mov_b32 v241, 0x20000
    v_mov_b32 v242, s85
    ds_write_b32 v241, v242
    s_mov_b64 exec, -1
    s_waitcnt lgkmcnt(0)
main_kernel_dy9:
    s_barrier
    s_barrier
    s_branch main_kernel_j0
main_kernel_c0:
    v_lshlrev_b32 v1, 4, v0
    v_and_b32 v6, 15, v0
    v_lshrrev_b32 v7, 4, v0
    s_and_b32 s7, s3, 1
    s_lshr_b32 s5, s3, 1
    s_lshl_b32 s4, s50, 2
    s_lshl_b32 s20, s7, 1
    s_add_u32 s4, s4, s20
    s_mul_i32 s22, s4, 20480
    s_lshl_b32 s20, s5, 10
    s_add_u32 s22, s22, s20
    s_add_u32 s22, s22, 8388608
    s_add_u32 s4, s4, s5
    s_mul_i32 s20, s5, 6144
    v_add_u32 v2, s20, v1
    v_add_u32 v3, 0x10000, v2
    v_add_u32 v4, 0x20000, v2
    v_add_u32 v5, 20480, v1
    v_lshrrev_b32 v10, 1, v7
    v_and_b32 v11, 1, v7
    v_lshlrev_b32 v8, 8, v10
    v_lshl_add_u32 v8, v6, 4, v8
    v_lshl_add_u32 v9, v11, 9, v8
    v_lshl_add_u32 v8, v11, 3, v8
    s_lshl_b32 s26, s4, 10
    s_add_u32 s26, s26, 47185920
    v_lshlrev_b32 v12, 6, v6
    v_lshl_add_u32 v12, v7, 4, v12
    buffer_load_dwordx4 v[12:15], v12, s[8:11], s26 offen sc1
    s_add_u32 s23, s22, 0
    buffer_load_dwordx4 v[24:27], v1, s[8:11], s23 offen sc1
    buffer_load_dwordx4 v[28:31], v5, s[8:11], s23 offen sc1
    s_add_u32 s23, s22, 2048
    buffer_load_dwordx4 v[32:35], v1, s[8:11], s23 offen sc1
    buffer_load_dwordx4 v[36:39], v5, s[8:11], s23 offen sc1
    s_add_u32 s23, s22, 4096
    buffer_load_dwordx4 v[40:43], v1, s[8:11], s23 offen sc1
    buffer_load_dwordx4 v[44:47], v5, s[8:11], s23 offen sc1
    s_add_u32 s23, s22, 6144
    buffer_load_dwordx4 v[48:51], v1, s[8:11], s23 offen sc1
    buffer_load_dwordx4 v[52:55], v5, s[8:11], s23 offen sc1
    s_add_u32 s23, s22, 8192
    buffer_load_dwordx4 v[56:59], v1, s[8:11], s23 offen sc1
    buffer_load_dwordx4 v[60:63], v5, s[8:11], s23 offen sc1
    s_add_u32 s23, s22, 10240
    buffer_load_dwordx4 v[64:67], v1, s[8:11], s23 offen sc1
    buffer_load_dwordx4 v[68:71], v5, s[8:11], s23 offen sc1
    s_add_u32 s23, s22, 12288
    buffer_load_dwordx4 v[72:75], v1, s[8:11], s23 offen sc1
    buffer_load_dwordx4 v[76:79], v5, s[8:11], s23 offen sc1
    s_add_u32 s23, s22, 14336
    buffer_load_dwordx4 v[80:83], v1, s[8:11], s23 offen sc1
    buffer_load_dwordx4 v[84:87], v5, s[8:11], s23 offen sc1
    s_add_u32 s23, s22, 16384
    buffer_load_dwordx4 v[88:91], v1, s[8:11], s23 offen sc1
    buffer_load_dwordx4 v[92:95], v5, s[8:11], s23 offen sc1
    s_add_u32 s23, s22, 18432
    buffer_load_dwordx4 v[96:99], v1, s[8:11], s23 offen sc1
    buffer_load_dwordx4 v[100:103], v5, s[8:11], s23 offen sc1
    s_barrier
    ds_read_b128 v[104:107], v2 offset:0
    ds_read_b128 v[108:111], v2 offset:1024
    ds_read_b128 v[112:115], v2 offset:2048
    ds_read_b128 v[116:119], v2 offset:3072
    ds_read_b128 v[120:123], v2 offset:4096
    ds_read_b128 v[124:127], v2 offset:5120
    s_waitcnt vmcnt(18)
    s_waitcnt lgkmcnt(5)
    v_mfma_f32_16x16x32_bf16 v[152:155], v[104:107], v[24:27], 0
    v_mfma_f32_16x16x32_bf16 v[176:179], v[104:107], v[28:31], 0
    ds_read_b128 v[128:131], v2 offset:12288
    s_waitcnt lgkmcnt(5)
    v_mfma_f32_16x16x32_bf16 v[156:159], v[108:111], v[24:27], 0
    v_mfma_f32_16x16x32_bf16 v[180:183], v[108:111], v[28:31], 0
    ds_read_b128 v[132:135], v2 offset:13312
    s_waitcnt lgkmcnt(5)
    v_mfma_f32_16x16x32_bf16 v[160:163], v[112:115], v[24:27], 0
    v_mfma_f32_16x16x32_bf16 v[184:187], v[112:115], v[28:31], 0
    ds_read_b128 v[136:139], v2 offset:14336
    s_waitcnt lgkmcnt(5)
    v_mfma_f32_16x16x32_bf16 v[164:167], v[116:119], v[24:27], 0
    v_mfma_f32_16x16x32_bf16 v[188:191], v[116:119], v[28:31], 0
    ds_read_b128 v[140:143], v2 offset:15360
    s_waitcnt lgkmcnt(5)
    v_mfma_f32_16x16x32_bf16 v[168:171], v[120:123], v[24:27], 0
    v_mfma_f32_16x16x32_bf16 v[192:195], v[120:123], v[28:31], 0
    ds_read_b128 v[144:147], v2 offset:16384
    s_waitcnt lgkmcnt(5)
    v_mfma_f32_16x16x32_bf16 v[172:175], v[124:127], v[24:27], 0
    v_mfma_f32_16x16x32_bf16 v[196:199], v[124:127], v[28:31], 0
    ds_read_b128 v[148:151], v2 offset:17408
    s_waitcnt vmcnt(16)
    s_waitcnt lgkmcnt(5)
    v_mfma_f32_16x16x32_bf16 v[152:155], v[128:131], v[32:35], v[152:155]
    v_mfma_f32_16x16x32_bf16 v[176:179], v[128:131], v[36:39], v[176:179]
    s_barrier
    ds_read_b128 v[104:107], v2 offset:24576
    s_waitcnt lgkmcnt(5)
    v_mfma_f32_16x16x32_bf16 v[156:159], v[132:135], v[32:35], v[156:159]
    v_mfma_f32_16x16x32_bf16 v[180:183], v[132:135], v[36:39], v[180:183]
    ds_read_b128 v[108:111], v2 offset:25600
    s_waitcnt lgkmcnt(5)
    v_mfma_f32_16x16x32_bf16 v[160:163], v[136:139], v[32:35], v[160:163]
    v_mfma_f32_16x16x32_bf16 v[184:187], v[136:139], v[36:39], v[184:187]
    ds_read_b128 v[112:115], v2 offset:26624
    s_waitcnt lgkmcnt(5)
    v_mfma_f32_16x16x32_bf16 v[164:167], v[140:143], v[32:35], v[164:167]
    v_mfma_f32_16x16x32_bf16 v[188:191], v[140:143], v[36:39], v[188:191]
    ds_read_b128 v[116:119], v2 offset:27648
    s_waitcnt lgkmcnt(5)
    v_mfma_f32_16x16x32_bf16 v[168:171], v[144:147], v[32:35], v[168:171]
    v_mfma_f32_16x16x32_bf16 v[192:195], v[144:147], v[36:39], v[192:195]
    ds_read_b128 v[120:123], v2 offset:28672
    s_waitcnt lgkmcnt(5)
    v_mfma_f32_16x16x32_bf16 v[172:175], v[148:151], v[32:35], v[172:175]
    v_mfma_f32_16x16x32_bf16 v[196:199], v[148:151], v[36:39], v[196:199]
    ds_read_b128 v[124:127], v2 offset:29696
    s_waitcnt vmcnt(14)
    s_waitcnt lgkmcnt(5)
    v_mfma_f32_16x16x32_bf16 v[152:155], v[104:107], v[40:43], v[152:155]
    v_mfma_f32_16x16x32_bf16 v[176:179], v[104:107], v[44:47], v[176:179]
    ds_read_b128 v[128:131], v2 offset:36864
    s_waitcnt lgkmcnt(5)
    v_mfma_f32_16x16x32_bf16 v[156:159], v[108:111], v[40:43], v[156:159]
    v_mfma_f32_16x16x32_bf16 v[180:183], v[108:111], v[44:47], v[180:183]
    ds_read_b128 v[132:135], v2 offset:37888
    s_waitcnt lgkmcnt(5)
    v_mfma_f32_16x16x32_bf16 v[160:163], v[112:115], v[40:43], v[160:163]
    v_mfma_f32_16x16x32_bf16 v[184:187], v[112:115], v[44:47], v[184:187]
    ds_read_b128 v[136:139], v2 offset:38912
    s_waitcnt lgkmcnt(5)
    v_mfma_f32_16x16x32_bf16 v[164:167], v[116:119], v[40:43], v[164:167]
    v_mfma_f32_16x16x32_bf16 v[188:191], v[116:119], v[44:47], v[188:191]
    ds_read_b128 v[140:143], v2 offset:39936
    s_waitcnt lgkmcnt(5)
    v_mfma_f32_16x16x32_bf16 v[168:171], v[120:123], v[40:43], v[168:171]
    v_mfma_f32_16x16x32_bf16 v[192:195], v[120:123], v[44:47], v[192:195]
    ds_read_b128 v[144:147], v2 offset:40960
    s_waitcnt lgkmcnt(5)
    v_mfma_f32_16x16x32_bf16 v[172:175], v[124:127], v[40:43], v[172:175]
    v_mfma_f32_16x16x32_bf16 v[196:199], v[124:127], v[44:47], v[196:199]
    ds_read_b128 v[148:151], v2 offset:41984
    s_waitcnt vmcnt(12)
    s_waitcnt lgkmcnt(5)
    v_mfma_f32_16x16x32_bf16 v[152:155], v[128:131], v[48:51], v[152:155]
    v_mfma_f32_16x16x32_bf16 v[176:179], v[128:131], v[52:55], v[176:179]
    s_barrier
    ds_read_b128 v[104:107], v2 offset:49152
    s_waitcnt lgkmcnt(5)
    v_mfma_f32_16x16x32_bf16 v[156:159], v[132:135], v[48:51], v[156:159]
    v_mfma_f32_16x16x32_bf16 v[180:183], v[132:135], v[52:55], v[180:183]
    ds_read_b128 v[108:111], v2 offset:50176
    s_waitcnt lgkmcnt(5)
    v_mfma_f32_16x16x32_bf16 v[160:163], v[136:139], v[48:51], v[160:163]
    v_mfma_f32_16x16x32_bf16 v[184:187], v[136:139], v[52:55], v[184:187]
    ds_read_b128 v[112:115], v2 offset:51200
    s_waitcnt lgkmcnt(5)
    v_mfma_f32_16x16x32_bf16 v[164:167], v[140:143], v[48:51], v[164:167]
    v_mfma_f32_16x16x32_bf16 v[188:191], v[140:143], v[52:55], v[188:191]
    ds_read_b128 v[116:119], v2 offset:52224
    s_waitcnt lgkmcnt(5)
    v_mfma_f32_16x16x32_bf16 v[168:171], v[144:147], v[48:51], v[168:171]
    v_mfma_f32_16x16x32_bf16 v[192:195], v[144:147], v[52:55], v[192:195]
    ds_read_b128 v[120:123], v2 offset:53248
    s_waitcnt lgkmcnt(5)
    v_mfma_f32_16x16x32_bf16 v[172:175], v[148:151], v[48:51], v[172:175]
    v_mfma_f32_16x16x32_bf16 v[196:199], v[148:151], v[52:55], v[196:199]
    ds_read_b128 v[124:127], v2 offset:54272
    s_waitcnt vmcnt(10)
    s_waitcnt lgkmcnt(5)
    v_mfma_f32_16x16x32_bf16 v[152:155], v[104:107], v[56:59], v[152:155]
    v_mfma_f32_16x16x32_bf16 v[176:179], v[104:107], v[60:63], v[176:179]
    ds_read_b128 v[128:131], v2 offset:61440
    s_waitcnt lgkmcnt(5)
    v_mfma_f32_16x16x32_bf16 v[156:159], v[108:111], v[56:59], v[156:159]
    v_mfma_f32_16x16x32_bf16 v[180:183], v[108:111], v[60:63], v[180:183]
    ds_read_b128 v[132:135], v2 offset:62464
    s_waitcnt lgkmcnt(5)
    v_mfma_f32_16x16x32_bf16 v[160:163], v[112:115], v[56:59], v[160:163]
    v_mfma_f32_16x16x32_bf16 v[184:187], v[112:115], v[60:63], v[184:187]
    ds_read_b128 v[136:139], v2 offset:63488
    s_waitcnt lgkmcnt(5)
    v_mfma_f32_16x16x32_bf16 v[164:167], v[116:119], v[56:59], v[164:167]
    v_mfma_f32_16x16x32_bf16 v[188:191], v[116:119], v[60:63], v[188:191]
    ds_read_b128 v[140:143], v2 offset:64512
    s_waitcnt lgkmcnt(5)
    v_mfma_f32_16x16x32_bf16 v[168:171], v[120:123], v[56:59], v[168:171]
    v_mfma_f32_16x16x32_bf16 v[192:195], v[120:123], v[60:63], v[192:195]
    ds_read_b128 v[144:147], v3 offset:0
    s_waitcnt lgkmcnt(5)
    v_mfma_f32_16x16x32_bf16 v[172:175], v[124:127], v[56:59], v[172:175]
    v_mfma_f32_16x16x32_bf16 v[196:199], v[124:127], v[60:63], v[196:199]
    ds_read_b128 v[148:151], v3 offset:1024
    s_waitcnt vmcnt(8)
    s_waitcnt lgkmcnt(5)
    v_mfma_f32_16x16x32_bf16 v[152:155], v[128:131], v[64:67], v[152:155]
    v_mfma_f32_16x16x32_bf16 v[176:179], v[128:131], v[68:71], v[176:179]
    s_barrier
    ds_read_b128 v[104:107], v3 offset:8192
    s_waitcnt lgkmcnt(5)
    v_mfma_f32_16x16x32_bf16 v[156:159], v[132:135], v[64:67], v[156:159]
    v_mfma_f32_16x16x32_bf16 v[180:183], v[132:135], v[68:71], v[180:183]
    ds_read_b128 v[108:111], v3 offset:9216
    s_waitcnt lgkmcnt(5)
    v_mfma_f32_16x16x32_bf16 v[160:163], v[136:139], v[64:67], v[160:163]
    v_mfma_f32_16x16x32_bf16 v[184:187], v[136:139], v[68:71], v[184:187]
    ds_read_b128 v[112:115], v3 offset:10240
    s_waitcnt lgkmcnt(5)
    v_mfma_f32_16x16x32_bf16 v[164:167], v[140:143], v[64:67], v[164:167]
    v_mfma_f32_16x16x32_bf16 v[188:191], v[140:143], v[68:71], v[188:191]
    ds_read_b128 v[116:119], v3 offset:11264
    s_waitcnt lgkmcnt(5)
    v_mfma_f32_16x16x32_bf16 v[168:171], v[144:147], v[64:67], v[168:171]
    v_mfma_f32_16x16x32_bf16 v[192:195], v[144:147], v[68:71], v[192:195]
    ds_read_b128 v[120:123], v3 offset:12288
    s_waitcnt lgkmcnt(5)
    v_mfma_f32_16x16x32_bf16 v[172:175], v[148:151], v[64:67], v[172:175]
    v_mfma_f32_16x16x32_bf16 v[196:199], v[148:151], v[68:71], v[196:199]
    ds_read_b128 v[124:127], v3 offset:13312
    s_waitcnt vmcnt(6)
    s_waitcnt lgkmcnt(5)
    v_mfma_f32_16x16x32_bf16 v[152:155], v[104:107], v[72:75], v[152:155]
    v_mfma_f32_16x16x32_bf16 v[176:179], v[104:107], v[76:79], v[176:179]
    ds_read_b128 v[128:131], v3 offset:20480
    s_waitcnt lgkmcnt(5)
    v_mfma_f32_16x16x32_bf16 v[156:159], v[108:111], v[72:75], v[156:159]
    v_mfma_f32_16x16x32_bf16 v[180:183], v[108:111], v[76:79], v[180:183]
    ds_read_b128 v[132:135], v3 offset:21504
    s_waitcnt lgkmcnt(5)
    v_mfma_f32_16x16x32_bf16 v[160:163], v[112:115], v[72:75], v[160:163]
    v_mfma_f32_16x16x32_bf16 v[184:187], v[112:115], v[76:79], v[184:187]
    ds_read_b128 v[136:139], v3 offset:22528
    s_waitcnt lgkmcnt(5)
    v_mfma_f32_16x16x32_bf16 v[164:167], v[116:119], v[72:75], v[164:167]
    v_mfma_f32_16x16x32_bf16 v[188:191], v[116:119], v[76:79], v[188:191]
    ds_read_b128 v[140:143], v3 offset:23552
    s_waitcnt lgkmcnt(5)
    v_mfma_f32_16x16x32_bf16 v[168:171], v[120:123], v[72:75], v[168:171]
    v_mfma_f32_16x16x32_bf16 v[192:195], v[120:123], v[76:79], v[192:195]
    ds_read_b128 v[144:147], v3 offset:24576
    s_waitcnt lgkmcnt(5)
    v_mfma_f32_16x16x32_bf16 v[172:175], v[124:127], v[72:75], v[172:175]
    v_mfma_f32_16x16x32_bf16 v[196:199], v[124:127], v[76:79], v[196:199]
    ds_read_b128 v[148:151], v3 offset:25600
    s_waitcnt vmcnt(4)
    s_waitcnt lgkmcnt(5)
    v_mfma_f32_16x16x32_bf16 v[152:155], v[128:131], v[80:83], v[152:155]
    v_mfma_f32_16x16x32_bf16 v[176:179], v[128:131], v[84:87], v[176:179]
    s_barrier
    ds_read_b128 v[104:107], v3 offset:32768
    s_waitcnt lgkmcnt(5)
    v_mfma_f32_16x16x32_bf16 v[156:159], v[132:135], v[80:83], v[156:159]
    v_mfma_f32_16x16x32_bf16 v[180:183], v[132:135], v[84:87], v[180:183]
    ds_read_b128 v[108:111], v3 offset:33792
    s_waitcnt lgkmcnt(5)
    v_mfma_f32_16x16x32_bf16 v[160:163], v[136:139], v[80:83], v[160:163]
    v_mfma_f32_16x16x32_bf16 v[184:187], v[136:139], v[84:87], v[184:187]
    ds_read_b128 v[112:115], v3 offset:34816
    s_waitcnt lgkmcnt(5)
    v_mfma_f32_16x16x32_bf16 v[164:167], v[140:143], v[80:83], v[164:167]
    v_mfma_f32_16x16x32_bf16 v[188:191], v[140:143], v[84:87], v[188:191]
    ds_read_b128 v[116:119], v3 offset:35840
    s_waitcnt lgkmcnt(5)
    v_mfma_f32_16x16x32_bf16 v[168:171], v[144:147], v[80:83], v[168:171]
    v_mfma_f32_16x16x32_bf16 v[192:195], v[144:147], v[84:87], v[192:195]
    ds_read_b128 v[120:123], v3 offset:36864
    s_waitcnt lgkmcnt(5)
    v_mfma_f32_16x16x32_bf16 v[172:175], v[148:151], v[80:83], v[172:175]
    v_mfma_f32_16x16x32_bf16 v[196:199], v[148:151], v[84:87], v[196:199]
    ds_read_b128 v[124:127], v3 offset:37888
    s_waitcnt vmcnt(2)
    s_waitcnt lgkmcnt(5)
    v_mfma_f32_16x16x32_bf16 v[152:155], v[104:107], v[88:91], v[152:155]
    v_mfma_f32_16x16x32_bf16 v[176:179], v[104:107], v[92:95], v[176:179]
    ds_read_b128 v[128:131], v3 offset:45056
    s_waitcnt lgkmcnt(5)
    v_mfma_f32_16x16x32_bf16 v[156:159], v[108:111], v[88:91], v[156:159]
    v_mfma_f32_16x16x32_bf16 v[180:183], v[108:111], v[92:95], v[180:183]
    ds_read_b128 v[132:135], v3 offset:46080
    s_waitcnt lgkmcnt(5)
    v_mfma_f32_16x16x32_bf16 v[160:163], v[112:115], v[88:91], v[160:163]
    v_mfma_f32_16x16x32_bf16 v[184:187], v[112:115], v[92:95], v[184:187]
    ds_read_b128 v[136:139], v3 offset:47104
    s_waitcnt lgkmcnt(5)
    v_mfma_f32_16x16x32_bf16 v[164:167], v[116:119], v[88:91], v[164:167]
    v_mfma_f32_16x16x32_bf16 v[188:191], v[116:119], v[92:95], v[188:191]
    ds_read_b128 v[140:143], v3 offset:48128
    s_waitcnt lgkmcnt(5)
    v_mfma_f32_16x16x32_bf16 v[168:171], v[120:123], v[88:91], v[168:171]
    v_mfma_f32_16x16x32_bf16 v[192:195], v[120:123], v[92:95], v[192:195]
    ds_read_b128 v[144:147], v3 offset:49152
    s_waitcnt lgkmcnt(5)
    v_mfma_f32_16x16x32_bf16 v[172:175], v[124:127], v[88:91], v[172:175]
    v_mfma_f32_16x16x32_bf16 v[196:199], v[124:127], v[92:95], v[196:199]
    ds_read_b128 v[148:151], v3 offset:50176
    s_waitcnt vmcnt(0)
    s_waitcnt lgkmcnt(5)
    v_mfma_f32_16x16x32_bf16 v[152:155], v[128:131], v[96:99], v[152:155]
    v_mfma_f32_16x16x32_bf16 v[176:179], v[128:131], v[100:103], v[176:179]
    s_waitcnt lgkmcnt(4)
    v_mfma_f32_16x16x32_bf16 v[156:159], v[132:135], v[96:99], v[156:159]
    v_mfma_f32_16x16x32_bf16 v[180:183], v[132:135], v[100:103], v[180:183]
    s_waitcnt lgkmcnt(3)
    v_mfma_f32_16x16x32_bf16 v[160:163], v[136:139], v[96:99], v[160:163]
    v_mfma_f32_16x16x32_bf16 v[184:187], v[136:139], v[100:103], v[184:187]
    s_waitcnt lgkmcnt(2)
    v_mfma_f32_16x16x32_bf16 v[164:167], v[140:143], v[96:99], v[164:167]
    v_mfma_f32_16x16x32_bf16 v[188:191], v[140:143], v[100:103], v[188:191]
    s_waitcnt lgkmcnt(1)
    v_mfma_f32_16x16x32_bf16 v[168:171], v[144:147], v[96:99], v[168:171]
    v_mfma_f32_16x16x32_bf16 v[192:195], v[144:147], v[100:103], v[192:195]
    s_waitcnt lgkmcnt(0)
    v_mfma_f32_16x16x32_bf16 v[172:175], v[148:151], v[96:99], v[172:175]
    v_mfma_f32_16x16x32_bf16 v[196:199], v[148:151], v[100:103], v[196:199]
    s_mul_i32 s20, s3, 6144
    s_xor_b32 s21, s3, 2
    s_mul_i32 s21, s21, 6144
    s_add_u32 s20, s20, 139264
    s_add_u32 s21, s21, 139264
    v_add_u32 v2, s20, v1
    v_add_u32 v3, s21, v1
    s_cmp_eq_u32 s5, 0
    s_cbranch_scc1 main_kernel_kh0_0
    ds_write_b128 v2, v[152:155] offset:0
    ds_write_b128 v2, v[156:159] offset:1024
    ds_write_b128 v2, v[160:163] offset:2048
    ds_write_b128 v2, v[164:167] offset:3072
    ds_write_b128 v2, v[168:171] offset:4096
    ds_write_b128 v2, v[172:175] offset:5120
    s_nop 0
    v_pk_mov_b32 v[152:153], v[176:177], v[176:177] op_sel:[0,1]
    v_pk_mov_b32 v[154:155], v[178:179], v[178:179] op_sel:[0,1]
    v_pk_mov_b32 v[156:157], v[180:181], v[180:181] op_sel:[0,1]
    v_pk_mov_b32 v[158:159], v[182:183], v[182:183] op_sel:[0,1]
    v_pk_mov_b32 v[160:161], v[184:185], v[184:185] op_sel:[0,1]
    v_pk_mov_b32 v[162:163], v[186:187], v[186:187] op_sel:[0,1]
    v_pk_mov_b32 v[164:165], v[188:189], v[188:189] op_sel:[0,1]
    v_pk_mov_b32 v[166:167], v[190:191], v[190:191] op_sel:[0,1]
    v_pk_mov_b32 v[168:169], v[192:193], v[192:193] op_sel:[0,1]
    v_pk_mov_b32 v[170:171], v[194:195], v[194:195] op_sel:[0,1]
    v_pk_mov_b32 v[172:173], v[196:197], v[196:197] op_sel:[0,1]
    v_pk_mov_b32 v[174:175], v[198:199], v[198:199] op_sel:[0,1]
    s_branch main_kernel_red_0
main_kernel_kh0_0:
    ds_write_b128 v2, v[176:179] offset:0
    ds_write_b128 v2, v[180:183] offset:1024
    ds_write_b128 v2, v[184:187] offset:2048
    ds_write_b128 v2, v[188:191] offset:3072
    ds_write_b128 v2, v[192:195] offset:4096
    ds_write_b128 v2, v[196:199] offset:5120
main_kernel_red_0:
    s_waitcnt lgkmcnt(0)
    s_barrier
    ds_read_b128 v[176:179], v3 offset:0
    ds_read_b128 v[180:183], v3 offset:1024
    ds_read_b128 v[184:187], v3 offset:2048
    ds_read_b128 v[188:191], v3 offset:3072
    ds_read_b128 v[192:195], v3 offset:4096
    ds_read_b128 v[196:199], v3 offset:5120
    v_add_f32 v10, v12, v14
    v_add_f32 v12, v13, v15
    v_mov_b32 v11, v10
    s_nop 1
    v_permlane32_swap_b32 v10, v11
    s_nop 1
    v_add_f32 v10, v10, v11
    v_mov_b32 v13, v12
    s_nop 1
    v_permlane32_swap_b32 v12, v13
    s_nop 1
    v_add_f32 v12, v12, v13
    v_mov_b32 v11, v10
    s_nop 1
    v_permlane16_swap_b32 v10, v11
    s_nop 1
    v_add_f32 v10, v10, v11
    v_mov_b32 v13, v12
    s_nop 1
    v_permlane16_swap_b32 v12, v13
    s_nop 1
    v_add_f32 v12, v12, v13
    v_mul_f32 v10, 0x3acccccd, v10
    v_mul_f32 v12, 0x3acccccd, v12
    v_fma_f32 v12, -v10, v10, v12
    v_add_f32 v12, 0x3727c5ac, v12
    v_rsq_f32 v12, v12
    s_mov_b32 s28, 252314624
    s_mov_b32 s29, 606018068
    s_lshl_b32 s26, s51, 3
    s_lshr_b64 s[28:29], s[28:29], s26
    s_and_b32 s28, s28, 0xff
    s_lshl_b32 s28, s28, 9
    s_mul_i32 s24, s4, 20480
    s_add_u32 s24, s24, s28
    s_add_u32 s24, s24, 20970496
    v_mul_f32 v10, 0x3ea52b5c, v12
    v_mov_b32 v13, v12
    v_mov_b32 v11, v10
    s_waitcnt lgkmcnt(0)
    v_pk_add_f32 v[152:153], v[152:153], v[176:177]
    v_pk_add_f32 v[154:155], v[154:155], v[178:179]
    v_pk_add_f32 v[156:157], v[156:157], v[180:181]
    v_pk_add_f32 v[158:159], v[158:159], v[182:183]
    v_pk_add_f32 v[160:161], v[160:161], v[184:185]
    v_pk_add_f32 v[162:163], v[162:163], v[186:187]
    v_pk_add_f32 v[164:165], v[164:165], v[188:189]
    v_pk_add_f32 v[166:167], v[166:167], v[190:191]
    v_pk_add_f32 v[168:169], v[168:169], v[192:193]
    v_pk_add_f32 v[170:171], v[170:171], v[194:195]
    v_pk_add_f32 v[172:173], v[172:173], v[196:197]
    v_pk_add_f32 v[174:175], v[174:175], v[198:199]
    s_cmp_lt_u32 s51, 2
    s_cbranch_scc1 main_kernel_kv0
    v_pk_mul_f32 v[152:153], v[152:153], v[10:11]
    v_pk_mul_f32 v[154:155], v[154:155], v[10:11]
    v_cvt_pk_bf16_f32 v104, v152, v153
    v_cvt_pk_bf16_f32 v105, v154, v155
    v_pk_mul_f32 v[156:157], v[156:157], v[10:11]
    v_pk_mul_f32 v[158:159], v[158:159], v[10:11]
    v_cvt_pk_bf16_f32 v106, v156, v157
    v_cvt_pk_bf16_f32 v107, v158, v159
    s_nop 1
    v_permlane16_swap_b32 v104, v106
    v_permlane16_swap_b32 v105, v107
    buffer_store_dwordx4 v[104:107], v9, s[8:11], s24 offen offset:0 sc1
    s_branch main_kernel_qrest0
main_kernel_kv0:
    v_pk_mul_f32 v[152:153], v[152:153], v[12:13]
    v_pk_mul_f32 v[154:155], v[154:155], v[12:13]
    v_pk_mul_f32 v[156:157], v[156:157], v[12:13]
    v_pk_mul_f32 v[158:159], v[158:159], v[12:13]
    s_lshr_b32 s26, s4, 1
    s_mul_i32 s26, s26, 2560
    s_add_u32 s26, s26, 46137344
    s_and_b32 s25, s4, 1
    v_cvt_pk_bf16_f32 v104, v152, v153
    v_cvt_pk_bf16_f32 v105, v154, v155
    v_cvt_pk_bf16_f32 v106, v156, v157
    v_cvt_pk_bf16_f32 v107, v158, v159
    s_cmp_eq_u32 s51, 1
    s_cbranch_scc1 main_kernel_v0
    s_lshl_b32 s25, s25, 4
    v_add_u32 v14, s25, v6
    v_lshrrev_b32 v15, 1, v7
    v_lshlrev_b32 v15, 9, v15
    v_lshl_add_u32 v15, v14, 4, v15
    v_and_b32 v16, 1, v7
    v_lshl_add_u32 v15, v16, 3, v15
    v_lshlrev_b32 v16, 3, v14
    v_add_u32 v15, s21, v15
    v_add_u32 v16, s21, v16
    ds_write_b64 v15, v[104:105]
    s_mov_b64 exec, 0xffff
    ds_write_b64 v16, v[106:107] offset:1024
    s_mov_b64 exec, -1
    v_lshlrev_b32 v15, 9, v7
    v_lshl_add_u32 v15, v6, 4, v15
    s_lshl_b32 s27, s25, 4
    s_lshl_b32 s25, s25, 3
    v_mov_b32 v16, s27
    s_mov_b32 exec_lo, 0
    v_mov_b32 v16, s25
    s_mov_b32 exec_lo, -1
    v_add_u32 v15, v15, v16
    v_add_u32 v16, s21, v15
    s_waitcnt lgkmcnt(0)
    ds_read_b128 v[20:23], v16
    v_mul_f32 v17, v152, v152
    v_fmac_f32 v17, v153, v153
    v_fmac_f32 v17, v154, v154
    v_fmac_f32 v17, v155, v155
    v_fmac_f32 v17, v156, v156
    v_fmac_f32 v17, v157, v157
    v_fmac_f32 v17, v158, v158
    v_fmac_f32 v17, v159, v159
    v_mov_b32 v18, v17
    s_nop 1
    v_permlane32_swap_b32 v17, v18
    s_nop 1
    v_add_f32 v17, v17, v18
    v_mov_b32 v18, v17
    s_nop 1
    v_permlane16_swap_b32 v17, v18
    s_nop 1
    v_add_f32 v17, v17, v18
    s_nop 1
    v_max_f32_dpp v17, v17, v17 row_ror:8 row_mask:0xf bank_mask:0xf
    s_nop 1
    v_max_f32_dpp v17, v17, v17 row_ror:4 row_mask:0xf bank_mask:0xf
    s_nop 1
    v_max_f32_dpp v17, v17, v17 row_ror:2 row_mask:0xf bank_mask:0xf
    s_nop 1
    v_max_f32_dpp v17, v17, v17 row_ror:1 row_mask:0xf bank_mask:0xf
    s_mov_b32 exec_hi, 0xff
    s_waitcnt lgkmcnt(0)
    buffer_store_dwordx4 v[20:23], v15, s[8:11], s26 offen sc1
    s_mov_b64 exec, 1
    s_lshl_b32 s25, s4, 2
    s_add_u32 s25, s25, 46661632
    buffer_store_dword v17, off, s[8:11], s25 sc1
    s_mov_b64 exec, -1
    s_branch main_kernel_qrest0
main_kernel_v0:
    s_mul_i32 s25, s25, 640
    s_add_u32 s26, s26, s25
    v_lshrrev_b32 v14, 2, v6
    v_and_b32 v15, 1, v14
    v_mul_u32_u24 v15, 320, v15
    v_lshrrev_b32 v14, 1, v14
    v_lshl_add_u32 v15, v14, 3, v15
    v_and_b32 v14, 3, v6
    v_lshl_add_u32 v15, v14, 1, v15
    v_lshl_add_u32 v15, v7, 6, v15
    v_add_u32 v15, s21, v15
    ds_write_b16 v15, v104 offset:0
    ds_write_b16_d16_hi v15, v104 offset:16
    ds_write_b16 v15, v105 offset:32
    ds_write_b16_d16_hi v15, v105 offset:48
    s_mov_b64 exec, 0xffff
    ds_write_b16 v15, v106 offset:256
    ds_write_b16_d16_hi v15, v106 offset:272
    ds_write_b16 v15, v107 offset:288
    ds_write_b16_d16_hi v15, v107 offset:304
    s_mov_b64 exec, -1
    s_waitcnt lgkmcnt(0)
    ds_read_b128 v[20:23], v3
    s_mov_b32 exec_hi, 0xff
    s_waitcnt lgkmcnt(0)
    buffer_store_dwordx4 v[20:23], v1, s[8:11], s26 offen offset:1280 sc1
    s_mov_b32 exec_hi, -1
main_kernel_qrest0:
    v_pk_mul_f32 v[160:161], v[160:161], v[10:11]
    v_pk_mul_f32 v[162:163], v[162:163], v[10:11]
    v_cvt_pk_bf16_f32 v108, v160, v161
    v_cvt_pk_bf16_f32 v109, v162, v163
    v_pk_mul_f32 v[164:165], v[164:165], v[10:11]
    v_pk_mul_f32 v[166:167], v[166:167], v[10:11]
    v_cvt_pk_bf16_f32 v110, v164, v165
    v_cvt_pk_bf16_f32 v111, v166, v167
    s_nop 1
    v_permlane16_swap_b32 v108, v110
    v_permlane16_swap_b32 v109, v111
    buffer_store_dwordx4 v[108:111], v9, s[8:11], s24 offen offset:1024 sc1
    v_pk_mul_f32 v[168:169], v[168:169], v[10:11]
    v_pk_mul_f32 v[170:171], v[170:171], v[10:11]
    v_cvt_pk_bf16_f32 v112, v168, v169
    v_cvt_pk_bf16_f32 v113, v170, v171
    v_pk_mul_f32 v[172:173], v[172:173], v[10:11]
    v_pk_mul_f32 v[174:175], v[174:175], v[10:11]
    v_cvt_pk_bf16_f32 v114, v172, v173
    v_cvt_pk_bf16_f32 v115, v174, v175
    s_nop 1
    v_permlane16_swap_b32 v112, v114
    v_permlane16_swap_b32 v113, v115
    buffer_store_dwordx4 v[112:115], v9, s[8:11], s24 offen offset:2048 sc1
    s_waitcnt vmcnt(0)
    s_barrier
    s_cmp_lg_u32 s3, 0
    s_cbranch_scc1 main_kernel_sig0
    s_add_u32 s44, s52, 48234496
    v_mov_b32 v246, 1
    s_cmp_ge_u32 s51, 2
    s_cbranch_scc1 main_kernel_sig0q
    s_lshl_b32 s45, s50, 1
    s_add_u32 s45, s45, s51
    s_lshl_b32 s45, s45, 2
    s_add_u32 s45, s45, 48242688
    v_lshlrev_b32 v247, 8, v0
    s_mov_b64 exec, 0xffff
    buffer_store_dword v246, v247, s[8:11], s45 offen sc1
main_kernel_sig0q:
    s_mov_b64 exec, 1
    buffer_store_dword v246, off, s[8:11], s44 sc1
main_kernel_sig0e:
    s_mov_b64 exec, -1
main_kernel_sig0:
main_kernel_j0:
    v_mov_b32 v241, 0x20000
    ds_read_b32 v242, v241
    s_waitcnt lgkmcnt(0)
    v_readfirstlane_b32 s85, v242
    s_lshr_b32 s84, s85, 8
    s_and_b32 s85, s85, 255
    s_and_b32 s4, s85, 7
    s_lshr_b32 s5, s85, 3
    s_lshr_b32 s6, s5, 3
    s_and_b32 s51, s5, 7
    s_lshl_b32 s50, s4, 2
    s_add_u32 s50, s50, s6
    s_lshr_b32 s59, s50, 1
    s_lshl_b32 s59, s59, 8
    s_and_b32 s52, s50, 1
    s_lshl_b32 s52, s52, 5
    s_add_u32 s59, s59, s52
    s_lshl_b32 s52, s51, 2
    s_add_u32 s52, s52, s59
    s_lshr_b32 s53, s4, 1
    s_lshl_b32 s53, s53, 2
    s_add_u32 s53, s53, s6
    s_and_b32 s54, s4, 1
    s_lshl_b32 s54, s54, 3
    s_add_u32 s54, s54, s51
    s_lshl_b32 s55, s53, 6
    s_add_u32 s55, s55, s54
    s_lshl_b32 s55, s55, 2
    s_lshl_b32 s56, s4, 3
    s_lshr_b32 s7, s5, 2
    s_add_u32 s56, s56, s7
    s_and_b32 s57, s5, 3
    s_and_b32 s58, s56, 3
    s_lshl_b32 s58, s58, 2
    s_add_u32 s58, s58, s57
    s_lshl_b32 s58, s58, 2
    s_lshr_b32 s7, s56, 2
    s_lshl_b32 s7, s7, 8
    s_add_u32 s58, s58, s7
    s_lshr_b32 s53, s50, 1
    s_and_b32 s54, s5, 15
    s_lshl_b32 s55, s53, 6
    s_add_u32 s55, s55, s54
    s_lshl_b32 s55, s55, 2
    v_lshlrev_b32 v1, 4, v0
    s_mov_b32 s4, s56
    s_lshl_b32 s5, s57, 3
    s_add_u32 s5, s5, s3
    s_lshl_b32 s20, s3, 10
    s_add_u32 s21, s20, 46137344
    v_and_b32 v7, 31, v0
    v_lshrrev_b32 v8, 5, v0
    s_mul_i32 s6, s5, 5
    s_mul_i32 s22, s4, 40960
    v_lshrrev_b32 v9, 4, v7
    v_mul_u32_u24 v9, 20480, v9
    v_and_b32 v10, 15, v0
    v_lshl_add_u32 v9, v10, 4, v9
    v_lshl_add_u32 v10, v8, 1, s6
    v_lshrrev_b32 v11, 1, v10
    v_lshl_add_u32 v4, v11, 8, v9
    v_and_b32 v11, 1, v10
    v_lshl_add_u32 v4, v11, 3, v4
    v_add_u32 v10, 1, v10
    v_lshrrev_b32 v11, 1, v10
    v_lshl_add_u32 v5, v11, 8, v9
    v_and_b32 v11, 1, v10
    v_lshl_add_u32 v5, v11, 3, v5
    v_add_u32 v10, 4, v8
    v_add_u32 v10, s6, v10
    v_lshrrev_b32 v11, 1, v10
    v_lshl_add_u32 v6, v11, 8, v9
    v_and_b32 v11, 1, v10
    v_lshl_add_u32 v6, v11, 3, v6
    v_mov_b32 v12, 0x7fff0000
    v_cmp_eq_u32 vcc, 0, v8
    s_add_u32 s23, s22, 20971520
    s_mov_b32 s24, 46661632
    v_cndmask_b32 v6, v12, v6, vcc
    v_lshlrev_b32 v13, 3, v0
    s_and_b32 s26, s85, 15
    s_lshl_b32 s26, s26, 8
    s_add_u32 s26, s26, 0x2000
    s_andn2_b32 s27, s58, 31
    s_cmp_lg_u32 s3, 0
    s_cbranch_scc1 main_kernel_poll1p
    v_lshlrev_b32 v250, 2, v0
    s_mov_b32 s45, 0x200000
    s_add_u32 s44, s27, 48234496
    s_mov_b64 exec, 255
main_kernel_poll1_0:
    buffer_load_dword v246, v250, s[8:11], s44 offen sc1
    s_waitcnt vmcnt(0)
    v_cmp_ne_u32 vcc, 1, v246
    s_sub_u32 s45, s45, 1
    s_cbranch_scc1 main_kernel_poll1d
    s_cmp_eq_u64 vcc, 0
    s_cbranch_scc0 main_kernel_poll1_0
    s_mov_b64 exec, -1
    s_add_u32 s44, s26, 48234496
main_kernel_poll1_1:
    buffer_load_dword v246, v250, s[8:11], s44 offen sc1
    s_waitcnt vmcnt(0)
    v_cmp_ne_u32 vcc, 1, v246
    s_sub_u32 s45, s45, 1
    s_cbranch_scc1 main_kernel_poll1d
    s_cmp_eq_u64 vcc, 0
    s_cbranch_scc0 main_kernel_poll1_1
main_kernel_poll1d:
    s_mov_b64 exec, -1
    s_cmp_eq_u32 s84, 0
    s_cbranch_scc1 main_kernel_poll1p
    buffer_inv sc1
    s_waitcnt vmcnt(0)
main_kernel_poll1p:
    s_barrier
    buffer_load_dwordx2 v[88:89], v4, s[8:11], s23 offen sc1
    buffer_load_dwordx2 v[90:91], v5, s[8:11], s23 offen sc1
    buffer_load_dwordx2 v[92:93], v6, s[8:11], s23 offen sc1
    buffer_load_dwordx2 v[14:15], v13, s[8:11], s24 offen sc1
    v_mov_b32 v124, v1
    s_add_u32 m0, s20, 0
    s_add_u32 s25, s21, 0
    buffer_load_dwordx4 v124, s[8:11], s25 offen sc1 lds
    s_add_u32 m0, s20, 8192
    s_add_u32 s25, s21, 8192
    buffer_load_dwordx4 v124, s[8:11], s25 offen sc1 lds
    s_add_u32 m0, s20, 16384
    s_add_u32 s25, s21, 16384
    buffer_load_dwordx4 v124, s[8:11], s25 offen sc1 lds
    s_add_u32 m0, s20, 24576
    s_add_u32 s25, s21, 24576
    buffer_load_dwordx4 v124, s[8:11], s25 offen sc1 lds
    v_add_u32 v10, s6, v8
    v_lshrrev_b32 v11, 1, v10
    v_lshl_add_u32 v4, v11, 8, v9
    v_and_b32 v11, 1, v10
    v_lshl_add_u32 v4, v11, 3, v4
    v_add_u32 v5, 256, v4
    v_lshlrev_b32 v2, 3, v7
    v_mul_u32_u24 v3, 320, v8
    v_lshl_add_u32 v3, v7, 4, v3
    s_mov_b32 s30, 0x000fffff
    s_mov_b32 s31, 0x000fffff
    v_and_b32 v10, 27, v7
    v_cmp_eq_u32 vcc, 24, v10
    v_mov_b32 v11, 0x3f803f80
    s_nop 0
    v_cndmask_b32 v11, 0, v11, vcc
    v_mov_b32 v128, v11
    v_mov_b32 v129, v11
    v_mov_b32 v130, v11
    v_mov_b32 v131, v11
    v_mov_b32 v132, v11
    v_mov_b32 v133, v11
    v_mov_b32 v134, v11
    v_mov_b32 v135, v11
    v_mov_b32 v136, v11
    v_mov_b32 v137, v11
    v_mov_b32 v138, v11
    v_mov_b32 v139, v11
    v_mov_b32 v140, v11
    v_mov_b32 v141, v11
    v_mov_b32 v142, v11
    v_mov_b32 v143, v11
    v_mov_b32 v144, v11
    v_mov_b32 v145, v11
    v_mov_b32 v146, v11
    v_mov_b32 v147, v11
    v_mov_b32 v148, v11
    v_mov_b32 v149, v11
    v_mov_b32 v150, v11
    v_mov_b32 v151, v11
    v_mov_b32 v152, v11
    v_mov_b32 v153, v11
    v_mov_b32 v154, v11
    v_mov_b32 v155, v11
    v_mov_b32 v156, v11
    v_mov_b32 v157, v11
    v_mov_b32 v158, v11
    v_mov_b32 v159, v11
    s_waitcnt vmcnt(4)
    v_max_f32 v14, v14, v15
    v_mov_b32 v10, 0
    v_dot2_f32_bf16 v10, v88, v88, v10
    v_dot2_f32_bf16 v10, v89, v89, v10
    v_dot2_f32_bf16 v10, v90, v90, v10
    v_dot2_f32_bf16 v10, v91, v91, v10
    v_dot2_f32_bf16 v10, v92, v92, v10
    v_dot2_f32_bf16 v10, v93, v93, v10
    v_mov_b32 v15, v14
    s_nop 1
    v_permlane32_swap_b32 v14, v15
    s_nop 1
    v_max_f32 v14, v14, v15
    v_mov_b32 v15, v14
    s_nop 1
    v_permlane16_swap_b32 v14, v15
    s_nop 1
    v_max_f32 v14, v14, v15
    s_nop 1
    v_max_f32_dpp v14, v14, v14 row_ror:8 row_mask:0xf bank_mask:0xf
    s_nop 1
    v_max_f32_dpp v14, v14, v14 row_ror:4 row_mask:0xf bank_mask:0xf
    s_nop 1
    v_max_f32_dpp v14, v14, v14 row_ror:2 row_mask:0xf bank_mask:0xf
    s_nop 1
    v_max_f32_dpp v14, v14, v14 row_ror:1 row_mask:0xf bank_mask:0xf
    v_mov_b32 v11, v10
    s_nop 1
    v_permlane32_swap_b32 v10, v11
    s_nop 1
    v_add_f32 v10, v10, v11
    v_mul_f32 v10, v10, v14
    v_sqrt_f32 v10, v10
    s_mov_b32 s28, 0
    v_mul_f32 v10, 0xbf828f5c, v10
    s_waitcnt vmcnt(0)
    s_barrier
main_kernel_at0restart:
    v_mov_b32 v64, v10
    v_mov_b32 v48, 0
    v_mov_b32 v65, v10
    v_mov_b32 v49, 0
    v_mov_b32 v66, v10
    v_mov_b32 v50, 0
    v_mov_b32 v67, v10
    v_mov_b32 v51, 0
    v_mov_b32 v68, v10
    v_mov_b32 v52, 0
    v_mov_b32 v69, v10
    v_mov_b32 v53, 0
    v_mov_b32 v70, v10
    v_mov_b32 v54, 0
    v_mov_b32 v71, v10
    v_mov_b32 v55, 0
    v_mov_b32 v72, v10
    v_mov_b32 v56, 0
    v_mov_b32 v73, v10
    v_mov_b32 v57, 0
    v_mov_b32 v74, v10
    v_mov_b32 v58, 0
    v_mov_b32 v75, v10
    v_mov_b32 v59, 0
    v_mov_b32 v76, v10
    v_mov_b32 v60, 0
    v_mov_b32 v77, v10
    v_mov_b32 v61, 0
    v_mov_b32 v78, v10
    v_mov_b32 v62, 0
    v_mov_b32 v79, v10
    v_mov_b32 v63, 0
    ds_read_b128 v[96:99], v1 offset:0
    ds_read_b64 v[100:101], v2 offset:1024
    ds_read_b128 v[102:105], v1 offset:2560
    ds_read_b64 v[106:107], v2 offset:3584
    s_mov_b64 exec, s[30:31]
    ds_read_b128 v[128:131], v3 offset:1280
    ds_read_b128 v[132:135], v3 offset:1920
    s_mov_b64 exec, -1
    v_mov_b32 v84, 0
    v_mov_b32 v85, 0
    v_mov_b32 v86, 0
    v_mov_b32 v87, 0
    s_waitcnt lgkmcnt(4)
    v_mfma_f32_32x32x16_bf16 v[16:31], v[96:99], v[88:91], v[64:79]
    v_mfma_f32_32x32x8_bf16 v[16:31], v[100:101], v[92:93], v[16:31]
    s_mov_b32 s29, 0
    s_add_u32 s26, s20, 32768
    s_add_u32 s25, s21, 32768
    s_nop 7
    s_nop 1
    s_cmp_lg_u32 s28, 0
    s_cbranch_scc1 main_kernel_at0loop
main_kernel_at0loopa:
    s_setprio 3
    s_waitcnt lgkmcnt(0)
    v_mfma_f32_32x32x16_bf16 v[32:47], v[102:105], v[88:91], v[64:79]
    ds_read_b128 v[96:99], v1 offset:5120
    ds_read_b64 v[100:101], v2 offset:6144
    s_mov_b64 exec, s[30:31]
    ds_read_b128 v[136:139], v3 offset:3840
    ds_read_b128 v[140:143], v3 offset:4480
    s_mov_b64 exec, -1
    v_exp_f32 v16, v16
    v_exp_f32 v17, v17
    v_exp_f32 v18, v18
    v_exp_f32 v19, v19
    v_exp_f32 v20, v20
    v_mfma_f32_32x32x16_bf16 v[48:63], v[156:159], v[84:87], v[48:63]
    s_mov_b32 m0, s26
    s_add_u32 s26, s26, 8192
    buffer_load_dwordx4 v124, s[8:11], s25 offen sc1 lds
    s_add_u32 s25, s25, 8192
    v_exp_f32 v21, v21
    v_exp_f32 v22, v22
    v_exp_f32 v23, v23
    v_cvt_pk_bf16_f32 v80, v16, v17
    v_cvt_pk_bf16_f32 v81, v18, v19
    v_cvt_pk_bf16_f32 v82, v20, v21
    v_cvt_pk_bf16_f32 v83, v22, v23
    v_mfma_f32_32x32x8_bf16 v[32:47], v[106:107], v[92:93], v[32:47]
    v_exp_f32 v24, v24
    v_exp_f32 v25, v25
    v_exp_f32 v26, v26
    v_exp_f32 v27, v27
    v_exp_f32 v28, v28
    v_mfma_f32_32x32x16_bf16 v[48:63], v[128:131], v[80:83], v[48:63]
    v_exp_f32 v29, v29
    v_exp_f32 v30, v30
    v_exp_f32 v31, v31
    v_cvt_pk_bf16_f32 v84, v24, v25
    v_cvt_pk_bf16_f32 v85, v26, v27
    v_cvt_pk_bf16_f32 v86, v28, v29
    v_cvt_pk_bf16_f32 v87, v30, v31
    s_waitcnt lgkmcnt(0)
    v_mfma_f32_32x32x16_bf16 v[16:31], v[96:99], v[88:91], v[64:79]
    ds_read_b128 v[102:105], v1 offset:7680
    ds_read_b64 v[106:107], v2 offset:8704
    s_mov_b64 exec, s[30:31]
    ds_read_b128 v[144:147], v3 offset:6400
    ds_read_b128 v[148:151], v3 offset:7040
    s_mov_b64 exec, -1
    v_exp_f32 v32, v32
    v_exp_f32 v33, v33
    v_exp_f32 v34, v34
    v_exp_f32 v35, v35
    v_exp_f32 v36, v36
    v_mfma_f32_32x32x16_bf16 v[48:63], v[132:135], v[84:87], v[48:63]
    s_mov_b32 m0, s26
    s_add_u32 s26, s26, 8192
    buffer_load_dwordx4 v124, s[8:11], s25 offen sc1 lds
    s_add_u32 s25, s25, 8192
    v_exp_f32 v37, v37
    v_exp_f32 v38, v38
    v_exp_f32 v39, v39
    v_cvt_pk_bf16_f32 v80, v32, v33
    v_cvt_pk_bf16_f32 v81, v34, v35
    v_cvt_pk_bf16_f32 v82, v36, v37
    v_cvt_pk_bf16_f32 v83, v38, v39
    v_mfma_f32_32x32x8_bf16 v[16:31], v[100:101], v[92:93], v[16:31]
    v_exp_f32 v40, v40
    v_exp_f32 v41, v41
    v_exp_f32 v42, v42
    v_exp_f32 v43, v43
    v_exp_f32 v44, v44
    v_mfma_f32_32x32x16_bf16 v[48:63], v[136:139], v[80:83], v[48:63]
    v_exp_f32 v45, v45
    v_exp_f32 v46, v46
    v_exp_f32 v47, v47
    v_cvt_pk_bf16_f32 v84, v40, v41
    v_cvt_pk_bf16_f32 v85, v42, v43
    v_cvt_pk_bf16_f32 v86, v44, v45
    v_cvt_pk_bf16_f32 v87, v46, v47
    s_setprio 2
    s_waitcnt lgkmcnt(0)
    v_mfma_f32_32x32x16_bf16 v[32:47], v[102:105], v[88:91], v[64:79]
    ds_read_b128 v[96:99], v1 offset:10240
    ds_read_b64 v[100:101], v2 offset:11264
    s_mov_b64 exec, s[30:31]
    ds_read_b128 v[152:155], v3 offset:8960
    ds_read_b128 v[156:159], v3 offset:9600
    s_mov_b64 exec, -1
    v_exp_f32 v16, v16
    v_exp_f32 v17, v17
    v_exp_f32 v18, v18
    v_exp_f32 v19, v19
    v_exp_f32 v20, v20
    v_mfma_f32_32x32x16_bf16 v[48:63], v[140:143], v[84:87], v[48:63]
    s_mov_b32 m0, s26
    s_add_u32 s26, s26, 8192
    buffer_load_dwordx4 v124, s[8:11], s25 offen sc1 lds
    s_add_u32 s25, s25, 8192
    v_exp_f32 v21, v21
    v_exp_f32 v22, v22
    v_exp_f32 v23, v23
    v_cvt_pk_bf16_f32 v80, v16, v17
    v_cvt_pk_bf16_f32 v81, v18, v19
    v_cvt_pk_bf16_f32 v82, v20, v21
    v_cvt_pk_bf16_f32 v83, v22, v23
    v_mfma_f32_32x32x8_bf16 v[32:47], v[106:107], v[92:93], v[32:47]
    v_exp_f32 v24, v24
    v_exp_f32 v25, v25
    v_exp_f32 v26, v26
    v_exp_f32 v27, v27
    v_exp_f32 v28, v28
    v_mfma_f32_32x32x16_bf16 v[48:63], v[144:147], v[80:83], v[48:63]
    v_exp_f32 v29, v29
    v_exp_f32 v30, v30
    v_exp_f32 v31, v31
    v_cvt_pk_bf16_f32 v84, v24, v25
    v_cvt_pk_bf16_f32 v85, v26, v27
    v_cvt_pk_bf16_f32 v86, v28, v29
    v_cvt_pk_bf16_f32 v87, v30, v31
    s_waitcnt lgkmcnt(0)
    v_mfma_f32_32x32x16_bf16 v[16:31], v[96:99], v[88:91], v[64:79]
    ds_read_b128 v[102:105], v1 offset:12800
    ds_read_b64 v[106:107], v2 offset:13824
    s_mov_b64 exec, s[30:31]
    ds_read_b128 v[128:131], v3 offset:11520
    ds_read_b128 v[132:135], v3 offset:12160
    s_mov_b64 exec, -1
    v_exp_f32 v32, v32
    v_exp_f32 v33, v33
    v_exp_f32 v34, v34
    v_exp_f32 v35, v35
    v_exp_f32 v36, v36
    v_mfma_f32_32x32x16_bf16 v[48:63], v[148:151], v[84:87], v[48:63]
    s_mov_b32 m0, s26
    s_add_u32 s26, s26, 8192
    buffer_load_dwordx4 v124, s[8:11], s25 offen sc1 lds
    s_add_u32 s25, s25, 8192
    v_exp_f32 v37, v37
    v_exp_f32 v38, v38
    v_exp_f32 v39, v39
    v_cvt_pk_bf16_f32 v80, v32, v33
    v_cvt_pk_bf16_f32 v81, v34, v35
    v_cvt_pk_bf16_f32 v82, v36, v37
    v_cvt_pk_bf16_f32 v83, v38, v39
    v_mfma_f32_32x32x8_bf16 v[16:31], v[100:101], v[92:93], v[16:31]
    v_exp_f32 v40, v40
    v_exp_f32 v41, v41
    v_exp_f32 v42, v42
    v_exp_f32 v43, v43
    v_exp_f32 v44, v44
    v_mfma_f32_32x32x16_bf16 v[48:63], v[152:155], v[80:83], v[48:63]
    v_exp_f32 v45, v45
    v_exp_f32 v46, v46
    v_exp_f32 v47, v47
    v_cvt_pk_bf16_f32 v84, v40, v41
    v_cvt_pk_bf16_f32 v85, v42, v43
    v_cvt_pk_bf16_f32 v86, v44, v45
    v_cvt_pk_bf16_f32 v87, v46, v47
    s_setprio 1
    s_waitcnt lgkmcnt(0)
    v_mfma_f32_32x32x16_bf16 v[32:47], v[102:105], v[88:91], v[64:79]
    ds_read_b128 v[96:99], v1 offset:15360
    ds_read_b64 v[100:101], v2 offset:16384
    s_mov_b64 exec, s[30:31]
    ds_read_b128 v[136:139], v3 offset:14080
    ds_read_b128 v[140:143], v3 offset:14720
    s_mov_b64 exec, -1
    v_exp_f32 v16, v16
    v_exp_f32 v17, v17
    v_exp_f32 v18, v18
    v_exp_f32 v19, v19
    v_exp_f32 v20, v20
    v_mfma_f32_32x32x16_bf16 v[48:63], v[156:159], v[84:87], v[48:63]
    v_exp_f32 v21, v21
    v_exp_f32 v22, v22
    v_exp_f32 v23, v23
    v_cvt_pk_bf16_f32 v80, v16, v17
    v_cvt_pk_bf16_f32 v81, v18, v19
    v_cvt_pk_bf16_f32 v82, v20, v21
    v_cvt_pk_bf16_f32 v83, v22, v23
    v_mfma_f32_32x32x8_bf16 v[32:47], v[106:107], v[92:93], v[32:47]
    v_exp_f32 v24, v24
    v_exp_f32 v25, v25
    v_exp_f32 v26, v26
    v_exp_f32 v27, v27
    v_exp_f32 v28, v28
    v_mfma_f32_32x32x16_bf16 v[48:63], v[128:131], v[80:83], v[48:63]
    v_exp_f32 v29, v29
    v_exp_f32 v30, v30
    v_exp_f32 v31, v31
    v_cvt_pk_bf16_f32 v84, v24, v25
    v_cvt_pk_bf16_f32 v85, v26, v27
    v_cvt_pk_bf16_f32 v86, v28, v29
    v_cvt_pk_bf16_f32 v87, v30, v31
    s_waitcnt lgkmcnt(0)
    v_mfma_f32_32x32x16_bf16 v[16:31], v[96:99], v[88:91], v[64:79]
    ds_read_b128 v[102:105], v1 offset:17920
    ds_read_b64 v[106:107], v2 offset:18944
    s_mov_b64 exec, s[30:31]
    ds_read_b128 v[144:147], v3 offset:16640
    ds_read_b128 v[148:151], v3 offset:17280
    s_mov_b64 exec, -1
    v_exp_f32 v32, v32
    v_exp_f32 v33, v33
    v_exp_f32 v34, v34
    v_exp_f32 v35, v35
    v_exp_f32 v36, v36
    v_mfma_f32_32x32x16_bf16 v[48:63], v[132:135], v[84:87], v[48:63]
    v_exp_f32 v37, v37
    v_exp_f32 v38, v38
    v_exp_f32 v39, v39
    v_cvt_pk_bf16_f32 v80, v32, v33
    v_cvt_pk_bf16_f32 v81, v34, v35
    v_cvt_pk_bf16_f32 v82, v36, v37
    v_cvt_pk_bf16_f32 v83, v38, v39
    v_mfma_f32_32x32x8_bf16 v[16:31], v[100:101], v[92:93], v[16:31]
    v_exp_f32 v40, v40
    v_exp_f32 v41, v41
    v_exp_f32 v42, v42
    v_exp_f32 v43, v43
    v_exp_f32 v44, v44
    v_mfma_f32_32x32x16_bf16 v[48:63], v[136:139], v[80:83], v[48:63]
    v_exp_f32 v45, v45
    v_exp_f32 v46, v46
    v_exp_f32 v47, v47
    v_cvt_pk_bf16_f32 v84, v40, v41
    v_cvt_pk_bf16_f32 v85, v42, v43
    v_cvt_pk_bf16_f32 v86, v44, v45
    v_cvt_pk_bf16_f32 v87, v46, v47
    s_setprio 0
    s_waitcnt lgkmcnt(0)
    v_mfma_f32_32x32x16_bf16 v[32:47], v[102:105], v[88:91], v[64:79]
    ds_read_b128 v[96:99], v1 offset:20480
    ds_read_b64 v[100:101], v2 offset:21504
    s_mov_b64 exec, s[30:31]
    ds_read_b128 v[152:155], v3 offset:19200
    ds_read_b128 v[156:159], v3 offset:19840
    s_mov_b64 exec, -1
    v_exp_f32 v16, v16
    v_exp_f32 v17, v17
    v_exp_f32 v18, v18
    v_exp_f32 v19, v19
    v_exp_f32 v20, v20
    v_mfma_f32_32x32x16_bf16 v[48:63], v[140:143], v[84:87], v[48:63]
    v_exp_f32 v21, v21
    v_exp_f32 v22, v22
    v_exp_f32 v23, v23
    v_cvt_pk_bf16_f32 v80, v16, v17
    v_cvt_pk_bf16_f32 v81, v18, v19
    v_cvt_pk_bf16_f32 v82, v20, v21
    v_cvt_pk_bf16_f32 v83, v22, v23
    v_mfma_f32_32x32x8_bf16 v[32:47], v[106:107], v[92:93], v[32:47]
    v_exp_f32 v24, v24
    v_exp_f32 v25, v25
    v_exp_f32 v26, v26
    v_exp_f32 v27, v27
    v_exp_f32 v28, v28
    v_mfma_f32_32x32x16_bf16 v[48:63], v[144:147], v[80:83], v[48:63]
    v_exp_f32 v29, v29
    v_exp_f32 v30, v30
    v_exp_f32 v31, v31
    v_cvt_pk_bf16_f32 v84, v24, v25
    v_cvt_pk_bf16_f32 v85, v26, v27
    v_cvt_pk_bf16_f32 v86, v28, v29
    v_cvt_pk_bf16_f32 v87, v30, v31
    s_waitcnt lgkmcnt(0)
    v_mfma_f32_32x32x16_bf16 v[16:31], v[96:99], v[88:91], v[64:79]
    ds_read_b128 v[102:105], v1 offset:23040
    ds_read_b64 v[106:107], v2 offset:24064
    s_mov_b64 exec, s[30:31]
    ds_read_b128 v[128:131], v3 offset:21760
    ds_read_b128 v[132:135], v3 offset:22400
    s_mov_b64 exec, -1
    v_exp_f32 v32, v32
    v_exp_f32 v33, v33
    v_exp_f32 v34, v34
    v_exp_f32 v35, v35
    v_exp_f32 v36, v36
    v_mfma_f32_32x32x16_bf16 v[48:63], v[148:151], v[84:87], v[48:63]
    v_exp_f32 v37, v37
    v_exp_f32 v38, v38
    v_exp_f32 v39, v39
    v_cvt_pk_bf16_f32 v80, v32, v33
    v_cvt_pk_bf16_f32 v81, v34, v35
    v_cvt_pk_bf16_f32 v82, v36, v37
    v_cvt_pk_bf16_f32 v83, v38, v39
    v_mfma_f32_32x32x8_bf16 v[16:31], v[100:101], v[92:93], v[16:31]
    v_exp_f32 v40, v40
    v_exp_f32 v41, v41
    v_exp_f32 v42, v42
    v_exp_f32 v43, v43
    v_exp_f32 v44, v44
    v_mfma_f32_32x32x16_bf16 v[48:63], v[152:155], v[80:83], v[48:63]
    v_exp_f32 v45, v45
    v_exp_f32 v46, v46
    v_exp_f32 v47, v47
    v_cvt_pk_bf16_f32 v84, v40, v41
    v_cvt_pk_bf16_f32 v85, v42, v43
    v_cvt_pk_bf16_f32 v86, v44, v45
    v_cvt_pk_bf16_f32 v87, v46, v47
    v_add_u32 v1, 20480, v1
    v_add_u32 v2, 20480, v2
    v_add_u32 v3, 20480, v3
    s_add_u32 s29, s29, 1
    s_waitcnt vmcnt(0)
    s_barrier
    s_cmp_lt_u32 s3, 4
    s_cbranch_scc1 main_kernel_at0ra
    s_setprio 3
    s_cmp_lg_u32 s29, 1
    s_cbranch_scc1 main_kernel_at0ra1
    s_and_b32 s98, s3, 3
    s_mul_i32 s93, s98, 2560
    s_mul_i32 s92, s51, 102400
    s_add_u32 s92, s92, s93
    s_add_u32 s92, s92, 1048576
    s_add_u32 s97, s92, 0
    buffer_load_dwordx4 v[160:163], v124, s[8:11], s97 offen offset:0
    buffer_load_dwordx4 v[164:167], v124, s[8:11], s97 offen offset:1024
    s_mov_b32 exec_hi, 0
    buffer_load_dwordx4 v[168:171], v124, s[8:11], s97 offen offset:2048
    s_mov_b32 exec_hi, -1
    s_add_u32 s97, s92, 10240
    buffer_load_dwordx4 v[172:175], v124, s[8:11], s97 offen offset:0
    buffer_load_dwordx4 v[176:179], v124, s[8:11], s97 offen offset:1024
    s_mov_b32 exec_hi, 0
    buffer_load_dwordx4 v[180:183], v124, s[8:11], s97 offen offset:2048
    s_mov_b32 exec_hi, -1
    s_branch main_kernel_at0loopa
main_kernel_at0ra1:
    s_cmp_lg_u32 s29, 2
    s_cbranch_scc1 main_kernel_at0ra2
    s_add_u32 s97, s92, 20480
    buffer_load_dwordx4 v[184:187], v124, s[8:11], s97 offen offset:0
    buffer_load_dwordx4 v[188:191], v124, s[8:11], s97 offen offset:1024
    s_mov_b32 exec_hi, 0
    buffer_load_dwordx4 v[192:195], v124, s[8:11], s97 offen offset:2048
    s_mov_b32 exec_hi, -1
    s_add_u32 s97, s92, 30720
    buffer_load_dwordx4 v[196:199], v124, s[8:11], s97 offen offset:0
    buffer_load_dwordx4 v[200:203], v124, s[8:11], s97 offen offset:1024
    s_mov_b32 exec_hi, 0
    buffer_load_dwordx4 v[204:207], v124, s[8:11], s97 offen offset:2048
    s_mov_b32 exec_hi, -1
    s_add_u32 s97, s92, 40960
    buffer_load_dwordx4 v[208:211], v124, s[8:11], s97 offen offset:0
    buffer_load_dwordx4 v[212:215], v124, s[8:11], s97 offen offset:1024
    s_mov_b32 exec_hi, 0
    buffer_load_dwordx4 v[216:219], v124, s[8:11], s97 offen offset:2048
    s_mov_b32 exec_hi, -1
    s_branch main_kernel_at0loopa
main_kernel_at0ra2:
    s_cmp_lg_u32 s29, 3
    s_cbranch_scc1 main_kernel_at0ra3
    s_add_u32 s97, s92, 51200
    buffer_load_dwordx4 v[220:223], v124, s[8:11], s97 offen offset:0
    buffer_load_dwordx4 v[224:227], v124, s[8:11], s97 offen offset:1024
    s_mov_b32 exec_hi, 0
    buffer_load_dwordx4 v[228:231], v124, s[8:11], s97 offen offset:2048
    s_mov_b32 exec_hi, -1
    s_add_u32 s97, s92, 61440
    buffer_load_dwordx4 v[232:235], v124, s[8:11], s97 offen offset:0
    buffer_load_dwordx4 v[236:239], v124, s[8:11], s97 offen offset:1024
    s_mov_b32 exec_hi, 0
    buffer_load_dwordx4 v[240:243], v124, s[8:11], s97 offen offset:2048
    s_mov_b32 exec_hi, -1
    s_branch main_kernel_at0loopa
main_kernel_at0ra3:
main_kernel_at0ra:
    s_cmp_lt_u32 s29, 4
    s_cbranch_scc1 main_kernel_at0loopa
main_kernel_at0loop:
    s_setprio 3
    s_waitcnt lgkmcnt(0)
    v_mfma_f32_32x32x16_bf16 v[32:47], v[102:105], v[88:91], v[64:79]
    ds_read_b128 v[96:99], v1 offset:5120
    ds_read_b64 v[100:101], v2 offset:6144
    s_mov_b64 exec, s[30:31]
    ds_read_b128 v[136:139], v3 offset:3840
    ds_read_b128 v[140:143], v3 offset:4480
    s_mov_b64 exec, -1
    v_exp_f32 v16, v16
    v_exp_f32 v17, v17
    v_exp_f32 v18, v18
    v_exp_f32 v19, v19
    v_exp_f32 v20, v20
    v_mfma_f32_32x32x16_bf16 v[48:63], v[156:159], v[84:87], v[48:63]
    v_exp_f32 v21, v21
    v_exp_f32 v22, v22
    v_exp_f32 v23, v23
    v_cvt_pk_bf16_f32 v80, v16, v17
    v_cvt_pk_bf16_f32 v81, v18, v19
    v_cvt_pk_bf16_f32 v82, v20, v21
    v_cvt_pk_bf16_f32 v83, v22, v23
    v_mfma_f32_32x32x8_bf16 v[32:47], v[106:107], v[92:93], v[32:47]
    v_exp_f32 v24, v24
    v_exp_f32 v25, v25
    v_exp_f32 v26, v26
    v_exp_f32 v27, v27
    v_exp_f32 v28, v28
    v_mfma_f32_32x32x16_bf16 v[48:63], v[128:131], v[80:83], v[48:63]
    v_exp_f32 v29, v29
    v_exp_f32 v30, v30
    v_exp_f32 v31, v31
    v_cvt_pk_bf16_f32 v84, v24, v25
    v_cvt_pk_bf16_f32 v85, v26, v27
    v_cvt_pk_bf16_f32 v86, v28, v29
    v_cvt_pk_bf16_f32 v87, v30, v31
    s_waitcnt lgkmcnt(0)
    v_mfma_f32_32x32x16_bf16 v[16:31], v[96:99], v[88:91], v[64:79]
    ds_read_b128 v[102:105], v1 offset:7680
    ds_read_b64 v[106:107], v2 offset:8704
    s_mov_b64 exec, s[30:31]
    ds_read_b128 v[144:147], v3 offset:6400
    ds_read_b128 v[148:151], v3 offset:7040
    s_mov_b64 exec, -1
    v_exp_f32 v32, v32
    v_exp_f32 v33, v33
    v_exp_f32 v34, v34
    v_exp_f32 v35, v35
    v_exp_f32 v36, v36
    v_mfma_f32_32x32x16_bf16 v[48:63], v[132:135], v[84:87], v[48:63]
    v_exp_f32 v37, v37
    v_exp_f32 v38, v38
    v_exp_f32 v39, v39
    v_cvt_pk_bf16_f32 v80, v32, v33
    v_cvt_pk_bf16_f32 v81, v34, v35
    v_cvt_pk_bf16_f32 v82, v36, v37
    v_cvt_pk_bf16_f32 v83, v38, v39
    v_mfma_f32_32x32x8_bf16 v[16:31], v[100:101], v[92:93], v[16:31]
    v_exp_f32 v40, v40
    v_exp_f32 v41, v41
    v_exp_f32 v42, v42
    v_exp_f32 v43, v43
    v_exp_f32 v44, v44
    v_mfma_f32_32x32x16_bf16 v[48:63], v[136:139], v[80:83], v[48:63]
    v_exp_f32 v45, v45
    v_exp_f32 v46, v46
    v_exp_f32 v47, v47
    v_cvt_pk_bf16_f32 v84, v40, v41
    v_cvt_pk_bf16_f32 v85, v42, v43
    v_cvt_pk_bf16_f32 v86, v44, v45
    v_cvt_pk_bf16_f32 v87, v46, v47
    s_setprio 2
    s_waitcnt lgkmcnt(0)
    v_mfma_f32_32x32x16_bf16 v[32:47], v[102:105], v[88:91], v[64:79]
    ds_read_b128 v[96:99], v1 offset:10240
    ds_read_b64 v[100:101], v2 offset:11264
    s_mov_b64 exec, s[30:31]
    ds_read_b128 v[152:155], v3 offset:8960
    ds_read_b128 v[156:159], v3 offset:9600
    s_mov_b64 exec, -1
    v_exp_f32 v16, v16
    v_exp_f32 v17, v17
    v_exp_f32 v18, v18
    v_exp_f32 v19, v19
    v_exp_f32 v20, v20
    v_mfma_f32_32x32x16_bf16 v[48:63], v[140:143], v[84:87], v[48:63]
    v_exp_f32 v21, v21
    v_exp_f32 v22, v22
    v_exp_f32 v23, v23
    v_cvt_pk_bf16_f32 v80, v16, v17
    v_cvt_pk_bf16_f32 v81, v18, v19
    v_cvt_pk_bf16_f32 v82, v20, v21
    v_cvt_pk_bf16_f32 v83, v22, v23
    v_mfma_f32_32x32x8_bf16 v[32:47], v[106:107], v[92:93], v[32:47]
    v_exp_f32 v24, v24
    v_exp_f32 v25, v25
    v_exp_f32 v26, v26
    v_exp_f32 v27, v27
    v_exp_f32 v28, v28
    v_mfma_f32_32x32x16_bf16 v[48:63], v[144:147], v[80:83], v[48:63]
    v_exp_f32 v29, v29
    v_exp_f32 v30, v30
    v_exp_f32 v31, v31
    v_cvt_pk_bf16_f32 v84, v24, v25
    v_cvt_pk_bf16_f32 v85, v26, v27
    v_cvt_pk_bf16_f32 v86, v28, v29
    v_cvt_pk_bf16_f32 v87, v30, v31
    s_waitcnt lgkmcnt(0)
    v_mfma_f32_32x32x16_bf16 v[16:31], v[96:99], v[88:91], v[64:79]
    ds_read_b128 v[102:105], v1 offset:12800
    ds_read_b64 v[106:107], v2 offset:13824
    s_mov_b64 exec, s[30:31]
    ds_read_b128 v[128:131], v3 offset:11520
    ds_read_b128 v[132:135], v3 offset:12160
    s_mov_b64 exec, -1
    v_exp_f32 v32, v32
    v_exp_f32 v33, v33
    v_exp_f32 v34, v34
    v_exp_f32 v35, v35
    v_exp_f32 v36, v36
    v_mfma_f32_32x32x16_bf16 v[48:63], v[148:151], v[84:87], v[48:63]
    v_exp_f32 v37, v37
    v_exp_f32 v38, v38
    v_exp_f32 v39, v39
    v_cvt_pk_bf16_f32 v80, v32, v33
    v_cvt_pk_bf16_f32 v81, v34, v35
    v_cvt_pk_bf16_f32 v82, v36, v37
    v_cvt_pk_bf16_f32 v83, v38, v39
    v_mfma_f32_32x32x8_bf16 v[16:31], v[100:101], v[92:93], v[16:31]
    v_exp_f32 v40, v40
    v_exp_f32 v41, v41
    v_exp_f32 v42, v42
    v_exp_f32 v43, v43
    v_exp_f32 v44, v44
    v_mfma_f32_32x32x16_bf16 v[48:63], v[152:155], v[80:83], v[48:63]
    v_exp_f32 v45, v45
    v_exp_f32 v46, v46
    v_exp_f32 v47, v47
    v_cvt_pk_bf16_f32 v84, v40, v41
    v_cvt_pk_bf16_f32 v85, v42, v43
    v_cvt_pk_bf16_f32 v86, v44, v45
    v_cvt_pk_bf16_f32 v87, v46, v47
    s_setprio 1
    s_waitcnt lgkmcnt(0)
    v_mfma_f32_32x32x16_bf16 v[32:47], v[102:105], v[88:91], v[64:79]
    ds_read_b128 v[96:99], v1 offset:15360
    ds_read_b64 v[100:101], v2 offset:16384
    s_mov_b64 exec, s[30:31]
    ds_read_b128 v[136:139], v3 offset:14080
    ds_read_b128 v[140:143], v3 offset:14720
    s_mov_b64 exec, -1
    v_exp_f32 v16, v16
    v_exp_f32 v17, v17
    v_exp_f32 v18, v18
    v_exp_f32 v19, v19
    v_exp_f32 v20, v20
    v_mfma_f32_32x32x16_bf16 v[48:63], v[156:159], v[84:87], v[48:63]
    v_exp_f32 v21, v21
    v_exp_f32 v22, v22
    v_exp_f32 v23, v23
    v_cvt_pk_bf16_f32 v80, v16, v17
    v_cvt_pk_bf16_f32 v81, v18, v19
    v_cvt_pk_bf16_f32 v82, v20, v21
    v_cvt_pk_bf16_f32 v83, v22, v23
    v_mfma_f32_32x32x8_bf16 v[32:47], v[106:107], v[92:93], v[32:47]
    v_exp_f32 v24, v24
    v_exp_f32 v25, v25
    v_exp_f32 v26, v26
    v_exp_f32 v27, v27
    v_exp_f32 v28, v28
    v_mfma_f32_32x32x16_bf16 v[48:63], v[128:131], v[80:83], v[48:63]
    v_exp_f32 v29, v29
    v_exp_f32 v30, v30
    v_exp_f32 v31, v31
    v_cvt_pk_bf16_f32 v84, v24, v25
    v_cvt_pk_bf16_f32 v85, v26, v27
    v_cvt_pk_bf16_f32 v86, v28, v29
    v_cvt_pk_bf16_f32 v87, v30, v31
    s_waitcnt lgkmcnt(0)
    v_mfma_f32_32x32x16_bf16 v[16:31], v[96:99], v[88:91], v[64:79]
    ds_read_b128 v[102:105], v1 offset:17920
    ds_read_b64 v[106:107], v2 offset:18944
    s_mov_b64 exec, s[30:31]
    ds_read_b128 v[144:147], v3 offset:16640
    ds_read_b128 v[148:151], v3 offset:17280
    s_mov_b64 exec, -1
    v_exp_f32 v32, v32
    v_exp_f32 v33, v33
    v_exp_f32 v34, v34
    v_exp_f32 v35, v35
    v_exp_f32 v36, v36
    v_mfma_f32_32x32x16_bf16 v[48:63], v[132:135], v[84:87], v[48:63]
    v_exp_f32 v37, v37
    v_exp_f32 v38, v38
    v_exp_f32 v39, v39
    v_cvt_pk_bf16_f32 v80, v32, v33
    v_cvt_pk_bf16_f32 v81, v34, v35
    v_cvt_pk_bf16_f32 v82, v36, v37
    v_cvt_pk_bf16_f32 v83, v38, v39
    v_mfma_f32_32x32x8_bf16 v[16:31], v[100:101], v[92:93], v[16:31]
    v_exp_f32 v40, v40
    v_exp_f32 v41, v41
    v_exp_f32 v42, v42
    v_exp_f32 v43, v43
    v_exp_f32 v44, v44
    v_mfma_f32_32x32x16_bf16 v[48:63], v[136:139], v[80:83], v[48:63]
    v_exp_f32 v45, v45
    v_exp_f32 v46, v46
    v_exp_f32 v47, v47
    v_cvt_pk_bf16_f32 v84, v40, v41
    v_cvt_pk_bf16_f32 v85, v42, v43
    v_cvt_pk_bf16_f32 v86, v44, v45
    v_cvt_pk_bf16_f32 v87, v46, v47
    s_setprio 0
    s_waitcnt lgkmcnt(0)
    v_mfma_f32_32x32x16_bf16 v[32:47], v[102:105], v[88:91], v[64:79]
    ds_read_b128 v[96:99], v1 offset:20480
    ds_read_b64 v[100:101], v2 offset:21504
    s_mov_b64 exec, s[30:31]
    ds_read_b128 v[152:155], v3 offset:19200
    ds_read_b128 v[156:159], v3 offset:19840
    s_mov_b64 exec, -1
    v_exp_f32 v16, v16
    v_exp_f32 v17, v17
    v_exp_f32 v18, v18
    v_exp_f32 v19, v19
    v_exp_f32 v20, v20
    v_mfma_f32_32x32x16_bf16 v[48:63], v[140:143], v[84:87], v[48:63]
    v_exp_f32 v21, v21
    v_exp_f32 v22, v22
    v_exp_f32 v23, v23
    v_cvt_pk_bf16_f32 v80, v16, v17
    v_cvt_pk_bf16_f32 v81, v18, v19
    v_cvt_pk_bf16_f32 v82, v20, v21
    v_cvt_pk_bf16_f32 v83, v22, v23
    v_mfma_f32_32x32x8_bf16 v[32:47], v[106:107], v[92:93], v[32:47]
    v_exp_f32 v24, v24
    v_exp_f32 v25, v25
    v_exp_f32 v26, v26
    v_exp_f32 v27, v27
    v_exp_f32 v28, v28
    v_mfma_f32_32x32x16_bf16 v[48:63], v[144:147], v[80:83], v[48:63]
    v_exp_f32 v29, v29
    v_exp_f32 v30, v30
    v_exp_f32 v31, v31
    v_cvt_pk_bf16_f32 v84, v24, v25
    v_cvt_pk_bf16_f32 v85, v26, v27
    v_cvt_pk_bf16_f32 v86, v28, v29
    v_cvt_pk_bf16_f32 v87, v30, v31
    s_waitcnt lgkmcnt(0)
    v_mfma_f32_32x32x16_bf16 v[16:31], v[96:99], v[88:91], v[64:79]
    ds_read_b128 v[102:105], v1 offset:23040
    ds_read_b64 v[106:107], v2 offset:24064
    s_mov_b64 exec, s[30:31]
    ds_read_b128 v[128:131], v3 offset:21760
    ds_read_b128 v[132:135], v3 offset:22400
    s_mov_b64 exec, -1
    v_exp_f32 v32, v32
    v_exp_f32 v33, v33
    v_exp_f32 v34, v34
    v_exp_f32 v35, v35
    v_exp_f32 v36, v36
    v_mfma_f32_32x32x16_bf16 v[48:63], v[148:151], v[84:87], v[48:63]
    v_exp_f32 v37, v37
    v_exp_f32 v38, v38
    v_exp_f32 v39, v39
    v_cvt_pk_bf16_f32 v80, v32, v33
    v_cvt_pk_bf16_f32 v81, v34, v35
    v_cvt_pk_bf16_f32 v82, v36, v37
    v_cvt_pk_bf16_f32 v83, v38, v39
    v_mfma_f32_32x32x8_bf16 v[16:31], v[100:101], v[92:93], v[16:31]
    v_exp_f32 v40, v40
    v_exp_f32 v41, v41
    v_exp_f32 v42, v42
    v_exp_f32 v43, v43
    v_exp_f32 v44, v44
    v_mfma_f32_32x32x16_bf16 v[48:63], v[152:155], v[80:83], v[48:63]
    v_exp_f32 v45, v45
    v_exp_f32 v46, v46
    v_exp_f32 v47, v47
    v_cvt_pk_bf16_f32 v84, v40, v41
    v_cvt_pk_bf16_f32 v85, v42, v43
    v_cvt_pk_bf16_f32 v86, v44, v45
    v_cvt_pk_bf16_f32 v87, v46, v47
    v_add_u32 v1, 20480, v1
    v_add_u32 v2, 20480, v2
    v_add_u32 v3, 20480, v3
    s_add_u32 s29, s29, 1
    s_cmp_ge_u32 s29, 8
    s_cbranch_scc1 main_kernel_at0done
    s_cmp_lg_u32 s28, 0
    s_cbranch_scc1 main_kernel_at0loop
    s_barrier
    s_cmp_lg_u32 s29, 5
    s_cbranch_scc1 main_kernel_at0loop
main_kernel_at0pfb:
    s_lshr_b32 s26, s85, 3
    s_lshl_b32 s26, s26, 3
    s_add_u32 s26, s26, s3
    s_mul_i32 s27, s26, 3200
    s_add_u32 s27, s27, 1048576
    v_lshlrev_b32 v125, 7, v0
    s_mov_b32 exec_hi, 0
    buffer_load_dword v126, v125, s[8:11], s27 offen
    s_mov_b32 exec_hi, -1
    s_mul_i32 s26, s26, 7680
    s_and_b32 s27, s85, 1
    s_mul_i32 s27, s27, 1966080
    s_add_u32 s26, s26, s27
    s_add_u32 s26, s26, 2097152
    buffer_load_dword v127, v125, s[8:11], s26 offen
    s_sub_u32 s26, s26, s27
    s_xor_b32 s27, s27, 1966080
    s_add_u32 s26, s26, s27
    buffer_load_dword v127, v125, s[8:11], s26 offen
    s_branch main_kernel_at0loop
main_kernel_at0done:
    v_mfma_f32_32x32x16_bf16 v[48:63], v[156:159], v[84:87], v[48:63]
    s_waitcnt lgkmcnt(0)
    s_nop 7
    s_nop 3
    v_cmp_gt_f32 vcc, 0x2b800000, v60
    s_cmp_lg_u32 s28, 0
    s_cbranch_scc1 main_kernel_at0fin
    s_cmp_eq_u64 vcc, 0
    s_cbranch_scc1 main_kernel_at0fin
    s_mov_b32 s28, 16
    v_subrev_u32 v1, 163840, v1
    v_subrev_u32 v2, 163840, v2
    v_subrev_u32 v3, 163840, v3
    v_mov_b32 v10, 0xff800000
    v_mov_b32 v12, v1
    v_mov_b32 v13, v2
    s_mov_b32 s29, 0
main_kernel_at0fb:
    ds_read_b128 v[96:99], v12
    ds_read_b64 v[100:101], v13 offset:1024
    s_waitcnt lgkmcnt(0)
    v_mfma_f32_32x32x16_bf16 v[16:31], v[96:99], v[88:91], 0
    v_mfma_f32_32x32x8_bf16 v[16:31], v[100:101], v[92:93], v[16:31]
    v_add_u32 v12, 2560, v12
    v_add_u32 v13, 2560, v13
    s_nop 7
    s_nop 3
    v_max3_f32 v10, v10, v16, v17
    v_max3_f32 v10, v10, v18, v19
    v_max3_f32 v10, v10, v20, v21
    v_max3_f32 v10, v10, v22, v23
    v_max3_f32 v10, v10, v24, v25
    v_max3_f32 v10, v10, v26, v27
    v_max3_f32 v10, v10, v28, v29
    v_max3_f32 v10, v10, v30, v31
    s_add_u32 s29, s29, 1
    s_cmp_lt_u32 s29, 64
    s_cbranch_scc1 main_kernel_at0fb
    v_mov_b32 v11, v10
    s_nop 1
    v_permlane32_swap_b32 v10, v11
    s_nop 1
    v_max_f32 v10, v10, v11
    v_sub_f32 v10, 0, v10
    s_branch main_kernel_at0restart
main_kernel_at0fin:
    s_setprio 0
    v_rcp_f32 v10, v60
    s_add_u32 s23, s22, 20971520
    v_mov_b32 v11, v10
    v_pk_mul_f32 v[48:49], v[48:49], v[10:11]
    v_pk_mul_f32 v[50:51], v[50:51], v[10:11]
    v_cvt_pk_bf16_f32 v48, v48, v49
    v_cvt_pk_bf16_f32 v49, v50, v51
    buffer_store_dwordx2 v[48:49], v4, s[8:11], s23 offen
    v_pk_mul_f32 v[52:53], v[52:53], v[10:11]
    v_pk_mul_f32 v[54:55], v[54:55], v[10:11]
    v_cvt_pk_bf16_f32 v52, v52, v53
    v_cvt_pk_bf16_f32 v53, v54, v55
    buffer_store_dwordx2 v[52:53], v5, s[8:11], s23 offen
    s_mov_b32 exec_hi, 0
    v_pk_mul_f32 v[56:57], v[56:57], v[10:11]
    v_pk_mul_f32 v[58:59], v[58:59], v[10:11]
    v_cvt_pk_bf16_f32 v56, v56, v57
    v_cvt_pk_bf16_f32 v57, v58, v59
    buffer_store_dwordx2 v[56:57], v6, s[8:11], s23 offen
    s_mov_b32 exec_hi, -1
    s_waitcnt vmcnt(0)
    s_barrier
    s_cmp_lg_u32 s3, 0
    s_cbranch_scc1 main_kernel_sig2
    s_add_u32 s44, s58, 48250880
    v_mov_b32 v246, 1
    s_mov_b64 exec, 1
    s_cmp_lg_u32 s84, 0
    s_cbranch_scc1 main_kernel_sig2s
    buffer_store_dword v246, off, s[8:11], s44
    s_branch main_kernel_sig2e
main_kernel_sig2s:
    buffer_wbl2 sc1
    s_waitcnt vmcnt(0)
    buffer_store_dword v246, off, s[8:11], s44 sc1
main_kernel_sig2e:
    s_mov_b64 exec, -1
main_kernel_sig2:
    s_cmp_lt_u32 s3, 4
    s_cbranch_scc1 main_kernel_c1
    s_and_b32 s7, s3, 3
    s_mov_b32 s20, s92
    s_mov_b32 s21, s93
    v_lshlrev_b32 v1, 4, v0
    v_add_u32 v20, s93, v1
    v_add_u32 v21, 0x10000, v20
    s_add_u32 m0, s21, 71680
    s_add_u32 s23, s20, 71680
    buffer_load_dwordx4 v1, s[8:11], s23 offen offset:0 lds
    buffer_load_dwordx4 v1, s[8:11], s23 offen offset:1024 lds
    s_mov_b32 exec_hi, 0
    buffer_load_dwordx4 v1, s[8:11], s23 offen offset:2048 lds
    s_mov_b32 exec_hi, -1
    s_add_u32 m0, s21, 81920
    s_add_u32 s23, s20, 81920
    buffer_load_dwordx4 v1, s[8:11], s23 offen offset:0 lds
    buffer_load_dwordx4 v1, s[8:11], s23 offen offset:1024 lds
    s_mov_b32 exec_hi, 0
    buffer_load_dwordx4 v1, s[8:11], s23 offen offset:2048 lds
    s_mov_b32 exec_hi, -1
    s_add_u32 m0, s21, 92160
    s_add_u32 s23, s20, 92160
    buffer_load_dwordx4 v1, s[8:11], s23 offen offset:0 lds
    buffer_load_dwordx4 v1, s[8:11], s23 offen offset:1024 lds
    s_mov_b32 exec_hi, 0
    buffer_load_dwordx4 v1, s[8:11], s23 offen offset:2048 lds
    s_mov_b32 exec_hi, -1
    ds_write_b128 v20, v[160:163] offset:0
    ds_write_b128 v20, v[164:167] offset:1024
    s_mov_b32 exec_hi, 0
    ds_write_b128 v20, v[168:171] offset:2048
    s_mov_b32 exec_hi, -1
    ds_write_b128 v20, v[172:175] offset:10240
    ds_write_b128 v20, v[176:179] offset:11264
    s_mov_b32 exec_hi, 0
    ds_write_b128 v20, v[180:183] offset:12288
    s_mov_b32 exec_hi, -1
    ds_write_b128 v20, v[184:187] offset:20480
    ds_write_b128 v20, v[188:191] offset:21504
    s_mov_b32 exec_hi, 0
    ds_write_b128 v20, v[192:195] offset:22528
    s_mov_b32 exec_hi, -1
    ds_write_b128 v20, v[196:199] offset:30720
    ds_write_b128 v20, v[200:203] offset:31744
    s_mov_b32 exec_hi, 0
    ds_write_b128 v20, v[204:207] offset:32768
    s_mov_b32 exec_hi, -1
    ds_write_b128 v20, v[208:211] offset:40960
    ds_write_b128 v20, v[212:215] offset:41984
    s_mov_b32 exec_hi, 0
    ds_write_b128 v20, v[216:219] offset:43008
    s_mov_b32 exec_hi, -1
    ds_write_b128 v20, v[220:223] offset:51200
    ds_write_b128 v20, v[224:227] offset:52224
    s_mov_b32 exec_hi, 0
    ds_write_b128 v20, v[228:231] offset:53248
    s_mov_b32 exec_hi, -1
    ds_write_b128 v20, v[232:235] offset:61440
    ds_write_b128 v20, v[236:239] offset:62464
    s_mov_b32 exec_hi, 0
    ds_write_b128 v20, v[240:243] offset:63488
    s_mov_b32 exec_hi, -1
    s_waitcnt lgkmcnt(0)
    s_barrier
    s_barrier
    s_and_b32 s98, s3, 3
    s_mul_i32 s93, s98, 3072
    s_mul_i32 s92, s54, 245760
    s_add_u32 s92, s92, s93
    s_add_u32 s92, s92, 2097152
    s_add_u32 s97, s92, 0
    buffer_load_dwordx4 v[32:35], v1, s[8:11], s97 offen offset:0
    buffer_load_dwordx4 v[36:39], v1, s[8:11], s97 offen offset:1024
    buffer_load_dwordx4 v[40:43], v1, s[8:11], s97 offen offset:2048
    s_add_u32 s97, s92, 12288
    buffer_load_dwordx4 v[44:47], v1, s[8:11], s97 offen offset:0
    buffer_load_dwordx4 v[48:51], v1, s[8:11], s97 offen offset:1024
    buffer_load_dwordx4 v[52:55], v1, s[8:11], s97 offen offset:2048
    s_barrier
    s_add_u32 s97, s92, 24576
    buffer_load_dwordx4 v[56:59], v1, s[8:11], s97 offen offset:0
    buffer_load_dwordx4 v[60:63], v1, s[8:11], s97 offen offset:1024
    buffer_load_dwordx4 v[64:67], v1, s[8:11], s97 offen offset:2048
    s_add_u32 s97, s92, 36864
    buffer_load_dwordx4 v[68:71], v1, s[8:11], s97 offen offset:0
    buffer_load_dwordx4 v[72:75], v1, s[8:11], s97 offen offset:1024
    buffer_load_dwordx4 v[76:79], v1, s[8:11], s97 offen offset:2048
    s_barrier
    s_add_u32 s97, s92, 49152
    buffer_load_dwordx4 v[80:83], v1, s[8:11], s97 offen offset:0
    buffer_load_dwordx4 v[84:87], v1, s[8:11], s97 offen offset:1024
    buffer_load_dwordx4 v[88:91], v1, s[8:11], s97 offen offset:2048
    s_add_u32 s97, s92, 61440
    buffer_load_dwordx4 v[92:95], v1, s[8:11], s97 offen offset:0
    buffer_load_dwordx4 v[96:99], v1, s[8:11], s97 offen offset:1024
    buffer_load_dwordx4 v[100:103], v1, s[8:11], s97 offen offset:2048
    s_waitcnt vmcnt(24)
    s_barrier
    s_add_u32 s97, s92, 73728
    buffer_load_dwordx4 v[104:107], v1, s[8:11], s97 offen offset:0
    buffer_load_dwordx4 v[108:111], v1, s[8:11], s97 offen offset:1024
    buffer_load_dwordx4 v[112:115], v1, s[8:11], s97 offen offset:2048
    s_add_u32 s97, s92, 86016
    buffer_load_dwordx4 v[116:119], v1, s[8:11], s97 offen offset:0
    buffer_load_dwordx4 v[120:123], v1, s[8:11], s97 offen offset:1024
    buffer_load_dwordx4 v[124:127], v1, s[8:11], s97 offen offset:2048
    s_waitcnt vmcnt(27)
    s_waitcnt vmcnt(24)
    s_barrier
    s_barrier
    s_and_b32 s7, s3, 3
    s_mov_b32 s20, s92
    s_mov_b32 s21, s93
    v_lshlrev_b32 v1, 4, v0
    v_add_u32 v20, s93, v1
    v_add_u32 v21, 0x10000, v20
    s_waitcnt vmcnt(21)
    ds_write_b128 v20, v[32:35] offset:0
    ds_write_b128 v20, v[36:39] offset:1024
    ds_write_b128 v20, v[40:43] offset:2048
    s_waitcnt vmcnt(18)
    ds_write_b128 v20, v[44:47] offset:12288
    ds_write_b128 v20, v[48:51] offset:13312
    ds_write_b128 v20, v[52:55] offset:14336
    s_waitcnt vmcnt(15)
    ds_write_b128 v20, v[56:59] offset:24576
    ds_write_b128 v20, v[60:63] offset:25600
    ds_write_b128 v20, v[64:67] offset:26624
    s_waitcnt vmcnt(12)
    ds_write_b128 v20, v[68:71] offset:36864
    ds_write_b128 v20, v[72:75] offset:37888
    ds_write_b128 v20, v[76:79] offset:38912
    s_waitcnt vmcnt(9)
    ds_write_b128 v20, v[80:83] offset:49152
    ds_write_b128 v20, v[84:87] offset:50176
    ds_write_b128 v20, v[88:91] offset:51200
    s_waitcnt vmcnt(6)
    ds_write_b128 v20, v[92:95] offset:61440
    ds_write_b128 v20, v[96:99] offset:62464
    ds_write_b128 v20, v[100:103] offset:63488
    s_waitcnt vmcnt(3)
    ds_write_b128 v21, v[104:107] offset:8192
    ds_write_b128 v21, v[108:111] offset:9216
    ds_write_b128 v21, v[112:115] offset:10240
    s_waitcnt vmcnt(0)
    ds_write_b128 v21, v[116:119] offset:20480
    ds_write_b128 v21, v[120:123] offset:21504
    ds_write_b128 v21, v[124:127] offset:22528
    s_waitcnt lgkmcnt(0)
    s_barrier
    s_lshl_b32 s4, s53, 2
    s_add_u32 s4, s4, s7
    s_mul_i32 s22, s4, 40960
    s_add_u32 s22, s22, 8388608
    v_and_b32 v6, 15, v0
    v_bfe_u32 v7, v0, 4, 1
    v_lshrrev_b32 v8, 5, v0
    v_lshlrev_b32 v6, 4, v6
    v_lshl_add_u32 v6, v8, 8, v6
    v_mul_u32_u24 v4, 20480, v7
    v_add_u32 v4, v4, v6
    s_barrier
    s_lshl_b32 s26, s7, 11
    s_add_u32 s26, s26, 98304
    s_add_u32 m0, s26, 0
    s_add_u32 s23, s22, 0
    buffer_load_dwordx4 v4, s[8:11], s23 offen sc1 lds
    s_add_u32 m0, s26, 1024
    s_add_u32 s23, s22, 512
    buffer_load_dwordx4 v4, s[8:11], s23 offen sc1 lds
    s_add_u32 m0, s26, 8192
    s_add_u32 s23, s22, 1024
    buffer_load_dwordx4 v4, s[8:11], s23 offen sc1 lds
    s_add_u32 m0, s26, 9216
    s_add_u32 s23, s22, 1536
    buffer_load_dwordx4 v4, s[8:11], s23 offen sc1 lds
    s_add_u32 m0, s26, 16384
    s_add_u32 s23, s22, 2048
    buffer_load_dwordx4 v4, s[8:11], s23 offen sc1 lds
    s_add_u32 m0, s26, 17408
    s_add_u32 s23, s22, 2560
    buffer_load_dwordx4 v4, s[8:11], s23 offen sc1 lds
    s_add_u32 m0, s26, 24576
    s_add_u32 s23, s22, 3072
    buffer_load_dwordx4 v4, s[8:11], s23 offen sc1 lds
    s_add_u32 m0, s26, 25600
    s_add_u32 s23, s22, 3584
    buffer_load_dwordx4 v4, s[8:11], s23 offen sc1 lds
    s_add_u32 m0, s26, 32768
    s_add_u32 s23, s22, 4096
    buffer_load_dwordx4 v4, s[8:11], s23 offen sc1 lds
    s_add_u32 m0, s26, 33792
    s_add_u32 s23, s22, 4608
    buffer_load_dwordx4 v4, s[8:11], s23 offen sc1 lds
    s_add_u32 m0, s26, 40960
    s_add_u32 s23, s22, 5120
    buffer_load_dwordx4 v4, s[8:11], s23 offen sc1 lds
    s_add_u32 m0, s26, 41984
    s_add_u32 s23, s22, 5632
    buffer_load_dwordx4 v4, s[8:11], s23 offen sc1 lds
    s_add_u32 m0, s26, 49152
    s_add_u32 s23, s22, 6144
    buffer_load_dwordx4 v4, s[8:11], s23 offen sc1 lds
    s_add_u32 m0, s26, 50176
    s_add_u32 s23, s22, 6656
    buffer_load_dwordx4 v4, s[8:11], s23 offen sc1 lds
    s_add_u32 m0, s26, 57344
    s_add_u32 s23, s22, 7168
    buffer_load_dwordx4 v4, s[8:11], s23 offen sc1 lds
    s_add_u32 m0, s26, 58368
    s_add_u32 s23, s22, 7680
    buffer_load_dwordx4 v4, s[8:11], s23 offen sc1 lds
    s_waitcnt vmcnt(14)
    s_barrier
    s_waitcnt vmcnt(12)
    s_barrier
    s_waitcnt vmcnt(10)
    s_barrier
    s_add_u32 m0, s26, 0
    s_add_u32 s23, s22, 8192
    buffer_load_dwordx4 v4, s[8:11], s23 offen sc1 lds
    s_add_u32 m0, s26, 1024
    s_add_u32 s23, s22, 8704
    buffer_load_dwordx4 v4, s[8:11], s23 offen sc1 lds
    s_add_u32 m0, s21, 0
    s_add_u32 s23, s20, 98304
    buffer_load_dwordx4 v1, s[8:11], s23 offen offset:0 lds
    buffer_load_dwordx4 v1, s[8:11], s23 offen offset:1024 lds
    buffer_load_dwordx4 v1, s[8:11], s23 offen offset:2048 lds
    s_waitcnt vmcnt(13)
    s_barrier
    s_add_u32 m0, s26, 8192
    s_add_u32 s23, s22, 9216
    buffer_load_dwordx4 v4, s[8:11], s23 offen sc1 lds
    s_add_u32 m0, s26, 9216
    s_add_u32 s23, s22, 9728
    buffer_load_dwordx4 v4, s[8:11], s23 offen sc1 lds
    s_add_u32 m0, s21, 12288
    s_add_u32 s23, s20, 110592
    buffer_load_dwordx4 v1, s[8:11], s23 offen offset:0 lds
    buffer_load_dwordx4 v1, s[8:11], s23 offen offset:1024 lds
    buffer_load_dwordx4 v1, s[8:11], s23 offen offset:2048 lds
    s_waitcnt vmcnt(16)
    s_barrier
    s_add_u32 m0, s26, 16384
    s_add_u32 s23, s22, 10240
    buffer_load_dwordx4 v4, s[8:11], s23 offen sc1 lds
    s_add_u32 m0, s26, 17408
    s_add_u32 s23, s22, 10752
    buffer_load_dwordx4 v4, s[8:11], s23 offen sc1 lds
    s_add_u32 m0, s21, 24576
    s_add_u32 s23, s20, 122880
    buffer_load_dwordx4 v1, s[8:11], s23 offen offset:0 lds
    buffer_load_dwordx4 v1, s[8:11], s23 offen offset:1024 lds
    buffer_load_dwordx4 v1, s[8:11], s23 offen offset:2048 lds
    s_waitcnt vmcnt(19)
    s_barrier
    s_add_u32 m0, s26, 24576
    s_add_u32 s23, s22, 11264
    buffer_load_dwordx4 v4, s[8:11], s23 offen sc1 lds
    s_add_u32 m0, s26, 25600
    s_add_u32 s23, s22, 11776
    buffer_load_dwordx4 v4, s[8:11], s23 offen sc1 lds
    s_add_u32 m0, s21, 36864
    s_add_u32 s23, s20, 135168
    buffer_load_dwordx4 v1, s[8:11], s23 offen offset:0 lds
    buffer_load_dwordx4 v1, s[8:11], s23 offen offset:1024 lds
    buffer_load_dwordx4 v1, s[8:11], s23 offen offset:2048 lds
    s_waitcnt vmcnt(22)
    s_barrier
    s_add_u32 m0, s26, 32768
    s_add_u32 s23, s22, 12288
    buffer_load_dwordx4 v4, s[8:11], s23 offen sc1 lds
    s_add_u32 m0, s26, 33792
    s_add_u32 s23, s22, 12800
    buffer_load_dwordx4 v4, s[8:11], s23 offen sc1 lds
    s_add_u32 m0, s21, 49152
    s_add_u32 s23, s20, 147456
    buffer_load_dwordx4 v1, s[8:11], s23 offen offset:0 lds
    buffer_load_dwordx4 v1, s[8:11], s23 offen offset:1024 lds
    buffer_load_dwordx4 v1, s[8:11], s23 offen offset:2048 lds
    s_waitcnt vmcnt(25)
    s_barrier
    s_add_u32 m0, s26, 40960
    s_add_u32 s23, s22, 13312
    buffer_load_dwordx4 v4, s[8:11], s23 offen sc1 lds
    s_add_u32 m0, s26, 41984
    s_add_u32 s23, s22, 13824
    buffer_load_dwordx4 v4, s[8:11], s23 offen sc1 lds
    s_add_u32 m0, s21, 61440
    s_add_u32 s23, s20, 159744
    buffer_load_dwordx4 v1, s[8:11], s23 offen offset:0 lds
    buffer_load_dwordx4 v1, s[8:11], s23 offen offset:1024 lds
    buffer_load_dwordx4 v1, s[8:11], s23 offen offset:2048 lds
    s_waitcnt vmcnt(25)
    s_barrier
    s_add_u32 m0, s26, 49152
    s_add_u32 s23, s22, 14336
    buffer_load_dwordx4 v4, s[8:11], s23 offen sc1 lds
    s_add_u32 m0, s26, 50176
    s_add_u32 s23, s22, 14848
    buffer_load_dwordx4 v4, s[8:11], s23 offen sc1 lds
    s_add_u32 m0, s21, 73728
    s_add_u32 s23, s20, 172032
    buffer_load_dwordx4 v1, s[8:11], s23 offen offset:0 lds
    buffer_load_dwordx4 v1, s[8:11], s23 offen offset:1024 lds
    buffer_load_dwordx4 v1, s[8:11], s23 offen offset:2048 lds
    s_waitcnt vmcnt(25)
    s_barrier
    s_add_u32 m0, s26, 57344
    s_add_u32 s23, s22, 15360
    buffer_load_dwordx4 v4, s[8:11], s23 offen sc1 lds
    s_add_u32 m0, s26, 58368
    s_add_u32 s23, s22, 15872
    buffer_load_dwordx4 v4, s[8:11], s23 offen sc1 lds
    s_add_u32 m0, s21, 86016
    s_add_u32 s23, s20, 184320
    buffer_load_dwordx4 v1, s[8:11], s23 offen offset:0 lds
    buffer_load_dwordx4 v1, s[8:11], s23 offen offset:1024 lds
    buffer_load_dwordx4 v1, s[8:11], s23 offen offset:2048 lds
    s_waitcnt vmcnt(25)
    s_barrier
    s_add_u32 m0, s26, 0
    s_add_u32 s23, s22, 16384
    buffer_load_dwordx4 v4, s[8:11], s23 offen sc1 lds
    s_add_u32 m0, s26, 1024
    s_add_u32 s23, s22, 16896
    buffer_load_dwordx4 v4, s[8:11], s23 offen sc1 lds
    s_add_u32 m0, s21, 0
    s_add_u32 s23, s20, 196608
    buffer_load_dwordx4 v1, s[8:11], s23 offen offset:0 lds
    buffer_load_dwordx4 v1, s[8:11], s23 offen offset:1024 lds
    buffer_load_dwordx4 v1, s[8:11], s23 offen offset:2048 lds
    s_waitcnt vmcnt(25)
    s_barrier
    s_add_u32 m0, s26, 8192
    s_add_u32 s23, s22, 17408
    buffer_load_dwordx4 v4, s[8:11], s23 offen sc1 lds
    s_add_u32 m0, s26, 9216
    s_add_u32 s23, s22, 17920
    buffer_load_dwordx4 v4, s[8:11], s23 offen sc1 lds
    s_add_u32 m0, s21, 12288
    s_add_u32 s23, s20, 208896
    buffer_load_dwordx4 v1, s[8:11], s23 offen offset:0 lds
    buffer_load_dwordx4 v1, s[8:11], s23 offen offset:1024 lds
    buffer_load_dwordx4 v1, s[8:11], s23 offen offset:2048 lds
    s_waitcnt vmcnt(25)
    s_barrier
    s_add_u32 m0, s26, 16384
    s_add_u32 s23, s22, 18432
    buffer_load_dwordx4 v4, s[8:11], s23 offen sc1 lds
    s_add_u32 m0, s26, 17408
    s_add_u32 s23, s22, 18944
    buffer_load_dwordx4 v4, s[8:11], s23 offen sc1 lds
    s_add_u32 m0, s21, 24576
    s_add_u32 s23, s20, 221184
    buffer_load_dwordx4 v1, s[8:11], s23 offen offset:0 lds
    buffer_load_dwordx4 v1, s[8:11], s23 offen offset:1024 lds
    buffer_load_dwordx4 v1, s[8:11], s23 offen offset:2048 lds
    s_waitcnt vmcnt(25)
    s_barrier
    s_add_u32 m0, s26, 24576
    s_add_u32 s23, s22, 19456
    buffer_load_dwordx4 v4, s[8:11], s23 offen sc1 lds
    s_add_u32 m0, s26, 25600
    s_add_u32 s23, s22, 19968
    buffer_load_dwordx4 v4, s[8:11], s23 offen sc1 lds
    s_add_u32 m0, s21, 36864
    s_add_u32 s23, s20, 233472
    buffer_load_dwordx4 v1, s[8:11], s23 offen offset:0 lds
    buffer_load_dwordx4 v1, s[8:11], s23 offen offset:1024 lds
    buffer_load_dwordx4 v1, s[8:11], s23 offen offset:2048 lds
    s_waitcnt vmcnt(25)
    s_barrier
    s_and_b32 s98, s3, 3
    s_mul_i32 s93, s98, 2560
    s_mul_i32 s92, s51, 245760
    s_add_u32 s92, s92, s93
    s_add_u32 s92, s92, 6291456
    s_add_u32 s97, s92, 0
    buffer_load_dwordx4 v[32:35], v1, s[8:11], s97 offen offset:0
    buffer_load_dwordx4 v[36:39], v1, s[8:11], s97 offen offset:1024
    s_mov_b32 exec_hi, 0
    buffer_load_dwordx4 v[40:43], v1, s[8:11], s97 offen offset:2048
    s_mov_b32 exec_hi, -1
    s_add_u32 s97, s92, 10240
    buffer_load_dwordx4 v[44:47], v1, s[8:11], s97 offen offset:0
    buffer_load_dwordx4 v[48:51], v1, s[8:11], s97 offen offset:1024
    s_mov_b32 exec_hi, 0
    buffer_load_dwordx4 v[52:55], v1, s[8:11], s97 offen offset:2048
    s_mov_b32 exec_hi, -1
    s_waitcnt vmcnt(26)
    s_barrier
    s_add_u32 s97, s92, 20480
    buffer_load_dwordx4 v[56:59], v1, s[8:11], s97 offen offset:0
    buffer_load_dwordx4 v[60:63], v1, s[8:11], s97 offen offset:1024
    s_mov_b32 exec_hi, 0
    buffer_load_dwordx4 v[64:67], v1, s[8:11], s97 offen offset:2048
    s_mov_b32 exec_hi, -1
    s_add_u32 s97, s92, 30720
    buffer_load_dwordx4 v[68:71], v1, s[8:11], s97 offen offset:0
    buffer_load_dwordx4 v[72:75], v1, s[8:11], s97 offen offset:1024
    s_mov_b32 exec_hi, 0
    buffer_load_dwordx4 v[76:79], v1, s[8:11], s97 offen offset:2048
    s_mov_b32 exec_hi, -1
    s_waitcnt vmcnt(27)
    s_barrier
    s_add_u32 s97, s92, 40960
    buffer_load_dwordx4 v[80:83], v1, s[8:11], s97 offen offset:0
    buffer_load_dwordx4 v[84:87], v1, s[8:11], s97 offen offset:1024
    s_mov_b32 exec_hi, 0
    buffer_load_dwordx4 v[88:91], v1, s[8:11], s97 offen offset:2048
    s_mov_b32 exec_hi, -1
    s_add_u32 s97, s92, 51200
    buffer_load_dwordx4 v[92:95], v1, s[8:11], s97 offen offset:0
    buffer_load_dwordx4 v[96:99], v1, s[8:11], s97 offen offset:1024
    s_mov_b32 exec_hi, 0
    buffer_load_dwordx4 v[100:103], v1, s[8:11], s97 offen offset:2048
    s_mov_b32 exec_hi, -1
    s_waitcnt vmcnt(28)
    s_barrier
    s_add_u32 s97, s92, 61440
    buffer_load_dwordx4 v[104:107], v1, s[8:11], s97 offen offset:0
    buffer_load_dwordx4 v[108:111], v1, s[8:11], s97 offen offset:1024
    s_mov_b32 exec_hi, 0
    buffer_load_dwordx4 v[112:115], v1, s[8:11], s97 offen offset:2048
    s_mov_b32 exec_hi, -1
    s_add_u32 s97, s92, 71680
    buffer_load_dwordx4 v[116:119], v1, s[8:11], s97 offen offset:0
    buffer_load_dwordx4 v[120:123], v1, s[8:11], s97 offen offset:1024
    s_mov_b32 exec_hi, 0
    buffer_load_dwordx4 v[124:127], v1, s[8:11], s97 offen offset:2048
    s_mov_b32 exec_hi, -1
    s_waitcnt vmcnt(29)
    s_barrier
    s_add_u32 s97, s92, 81920
    buffer_load_dwordx4 v[128:131], v1, s[8:11], s97 offen offset:0
    buffer_load_dwordx4 v[132:135], v1, s[8:11], s97 offen offset:1024
    s_mov_b32 exec_hi, 0
    buffer_load_dwordx4 v[136:139], v1, s[8:11], s97 offen offset:2048
    s_mov_b32 exec_hi, -1
    s_add_u32 s97, s92, 92160
    buffer_load_dwordx4 v[140:143], v1, s[8:11], s97 offen offset:0
    buffer_load_dwordx4 v[144:147], v1, s[8:11], s97 offen offset:1024
    s_mov_b32 exec_hi, 0
    buffer_load_dwordx4 v[148:151], v1, s[8:11], s97 offen offset:2048
    s_mov_b32 exec_hi, -1
    s_waitcnt vmcnt(30)
    s_barrier
    s_add_u32 s97, s92, 102400
    buffer_load_dwordx4 v[152:155], v1, s[8:11], s97 offen offset:0
    buffer_load_dwordx4 v[156:159], v1, s[8:11], s97 offen offset:1024
    s_mov_b32 exec_hi, 0
    buffer_load_dwordx4 v[160:163], v1, s[8:11], s97 offen offset:2048
    s_mov_b32 exec_hi, -1
    s_add_u32 s97, s92, 112640
    buffer_load_dwordx4 v[164:167], v1, s[8:11], s97 offen offset:0
    buffer_load_dwordx4 v[168:171], v1, s[8:11], s97 offen offset:1024
    s_mov_b32 exec_hi, 0
    buffer_load_dwordx4 v[172:175], v1, s[8:11], s97 offen offset:2048
    s_mov_b32 exec_hi, -1
    s_barrier
    s_and_b32 s7, s3, 3
    s_mov_b32 s20, s92
    s_mov_b32 s21, s93
    v_lshlrev_b32 v1, 4, v0
    v_add_u32 v20, s93, v1
    v_add_u32 v21, 0x10000, v20
    s_add_u32 m0, s21, 122880
    s_add_u32 s23, s20, 122880
    buffer_load_dwordx4 v1, s[8:11], s23 offen offset:0 lds
    buffer_load_dwordx4 v1, s[8:11], s23 offen offset:1024 lds
    s_mov_b32 exec_hi, 0
    buffer_load_dwordx4 v1, s[8:11], s23 offen offset:2048 lds
    s_mov_b32 exec_hi, -1
    s_waitcnt vmcnt(36)
    ds_write_b128 v20, v[32:35] offset:0
    ds_write_b128 v20, v[36:39] offset:1024
    s_mov_b32 exec_hi, 0
    ds_write_b128 v20, v[40:43] offset:2048
    s_mov_b32 exec_hi, -1
    s_waitcnt vmcnt(33)
    ds_write_b128 v20, v[44:47] offset:10240
    ds_write_b128 v20, v[48:51] offset:11264
    s_mov_b32 exec_hi, 0
    ds_write_b128 v20, v[52:55] offset:12288
    s_mov_b32 exec_hi, -1
    s_waitcnt vmcnt(30)
    ds_write_b128 v20, v[56:59] offset:20480
    ds_write_b128 v20, v[60:63] offset:21504
    s_mov_b32 exec_hi, 0
    ds_write_b128 v20, v[64:67] offset:22528
    s_mov_b32 exec_hi, -1
    s_waitcnt vmcnt(27)
    ds_write_b128 v20, v[68:71] offset:30720
    ds_write_b128 v20, v[72:75] offset:31744
    s_mov_b32 exec_hi, 0
    ds_write_b128 v20, v[76:79] offset:32768
    s_mov_b32 exec_hi, -1
    s_waitcnt vmcnt(24)
    ds_write_b128 v20, v[80:83] offset:40960
    ds_write_b128 v20, v[84:87] offset:41984
    s_mov_b32 exec_hi, 0
    ds_write_b128 v20, v[88:91] offset:43008
    s_mov_b32 exec_hi, -1
    s_waitcnt vmcnt(21)
    ds_write_b128 v20, v[92:95] offset:51200
    ds_write_b128 v20, v[96:99] offset:52224
    s_mov_b32 exec_hi, 0
    ds_write_b128 v20, v[100:103] offset:53248
    s_mov_b32 exec_hi, -1
    s_waitcnt vmcnt(18)
    ds_write_b128 v20, v[104:107] offset:61440
    ds_write_b128 v20, v[108:111] offset:62464
    s_mov_b32 exec_hi, 0
    ds_write_b128 v20, v[112:115] offset:63488
    s_mov_b32 exec_hi, -1
    s_waitcnt vmcnt(15)
    ds_write_b128 v21, v[116:119] offset:6144
    ds_write_b128 v21, v[120:123] offset:7168
    s_mov_b32 exec_hi, 0
    ds_write_b128 v21, v[124:127] offset:8192
    s_mov_b32 exec_hi, -1
    s_waitcnt vmcnt(12)
    ds_write_b128 v21, v[128:131] offset:16384
    ds_write_b128 v21, v[132:135] offset:17408
    s_mov_b32 exec_hi, 0
    ds_write_b128 v21, v[136:139] offset:18432
    s_mov_b32 exec_hi, -1
    s_waitcnt vmcnt(9)
    ds_write_b128 v21, v[140:143] offset:26624
    ds_write_b128 v21, v[144:147] offset:27648
    s_mov_b32 exec_hi, 0
    ds_write_b128 v21, v[148:151] offset:28672
    s_mov_b32 exec_hi, -1
    s_waitcnt vmcnt(6)
    ds_write_b128 v21, v[152:155] offset:36864
    ds_write_b128 v21, v[156:159] offset:37888
    s_mov_b32 exec_hi, 0
    ds_write_b128 v21, v[160:163] offset:38912
    s_mov_b32 exec_hi, -1
    s_waitcnt vmcnt(3)
    ds_write_b128 v21, v[164:167] offset:47104
    ds_write_b128 v21, v[168:171] offset:48128
    s_mov_b32 exec_hi, 0
    ds_write_b128 v21, v[172:175] offset:49152
    s_mov_b32 exec_hi, -1
    s_waitcnt lgkmcnt(0)
    s_barrier
    s_barrier
    s_barrier
    s_barrier
    s_add_u32 m0, s21, 0
    s_add_u32 s23, s20, 133120
    buffer_load_dwordx4 v1, s[8:11], s23 offen offset:0 lds
    buffer_load_dwordx4 v1, s[8:11], s23 offen offset:1024 lds
    s_mov_b32 exec_hi, 0
    buffer_load_dwordx4 v1, s[8:11], s23 offen offset:2048 lds
    s_mov_b32 exec_hi, -1
    s_barrier
    s_add_u32 m0, s21, 10240
    s_add_u32 s23, s20, 143360
    buffer_load_dwordx4 v1, s[8:11], s23 offen offset:0 lds
    buffer_load_dwordx4 v1, s[8:11], s23 offen offset:1024 lds
    s_mov_b32 exec_hi, 0
    buffer_load_dwordx4 v1, s[8:11], s23 offen offset:2048 lds
    s_mov_b32 exec_hi, -1
    s_add_u32 m0, s21, 20480
    s_add_u32 s23, s20, 153600
    buffer_load_dwordx4 v1, s[8:11], s23 offen offset:0 lds
    buffer_load_dwordx4 v1, s[8:11], s23 offen offset:1024 lds
    s_mov_b32 exec_hi, 0
    buffer_load_dwordx4 v1, s[8:11], s23 offen offset:2048 lds
    s_mov_b32 exec_hi, -1
    s_barrier
    s_add_u32 m0, s21, 30720
    s_add_u32 s23, s20, 163840
    buffer_load_dwordx4 v1, s[8:11], s23 offen offset:0 lds
    buffer_load_dwordx4 v1, s[8:11], s23 offen offset:1024 lds
    s_mov_b32 exec_hi, 0
    buffer_load_dwordx4 v1, s[8:11], s23 offen offset:2048 lds
    s_mov_b32 exec_hi, -1
    s_add_u32 m0, s21, 40960
    s_add_u32 s23, s20, 174080
    buffer_load_dwordx4 v1, s[8:11], s23 offen offset:0 lds
    buffer_load_dwordx4 v1, s[8:11], s23 offen offset:1024 lds
    s_mov_b32 exec_hi, 0
    buffer_load_dwordx4 v1, s[8:11], s23 offen offset:2048 lds
    s_mov_b32 exec_hi, -1
    s_barrier
    s_add_u32 m0, s21, 51200
    s_add_u32 s23, s20, 184320
    buffer_load_dwordx4 v1, s[8:11], s23 offen offset:0 lds
    buffer_load_dwordx4 v1, s[8:11], s23 offen offset:1024 lds
    s_mov_b32 exec_hi, 0
    buffer_load_dwordx4 v1, s[8:11], s23 offen offset:2048 lds
    s_mov_b32 exec_hi, -1
    s_add_u32 m0, s21, 61440
    s_add_u32 s23, s20, 194560
    buffer_load_dwordx4 v1, s[8:11], s23 offen offset:0 lds
    buffer_load_dwordx4 v1, s[8:11], s23 offen offset:1024 lds
    s_mov_b32 exec_hi, 0
    buffer_load_dwordx4 v1, s[8:11], s23 offen offset:2048 lds
    s_mov_b32 exec_hi, -1
    s_barrier
    s_add_u32 m0, s21, 71680
    s_add_u32 s23, s20, 204800
    buffer_load_dwordx4 v1, s[8:11], s23 offen offset:0 lds
    buffer_load_dwordx4 v1, s[8:11], s23 offen offset:1024 lds
    s_mov_b32 exec_hi, 0
    buffer_load_dwordx4 v1, s[8:11], s23 offen offset:2048 lds
    s_mov_b32 exec_hi, -1
    s_add_u32 m0, s21, 81920
    s_add_u32 s23, s20, 215040
    buffer_load_dwordx4 v1, s[8:11], s23 offen offset:0 lds
    buffer_load_dwordx4 v1, s[8:11], s23 offen offset:1024 lds
    s_mov_b32 exec_hi, 0
    buffer_load_dwordx4 v1, s[8:11], s23 offen offset:2048 lds
    s_mov_b32 exec_hi, -1
    s_waitcnt vmcnt(27)
    s_waitcnt vmcnt(24)
    s_barrier
    s_add_u32 m0, s21, 92160
    s_add_u32 s23, s20, 225280
    buffer_load_dwordx4 v1, s[8:11], s23 offen offset:0 lds
    buffer_load_dwordx4 v1, s[8:11], s23 offen offset:1024 lds
    s_mov_b32 exec_hi, 0
    buffer_load_dwordx4 v1, s[8:11], s23 offen offset:2048 lds
    s_mov_b32 exec_hi, -1
    s_add_u32 m0, s21, 102400
    s_add_u32 s23, s20, 235520
    buffer_load_dwordx4 v1, s[8:11], s23 offen offset:0 lds
    buffer_load_dwordx4 v1, s[8:11], s23 offen offset:1024 lds
    s_mov_b32 exec_hi, 0
    buffer_load_dwordx4 v1, s[8:11], s23 offen offset:2048 lds
    s_mov_b32 exec_hi, -1
    s_waitcnt vmcnt(27)
    s_waitcnt vmcnt(24)
    s_barrier
    s_and_b32 s98, s3, 3
    s_mul_i32 s93, s98, 3072
    s_mov_b32 s94, 286000640
    s_mov_b32 s95, 639704086
    s_lshl_b32 s96, s51, 3
    s_lshr_b64 s[94:95], s[94:95], s96
    s_and_b32 s92, s94, 0xff
    s_lshr_b32 s94, s98, 1
    s_mul_i32 s94, s94, 44
    s_add_u32 s92, s92, s94
    s_and_b32 s94, s98, 1
    s_mul_i32 s94, s94, 3
    s_add_u32 s92, s92, s94
    s_lshl_b32 s92, s92, 10
    s_add_u32 s92, s92, 0
    s_add_u32 s97, s92, 0
    buffer_load_dwordx4 v[32:35], v1, s[8:11], s97 offen offset:0
    buffer_load_dwordx4 v[36:39], v1, s[8:11], s97 offen offset:1024
    buffer_load_dwordx4 v[40:43], v1, s[8:11], s97 offen offset:2048
    s_add_u32 s97, s92, 90112
    buffer_load_dwordx4 v[44:47], v1, s[8:11], s97 offen offset:0
    buffer_load_dwordx4 v[48:51], v1, s[8:11], s97 offen offset:1024
    buffer_load_dwordx4 v[52:55], v1, s[8:11], s97 offen offset:2048
    s_waitcnt vmcnt(27)
    s_waitcnt vmcnt(24)
    s_barrier
    s_add_u32 s97, s92, 180224
    buffer_load_dwordx4 v[56:59], v1, s[8:11], s97 offen offset:0
    buffer_load_dwordx4 v[60:63], v1, s[8:11], s97 offen offset:1024
    buffer_load_dwordx4 v[64:67], v1, s[8:11], s97 offen offset:2048
    s_add_u32 s97, s92, 270336
    buffer_load_dwordx4 v[68:71], v1, s[8:11], s97 offen offset:0
    buffer_load_dwordx4 v[72:75], v1, s[8:11], s97 offen offset:1024
    buffer_load_dwordx4 v[76:79], v1, s[8:11], s97 offen offset:2048
    s_waitcnt vmcnt(27)
    s_waitcnt vmcnt(24)
    s_barrier
    s_add_u32 s97, s92, 360448
    buffer_load_dwordx4 v[80:83], v1, s[8:11], s97 offen offset:0
    buffer_load_dwordx4 v[84:87], v1, s[8:11], s97 offen offset:1024
    buffer_load_dwordx4 v[88:91], v1, s[8:11], s97 offen offset:2048
    s_add_u32 s97, s92, 450560
    buffer_load_dwordx4 v[92:95], v1, s[8:11], s97 offen offset:0
    buffer_load_dwordx4 v[96:99], v1, s[8:11], s97 offen offset:1024
    buffer_load_dwordx4 v[100:103], v1, s[8:11], s97 offen offset:2048
    s_waitcnt vmcnt(27)
    s_waitcnt vmcnt(24)
    s_barrier
    s_add_u32 s97, s92, 540672
    buffer_load_dwordx4 v[104:107], v1, s[8:11], s97 offen offset:0
    buffer_load_dwordx4 v[108:111], v1, s[8:11], s97 offen offset:1024
    buffer_load_dwordx4 v[112:115], v1, s[8:11], s97 offen offset:2048
    s_add_u32 s97, s92, 630784
    buffer_load_dwordx4 v[116:119], v1, s[8:11], s97 offen offset:0
    buffer_load_dwordx4 v[120:123], v1, s[8:11], s97 offen offset:1024
    buffer_load_dwordx4 v[124:127], v1, s[8:11], s97 offen offset:2048
    s_waitcnt vmcnt(27)
    s_waitcnt vmcnt(24)
    s_barrier
    s_add_u32 s97, s92, 720896
    buffer_load_dwordx4 v[128:131], v1, s[8:11], s97 offen offset:0
    buffer_load_dwordx4 v[132:135], v1, s[8:11], s97 offen offset:1024
    buffer_load_dwordx4 v[136:139], v1, s[8:11], s97 offen offset:2048
    s_add_u32 s97, s92, 811008
    buffer_load_dwordx4 v[140:143], v1, s[8:11], s97 offen offset:0
    buffer_load_dwordx4 v[144:147], v1, s[8:11], s97 offen offset:1024
    buffer_load_dwordx4 v[148:151], v1, s[8:11], s97 offen offset:2048
    s_barrier
    s_and_b32 s7, s3, 3
    s_mov_b32 s20, s92
    s_mov_b32 s21, s93
    v_lshlrev_b32 v1, 4, v0
    v_add_u32 v20, s93, v1
    v_add_u32 v21, 0x10000, v20
    s_waitcnt vmcnt(27)
    ds_write_b128 v20, v[32:35] offset:0
    ds_write_b128 v20, v[36:39] offset:1024
    ds_write_b128 v20, v[40:43] offset:2048
    s_waitcnt vmcnt(24)
    ds_write_b128 v20, v[44:47] offset:12288
    ds_write_b128 v20, v[48:51] offset:13312
    ds_write_b128 v20, v[52:55] offset:14336
    s_waitcnt vmcnt(21)
    ds_write_b128 v20, v[56:59] offset:24576
    ds_write_b128 v20, v[60:63] offset:25600
    ds_write_b128 v20, v[64:67] offset:26624
    s_waitcnt vmcnt(18)
    ds_write_b128 v20, v[68:71] offset:36864
    ds_write_b128 v20, v[72:75] offset:37888
    ds_write_b128 v20, v[76:79] offset:38912
    s_waitcnt vmcnt(15)
    ds_write_b128 v20, v[80:83] offset:49152
    ds_write_b128 v20, v[84:87] offset:50176
    ds_write_b128 v20, v[88:91] offset:51200
    s_waitcnt vmcnt(12)
    ds_write_b128 v20, v[92:95] offset:61440
    ds_write_b128 v20, v[96:99] offset:62464
    ds_write_b128 v20, v[100:103] offset:63488
    s_waitcnt vmcnt(9)
    ds_write_b128 v21, v[104:107] offset:8192
    ds_write_b128 v21, v[108:111] offset:9216
    ds_write_b128 v21, v[112:115] offset:10240
    s_waitcnt vmcnt(6)
    ds_write_b128 v21, v[116:119] offset:20480
    ds_write_b128 v21, v[120:123] offset:21504
    ds_write_b128 v21, v[124:127] offset:22528
    s_waitcnt vmcnt(3)
    ds_write_b128 v21, v[128:131] offset:32768
    ds_write_b128 v21, v[132:135] offset:33792
    ds_write_b128 v21, v[136:139] offset:34816
    s_waitcnt vmcnt(0)
    ds_write_b128 v21, v[140:143] offset:45056
    ds_write_b128 v21, v[144:147] offset:46080
    ds_write_b128 v21, v[148:151] offset:47104
    s_waitcnt lgkmcnt(0)
    s_barrier
    s_barrier
    s_barrier
    s_barrier
    s_barrier
    s_barrier
    s_barrier
    s_barrier
    s_barrier
    s_branch main_kernel_j1
main_kernel_c1:
    v_lshlrev_b32 v1, 4, v0
    v_and_b32 v6, 15, v0
    v_lshrrev_b32 v7, 4, v0
    s_and_b32 s7, s3, 1
    s_lshr_b32 s5, s3, 1
    s_lshl_b32 s4, s50, 2
    s_lshl_b32 s20, s7, 1
    s_add_u32 s4, s4, s20
    s_mul_i32 s22, s4, 20480
    s_lshl_b32 s20, s5, 10
    s_add_u32 s22, s22, s20
    s_add_u32 s22, s22, 20971520
    s_add_u32 s4, s4, s5
    s_mul_i32 s20, s5, 5120
    v_add_u32 v2, s20, v1
    v_add_u32 v3, 0x10000, v2
    v_add_u32 v4, 0x20000, v2
    v_add_u32 v5, 20480, v1
    v_lshrrev_b32 v10, 1, v7
    v_and_b32 v11, 1, v7
    v_lshlrev_b32 v8, 8, v10
    v_lshl_add_u32 v8, v6, 4, v8
    v_lshl_add_u32 v9, v11, 9, v8
    v_lshl_add_u32 v8, v11, 3, v8
    s_mul_i32 s24, s4, 20480
    s_mul_i32 s26, s51, 2560
    s_add_u32 s24, s24, s26
    s_add_u32 s25, s24, 8388608
    buffer_load_dwordx2 v[184:185], v8, s[8:11], s25 offen offset:0 sc1
    buffer_load_dwordx2 v[186:187], v8, s[8:11], s25 offen offset:512 sc1
    buffer_load_dwordx2 v[188:189], v8, s[8:11], s25 offen offset:1024 sc1
    buffer_load_dwordx2 v[190:191], v8, s[8:11], s25 offen offset:1536 sc1
    buffer_load_dwordx2 v[192:193], v8, s[8:11], s25 offen offset:2048 sc1
    s_cmp_lg_u32 s3, 0
    s_cbranch_scc1 main_kernel_poll3p
    v_lshlrev_b32 v250, 2, v0
    s_mov_b32 s45, 0x200000
    s_add_u32 s44, s59, 48250880
    s_mov_b64 exec, 255
main_kernel_poll3_0:
    buffer_load_dword v246, v250, s[8:11], s44 offen sc1
    s_waitcnt vmcnt(0)
    v_cmp_ne_u32 vcc, 1, v246
    s_sub_u32 s45, s45, 1
    s_cbranch_scc1 main_kernel_poll3d
    s_cmp_eq_u64 vcc, 0
    s_cbranch_scc0 main_kernel_poll3_0
    s_mov_b64 exec, -1
main_kernel_poll3d:
    s_mov_b64 exec, -1
    s_cmp_eq_u32 s84, 0
    s_cbranch_scc1 main_kernel_poll3p
    buffer_inv sc1
    s_waitcnt vmcnt(0)
main_kernel_poll3p:
    s_barrier
    s_add_u32 s23, s22, 0
    buffer_load_dwordx4 v[24:27], v1, s[8:11], s23 offen sc1
    buffer_load_dwordx4 v[28:31], v5, s[8:11], s23 offen sc1
    s_add_u32 s23, s22, 2048
    buffer_load_dwordx4 v[32:35], v1, s[8:11], s23 offen sc1
    buffer_load_dwordx4 v[36:39], v5, s[8:11], s23 offen sc1
    s_add_u32 s23, s22, 4096
    buffer_load_dwordx4 v[40:43], v1, s[8:11], s23 offen sc1
    buffer_load_dwordx4 v[44:47], v5, s[8:11], s23 offen sc1
    s_add_u32 s23, s22, 6144
    buffer_load_dwordx4 v[48:51], v1, s[8:11], s23 offen sc1
    buffer_load_dwordx4 v[52:55], v5, s[8:11], s23 offen sc1
    s_add_u32 s23, s22, 8192
    buffer_load_dwordx4 v[56:59], v1, s[8:11], s23 offen sc1
    buffer_load_dwordx4 v[60:63], v5, s[8:11], s23 offen sc1
    s_add_u32 s23, s22, 10240
    buffer_load_dwordx4 v[64:67], v1, s[8:11], s23 offen sc1
    buffer_load_dwordx4 v[68:71], v5, s[8:11], s23 offen sc1
    s_add_u32 s23, s22, 12288
    buffer_load_dwordx4 v[72:75], v1, s[8:11], s23 offen sc1
    buffer_load_dwordx4 v[76:79], v5, s[8:11], s23 offen sc1
    s_add_u32 s23, s22, 14336
    buffer_load_dwordx4 v[80:83], v1, s[8:11], s23 offen sc1
    buffer_load_dwordx4 v[84:87], v5, s[8:11], s23 offen sc1
    s_add_u32 s23, s22, 16384
    buffer_load_dwordx4 v[88:91], v1, s[8:11], s23 offen sc1
    buffer_load_dwordx4 v[92:95], v5, s[8:11], s23 offen sc1
    s_add_u32 s23, s22, 18432
    buffer_load_dwordx4 v[96:99], v1, s[8:11], s23 offen sc1
    buffer_load_dwordx4 v[100:103], v5, s[8:11], s23 offen sc1
    v_lshlrev_b32 v244, 7, v0
    s_mov_b64 exec, 1048575
    s_lshl_b32 s26, s4, 10
    s_add_u32 s26, s26, 47185920
    s_mov_b64 exec, 0xff
    buffer_load_dword v245, v244, s[8:11], s26 offen sc1
    s_mov_b64 exec, -1
    s_barrier
    ds_read_b128 v[104:107], v2 offset:0
    ds_read_b128 v[108:111], v2 offset:1024
    ds_read_b128 v[112:115], v2 offset:2048
    ds_read_b128 v[116:119], v2 offset:3072
    ds_read_b128 v[120:123], v2 offset:4096
    s_waitcnt vmcnt(19)
    s_waitcnt lgkmcnt(4)
    v_mfma_f32_16x16x32_bf16 v[144:147], v[104:107], v[24:27], 0
    v_mfma_f32_16x16x32_bf16 v[164:167], v[104:107], v[28:31], 0
    ds_read_b128 v[124:127], v2 offset:10240
    s_waitcnt lgkmcnt(4)
    v_mfma_f32_16x16x32_bf16 v[148:151], v[108:111], v[24:27], 0
    v_mfma_f32_16x16x32_bf16 v[168:171], v[108:111], v[28:31], 0
    ds_read_b128 v[128:131], v2 offset:11264
    s_waitcnt lgkmcnt(4)
    v_mfma_f32_16x16x32_bf16 v[152:155], v[112:115], v[24:27], 0
    v_mfma_f32_16x16x32_bf16 v[172:175], v[112:115], v[28:31], 0
    ds_read_b128 v[132:135], v2 offset:12288
    s_waitcnt lgkmcnt(4)
    v_mfma_f32_16x16x32_bf16 v[156:159], v[116:119], v[24:27], 0
    v_mfma_f32_16x16x32_bf16 v[176:179], v[116:119], v[28:31], 0
    ds_read_b128 v[136:139], v2 offset:13312
    s_waitcnt lgkmcnt(4)
    v_mfma_f32_16x16x32_bf16 v[160:163], v[120:123], v[24:27], 0
    v_mfma_f32_16x16x32_bf16 v[180:183], v[120:123], v[28:31], 0
    ds_read_b128 v[140:143], v2 offset:14336
    s_waitcnt vmcnt(17)
    s_waitcnt lgkmcnt(4)
    v_mfma_f32_16x16x32_bf16 v[144:147], v[124:127], v[32:35], v[144:147]
    v_mfma_f32_16x16x32_bf16 v[164:167], v[124:127], v[36:39], v[164:167]
    s_barrier
    ds_read_b128 v[104:107], v2 offset:20480
    s_waitcnt lgkmcnt(4)
    v_mfma_f32_16x16x32_bf16 v[148:151], v[128:131], v[32:35], v[148:151]
    v_mfma_f32_16x16x32_bf16 v[168:171], v[128:131], v[36:39], v[168:171]
    ds_read_b128 v[108:111], v2 offset:21504
    s_waitcnt lgkmcnt(4)
    v_mfma_f32_16x16x32_bf16 v[152:155], v[132:135], v[32:35], v[152:155]
    v_mfma_f32_16x16x32_bf16 v[172:175], v[132:135], v[36:39], v[172:175]
    ds_read_b128 v[112:115], v2 offset:22528
    s_waitcnt lgkmcnt(4)
    v_mfma_f32_16x16x32_bf16 v[156:159], v[136:139], v[32:35], v[156:159]
    v_mfma_f32_16x16x32_bf16 v[176:179], v[136:139], v[36:39], v[176:179]
    ds_read_b128 v[116:119], v2 offset:23552
    s_waitcnt lgkmcnt(4)
    v_mfma_f32_16x16x32_bf16 v[160:163], v[140:143], v[32:35], v[160:163]
    v_mfma_f32_16x16x32_bf16 v[180:183], v[140:143], v[36:39], v[180:183]
    ds_read_b128 v[120:123], v2 offset:24576
    s_waitcnt vmcnt(15)
    s_waitcnt lgkmcnt(4)
    v_mfma_f32_16x16x32_bf16 v[144:147], v[104:107], v[40:43], v[144:147]
    v_mfma_f32_16x16x32_bf16 v[164:167], v[104:107], v[44:47], v[164:167]
    ds_read_b128 v[124:127], v2 offset:30720
    s_waitcnt lgkmcnt(4)
    v_mfma_f32_16x16x32_bf16 v[148:151], v[108:111], v[40:43], v[148:151]
    v_mfma_f32_16x16x32_bf16 v[168:171], v[108:111], v[44:47], v[168:171]
    ds_read_b128 v[128:131], v2 offset:31744
    s_waitcnt lgkmcnt(4)
    v_mfma_f32_16x16x32_bf16 v[152:155], v[112:115], v[40:43], v[152:155]
    v_mfma_f32_16x16x32_bf16 v[172:175], v[112:115], v[44:47], v[172:175]
    ds_read_b128 v[132:135], v2 offset:32768
    s_waitcnt lgkmcnt(4)
    v_mfma_f32_16x16x32_bf16 v[156:159], v[116:119], v[40:43], v[156:159]
    v_mfma_f32_16x16x32_bf16 v[176:179], v[116:119], v[44:47], v[176:179]
    ds_read_b128 v[136:139], v2 offset:33792
    s_waitcnt lgkmcnt(4)
    v_mfma_f32_16x16x32_bf16 v[160:163], v[120:123], v[40:43], v[160:163]
    v_mfma_f32_16x16x32_bf16 v[180:183], v[120:123], v[44:47], v[180:183]
    ds_read_b128 v[140:143], v2 offset:34816
    s_waitcnt vmcnt(13)
    s_waitcnt lgkmcnt(4)
    v_mfma_f32_16x16x32_bf16 v[144:147], v[124:127], v[48:51], v[144:147]
    v_mfma_f32_16x16x32_bf16 v[164:167], v[124:127], v[52:55], v[164:167]
    s_barrier
    ds_read_b128 v[104:107], v2 offset:40960
    s_waitcnt lgkmcnt(4)
    v_mfma_f32_16x16x32_bf16 v[148:151], v[128:131], v[48:51], v[148:151]
    v_mfma_f32_16x16x32_bf16 v[168:171], v[128:131], v[52:55], v[168:171]
    ds_read_b128 v[108:111], v2 offset:41984
    s_waitcnt lgkmcnt(4)
    v_mfma_f32_16x16x32_bf16 v[152:155], v[132:135], v[48:51], v[152:155]
    v_mfma_f32_16x16x32_bf16 v[172:175], v[132:135], v[52:55], v[172:175]
    ds_read_b128 v[112:115], v2 offset:43008
    s_waitcnt lgkmcnt(4)
    v_mfma_f32_16x16x32_bf16 v[156:159], v[136:139], v[48:51], v[156:159]
    v_mfma_f32_16x16x32_bf16 v[176:179], v[136:139], v[52:55], v[176:179]
    ds_read_b128 v[116:119], v2 offset:44032
    s_waitcnt lgkmcnt(4)
    v_mfma_f32_16x16x32_bf16 v[160:163], v[140:143], v[48:51], v[160:163]
    v_mfma_f32_16x16x32_bf16 v[180:183], v[140:143], v[52:55], v[180:183]
    ds_read_b128 v[120:123], v2 offset:45056
    s_waitcnt vmcnt(11)
    s_waitcnt lgkmcnt(4)
    v_mfma_f32_16x16x32_bf16 v[144:147], v[104:107], v[56:59], v[144:147]
    v_mfma_f32_16x16x32_bf16 v[164:167], v[104:107], v[60:63], v[164:167]
    ds_read_b128 v[124:127], v2 offset:51200
    s_waitcnt lgkmcnt(4)
    v_mfma_f32_16x16x32_bf16 v[148:151], v[108:111], v[56:59], v[148:151]
    v_mfma_f32_16x16x32_bf16 v[168:171], v[108:111], v[60:63], v[168:171]
    ds_read_b128 v[128:131], v2 offset:52224
    s_waitcnt lgkmcnt(4)
    v_mfma_f32_16x16x32_bf16 v[152:155], v[112:115], v[56:59], v[152:155]
    v_mfma_f32_16x16x32_bf16 v[172:175], v[112:115], v[60:63], v[172:175]
    ds_read_b128 v[132:135], v2 offset:53248
    s_waitcnt lgkmcnt(4)
    v_mfma_f32_16x16x32_bf16 v[156:159], v[116:119], v[56:59], v[156:159]
    v_mfma_f32_16x16x32_bf16 v[176:179], v[116:119], v[60:63], v[176:179]
    ds_read_b128 v[136:139], v2 offset:54272
    s_waitcnt lgkmcnt(4)
    v_mfma_f32_16x16x32_bf16 v[160:163], v[120:123], v[56:59], v[160:163]
    v_mfma_f32_16x16x32_bf16 v[180:183], v[120:123], v[60:63], v[180:183]
    ds_read_b128 v[140:143], v2 offset:55296
    s_waitcnt vmcnt(9)
    s_waitcnt lgkmcnt(4)
    v_mfma_f32_16x16x32_bf16 v[144:147], v[124:127], v[64:67], v[144:147]
    v_mfma_f32_16x16x32_bf16 v[164:167], v[124:127], v[68:71], v[164:167]
    s_barrier
    ds_read_b128 v[104:107], v2 offset:61440
    s_waitcnt lgkmcnt(4)
    v_mfma_f32_16x16x32_bf16 v[148:151], v[128:131], v[64:67], v[148:151]
    v_mfma_f32_16x16x32_bf16 v[168:171], v[128:131], v[68:71], v[168:171]
    ds_read_b128 v[108:111], v2 offset:62464
    s_waitcnt lgkmcnt(4)
    v_mfma_f32_16x16x32_bf16 v[152:155], v[132:135], v[64:67], v[152:155]
    v_mfma_f32_16x16x32_bf16 v[172:175], v[132:135], v[68:71], v[172:175]
    ds_read_b128 v[112:115], v2 offset:63488
    s_waitcnt lgkmcnt(4)
    v_mfma_f32_16x16x32_bf16 v[156:159], v[136:139], v[64:67], v[156:159]
    v_mfma_f32_16x16x32_bf16 v[176:179], v[136:139], v[68:71], v[176:179]
    ds_read_b128 v[116:119], v2 offset:64512
    s_waitcnt lgkmcnt(4)
    v_mfma_f32_16x16x32_bf16 v[160:163], v[140:143], v[64:67], v[160:163]
    v_mfma_f32_16x16x32_bf16 v[180:183], v[140:143], v[68:71], v[180:183]
    ds_read_b128 v[120:123], v3 offset:0
    s_waitcnt vmcnt(7)
    s_waitcnt lgkmcnt(4)
    v_mfma_f32_16x16x32_bf16 v[144:147], v[104:107], v[72:75], v[144:147]
    v_mfma_f32_16x16x32_bf16 v[164:167], v[104:107], v[76:79], v[164:167]
    ds_read_b128 v[124:127], v3 offset:6144
    s_waitcnt lgkmcnt(4)
    v_mfma_f32_16x16x32_bf16 v[148:151], v[108:111], v[72:75], v[148:151]
    v_mfma_f32_16x16x32_bf16 v[168:171], v[108:111], v[76:79], v[168:171]
    ds_read_b128 v[128:131], v3 offset:7168
    s_waitcnt lgkmcnt(4)
    v_mfma_f32_16x16x32_bf16 v[152:155], v[112:115], v[72:75], v[152:155]
    v_mfma_f32_16x16x32_bf16 v[172:175], v[112:115], v[76:79], v[172:175]
    ds_read_b128 v[132:135], v3 offset:8192
    s_waitcnt lgkmcnt(4)
    v_mfma_f32_16x16x32_bf16 v[156:159], v[116:119], v[72:75], v[156:159]
    v_mfma_f32_16x16x32_bf16 v[176:179], v[116:119], v[76:79], v[176:179]
    ds_read_b128 v[136:139], v3 offset:9216
    s_waitcnt lgkmcnt(4)
    v_mfma_f32_16x16x32_bf16 v[160:163], v[120:123], v[72:75], v[160:163]
    v_mfma_f32_16x16x32_bf16 v[180:183], v[120:123], v[76:79], v[180:183]
    ds_read_b128 v[140:143], v3 offset:10240
    s_waitcnt vmcnt(5)
    s_waitcnt lgkmcnt(4)
    v_mfma_f32_16x16x32_bf16 v[144:147], v[124:127], v[80:83], v[144:147]
    v_mfma_f32_16x16x32_bf16 v[164:167], v[124:127], v[84:87], v[164:167]
    s_barrier
    ds_read_b128 v[104:107], v3 offset:16384
    s_waitcnt lgkmcnt(4)
    v_mfma_f32_16x16x32_bf16 v[148:151], v[128:131], v[80:83], v[148:151]
    v_mfma_f32_16x16x32_bf16 v[168:171], v[128:131], v[84:87], v[168:171]
    ds_read_b128 v[108:111], v3 offset:17408
    s_waitcnt lgkmcnt(4)
    v_mfma_f32_16x16x32_bf16 v[152:155], v[132:135], v[80:83], v[152:155]
    v_mfma_f32_16x16x32_bf16 v[172:175], v[132:135], v[84:87], v[172:175]
    ds_read_b128 v[112:115], v3 offset:18432
    s_waitcnt lgkmcnt(4)
    v_mfma_f32_16x16x32_bf16 v[156:159], v[136:139], v[80:83], v[156:159]
    v_mfma_f32_16x16x32_bf16 v[176:179], v[136:139], v[84:87], v[176:179]
    ds_read_b128 v[116:119], v3 offset:19456
    s_waitcnt lgkmcnt(4)
    v_mfma_f32_16x16x32_bf16 v[160:163], v[140:143], v[80:83], v[160:163]
    v_mfma_f32_16x16x32_bf16 v[180:183], v[140:143], v[84:87], v[180:183]
    ds_read_b128 v[120:123], v3 offset:20480
    s_waitcnt vmcnt(3)
    s_waitcnt lgkmcnt(4)
    v_mfma_f32_16x16x32_bf16 v[144:147], v[104:107], v[88:91], v[144:147]
    v_mfma_f32_16x16x32_bf16 v[164:167], v[104:107], v[92:95], v[164:167]
    ds_read_b128 v[124:127], v3 offset:26624
    s_waitcnt lgkmcnt(4)
    v_mfma_f32_16x16x32_bf16 v[148:151], v[108:111], v[88:91], v[148:151]
    v_mfma_f32_16x16x32_bf16 v[168:171], v[108:111], v[92:95], v[168:171]
    ds_read_b128 v[128:131], v3 offset:27648
    s_waitcnt lgkmcnt(4)
    v_mfma_f32_16x16x32_bf16 v[152:155], v[112:115], v[88:91], v[152:155]
    v_mfma_f32_16x16x32_bf16 v[172:175], v[112:115], v[92:95], v[172:175]
    ds_read_b128 v[132:135], v3 offset:28672
    s_waitcnt lgkmcnt(4)
    v_mfma_f32_16x16x32_bf16 v[156:159], v[116:119], v[88:91], v[156:159]
    v_mfma_f32_16x16x32_bf16 v[176:179], v[116:119], v[92:95], v[176:179]
    ds_read_b128 v[136:139], v3 offset:29696
    s_waitcnt lgkmcnt(4)
    v_mfma_f32_16x16x32_bf16 v[160:163], v[120:123], v[88:91], v[160:163]
    v_mfma_f32_16x16x32_bf16 v[180:183], v[120:123], v[92:95], v[180:183]
    ds_read_b128 v[140:143], v3 offset:30720
    s_waitcnt vmcnt(1)
    s_waitcnt lgkmcnt(4)
    v_mfma_f32_16x16x32_bf16 v[144:147], v[124:127], v[96:99], v[144:147]
    v_mfma_f32_16x16x32_bf16 v[164:167], v[124:127], v[100:103], v[164:167]
    s_waitcnt lgkmcnt(3)
    v_mfma_f32_16x16x32_bf16 v[148:151], v[128:131], v[96:99], v[148:151]
    v_mfma_f32_16x16x32_bf16 v[168:171], v[128:131], v[100:103], v[168:171]
    s_waitcnt lgkmcnt(2)
    v_mfma_f32_16x16x32_bf16 v[152:155], v[132:135], v[96:99], v[152:155]
    v_mfma_f32_16x16x32_bf16 v[172:175], v[132:135], v[100:103], v[172:175]
    s_waitcnt lgkmcnt(1)
    v_mfma_f32_16x16x32_bf16 v[156:159], v[136:139], v[96:99], v[156:159]
    v_mfma_f32_16x16x32_bf16 v[176:179], v[136:139], v[100:103], v[176:179]
    s_waitcnt lgkmcnt(0)
    v_mfma_f32_16x16x32_bf16 v[160:163], v[140:143], v[96:99], v[160:163]
    v_mfma_f32_16x16x32_bf16 v[180:183], v[140:143], v[100:103], v[180:183]
    s_mul_i32 s20, s3, 5120
    s_xor_b32 s21, s3, 2
    s_mul_i32 s21, s21, 5120
    s_add_u32 s20, s20, 139264
    s_add_u32 s21, s21, 139264
    v_add_u32 v2, s20, v1
    v_add_u32 v3, s21, v1
    s_cmp_eq_u32 s5, 0
    s_cbranch_scc1 main_kernel_kh0_2
    ds_write_b128 v2, v[144:147] offset:0
    ds_write_b128 v2, v[148:151] offset:1024
    ds_write_b128 v2, v[152:155] offset:2048
    ds_write_b128 v2, v[156:159] offset:3072
    ds_write_b128 v2, v[160:163] offset:4096
    s_nop 0
    v_pk_mov_b32 v[144:145], v[164:165], v[164:165] op_sel:[0,1]
    v_pk_mov_b32 v[146:147], v[166:167], v[166:167] op_sel:[0,1]
    v_pk_mov_b32 v[148:149], v[168:169], v[168:169] op_sel:[0,1]
    v_pk_mov_b32 v[150:151], v[170:171], v[170:171] op_sel:[0,1]
    v_pk_mov_b32 v[152:153], v[172:173], v[172:173] op_sel:[0,1]
    v_pk_mov_b32 v[154:155], v[174:175], v[174:175] op_sel:[0,1]
    v_pk_mov_b32 v[156:157], v[176:177], v[176:177] op_sel:[0,1]
    v_pk_mov_b32 v[158:159], v[178:179], v[178:179] op_sel:[0,1]
    v_pk_mov_b32 v[160:161], v[180:181], v[180:181] op_sel:[0,1]
    v_pk_mov_b32 v[162:163], v[182:183], v[182:183] op_sel:[0,1]
    s_branch main_kernel_red_2
main_kernel_kh0_2:
    ds_write_b128 v2, v[164:167] offset:0
    ds_write_b128 v2, v[168:171] offset:1024
    ds_write_b128 v2, v[172:175] offset:2048
    ds_write_b128 v2, v[176:179] offset:3072
    ds_write_b128 v2, v[180:183] offset:4096
main_kernel_red_2:
    s_waitcnt lgkmcnt(0)
    s_barrier
    ds_read_b128 v[164:167], v3 offset:0
    ds_read_b128 v[168:171], v3 offset:1024
    ds_read_b128 v[172:175], v3 offset:2048
    ds_read_b128 v[176:179], v3 offset:3072
    ds_read_b128 v[180:183], v3 offset:4096
    v_lshlrev_b32 v24, 16, v184
    v_and_b32 v25, 0xffff0000, v184
    v_lshlrev_b32 v26, 16, v185
    v_and_b32 v27, 0xffff0000, v185
    v_pk_add_f32 v[144:145], v[24:25], v[144:145]
    v_pk_add_f32 v[146:147], v[26:27], v[146:147]
    v_lshlrev_b32 v28, 16, v186
    v_and_b32 v29, 0xffff0000, v186
    v_lshlrev_b32 v30, 16, v187
    v_and_b32 v31, 0xffff0000, v187
    v_pk_add_f32 v[148:149], v[28:29], v[148:149]
    v_pk_add_f32 v[150:151], v[30:31], v[150:151]
    v_lshlrev_b32 v32, 16, v188
    v_and_b32 v33, 0xffff0000, v188
    v_lshlrev_b32 v34, 16, v189
    v_and_b32 v35, 0xffff0000, v189
    v_pk_add_f32 v[152:153], v[32:33], v[152:153]
    v_pk_add_f32 v[154:155], v[34:35], v[154:155]
    v_lshlrev_b32 v36, 16, v190
    v_and_b32 v37, 0xffff0000, v190
    v_lshlrev_b32 v38, 16, v191
    v_and_b32 v39, 0xffff0000, v191
    v_pk_add_f32 v[156:157], v[36:37], v[156:157]
    v_pk_add_f32 v[158:159], v[38:39], v[158:159]
    v_lshlrev_b32 v40, 16, v192
    v_and_b32 v41, 0xffff0000, v192
    v_lshlrev_b32 v42, 16, v193
    v_and_b32 v43, 0xffff0000, v193
    v_pk_add_f32 v[160:161], v[40:41], v[160:161]
    v_pk_add_f32 v[162:163], v[42:43], v[162:163]
    s_add_u32 s25, s24, 8388608
    s_waitcnt lgkmcnt(4)
    v_pk_add_f32 v[144:145], v[144:145], v[164:165]
    v_pk_add_f32 v[146:147], v[146:147], v[166:167]
    v_cvt_pk_bf16_f32 v104, v144, v145
    v_cvt_pk_bf16_f32 v105, v146, v147
    s_waitcnt lgkmcnt(3)
    v_pk_add_f32 v[148:149], v[148:149], v[168:169]
    v_pk_add_f32 v[150:151], v[150:151], v[170:171]
    v_cvt_pk_bf16_f32 v106, v148, v149
    v_cvt_pk_bf16_f32 v107, v150, v151
    s_nop 1
    v_permlane16_swap_b32 v104, v106
    v_permlane16_swap_b32 v105, v107
    buffer_store_dwordx4 v[104:107], v9, s[8:11], s25 offen offset:0
    s_waitcnt lgkmcnt(2)
    v_pk_add_f32 v[152:153], v[152:153], v[172:173]
    v_pk_add_f32 v[154:155], v[154:155], v[174:175]
    v_cvt_pk_bf16_f32 v108, v152, v153
    v_cvt_pk_bf16_f32 v109, v154, v155
    s_waitcnt lgkmcnt(1)
    v_pk_add_f32 v[156:157], v[156:157], v[176:177]
    v_pk_add_f32 v[158:159], v[158:159], v[178:179]
    v_cvt_pk_bf16_f32 v110, v156, v157
    v_cvt_pk_bf16_f32 v111, v158, v159
    s_nop 1
    v_permlane16_swap_b32 v108, v110
    v_permlane16_swap_b32 v109, v111
    buffer_store_dwordx4 v[108:111], v9, s[8:11], s25 offen offset:1024
    s_waitcnt lgkmcnt(0)
    v_pk_add_f32 v[160:161], v[160:161], v[180:181]
    v_pk_add_f32 v[162:163], v[162:163], v[182:183]
    v_cvt_pk_bf16_f32 v112, v160, v161
    v_cvt_pk_bf16_f32 v113, v162, v163
    buffer_store_dwordx2 v[112:113], v8, s[8:11], s25 offen offset:2048
    v_pk_add_f32 v[10:11], v[144:145], v[146:147]
    v_pk_mul_f32 v[12:13], v[144:145], v[144:145]
    v_pk_fma_f32 v[12:13], v[146:147], v[146:147], v[12:13]
    v_pk_add_f32 v[10:11], v[10:11], v[148:149]
    v_pk_fma_f32 v[12:13], v[148:149], v[148:149], v[12:13]
    v_pk_add_f32 v[10:11], v[10:11], v[150:151]
    v_pk_fma_f32 v[12:13], v[150:151], v[150:151], v[12:13]
    v_pk_add_f32 v[10:11], v[10:11], v[152:153]
    v_pk_fma_f32 v[12:13], v[152:153], v[152:153], v[12:13]
    v_pk_add_f32 v[10:11], v[10:11], v[154:155]
    v_pk_fma_f32 v[12:13], v[154:155], v[154:155], v[12:13]
    v_pk_add_f32 v[10:11], v[10:11], v[156:157]
    v_pk_fma_f32 v[12:13], v[156:157], v[156:157], v[12:13]
    v_pk_add_f32 v[10:11], v[10:11], v[158:159]
    v_pk_fma_f32 v[12:13], v[158:159], v[158:159], v[12:13]
    v_pk_add_f32 v[10:11], v[10:11], v[160:161]
    v_pk_fma_f32 v[12:13], v[160:161], v[160:161], v[12:13]
    v_pk_add_f32 v[10:11], v[10:11], v[162:163]
    v_pk_fma_f32 v[12:13], v[162:163], v[162:163], v[12:13]
    v_add_f32 v10, v10, v11
    v_add_f32 v11, v12, v13
    v_mov_b32 v12, v10
    s_nop 1
    v_permlane32_swap_b32 v10, v12
    s_nop 1
    v_add_f32 v10, v10, v12
    v_mov_b32 v13, v11
    s_nop 1
    v_permlane32_swap_b32 v11, v13
    s_nop 1
    v_add_f32 v11, v11, v13
    v_mov_b32 v12, v10
    s_nop 1
    v_permlane16_swap_b32 v10, v12
    s_nop 1
    v_add_f32 v10, v10, v12
    v_mov_b32 v13, v11
    s_nop 1
    v_permlane16_swap_b32 v11, v13
    s_nop 1
    v_add_f32 v11, v11, v13
    s_lshl_b32 s24, s4, 10
    s_lshl_b32 s25, s51, 3
    s_add_u32 s24, s24, s25
    s_add_u32 s24, s24, 47185920
    v_lshlrev_b32 v12, 6, v6
    s_mov_b64 exec, 0xffff
    buffer_store_dwordx2 v[10:11], v12, s[8:11], s24 offen
    s_mov_b64 exec, -1
    s_waitcnt vmcnt(0)
    s_barrier
    s_cmp_lg_u32 s3, 0
    s_cbranch_scc1 main_kernel_sig4
    s_add_u32 s44, s52, 48267264
    v_mov_b32 v246, 1
    s_mov_b64 exec, 1
    s_cmp_lg_u32 s84, 0
    s_cbranch_scc1 main_kernel_sig4s
    buffer_store_dword v246, off, s[8:11], s44
    s_branch main_kernel_sig4e
main_kernel_sig4s:
    buffer_wbl2 sc1
    s_waitcnt vmcnt(0)
    buffer_store_dword v246, off, s[8:11], s44 sc1
main_kernel_sig4e:
    s_mov_b64 exec, -1
main_kernel_sig4:
    v_lshlrev_b32 v1, 4, v0
    v_and_b32 v6, 15, v0
    v_bfe_u32 v7, v0, 4, 1
    v_lshrrev_b32 v8, 5, v0
    v_lshlrev_b32 v6, 4, v6
    v_lshl_add_u32 v6, v8, 8, v6
    s_and_b32 s7, s3, 1
    s_lshr_b32 s5, s3, 1
    s_lshl_b32 s4, s53, 2
    s_lshl_b32 s20, s7, 1
    s_add_u32 s4, s4, s20
    s_mul_i32 s20, s5, 3072
    v_add_u32 v2, s20, v1
    v_add_u32 v3, 0x10000, v2
    s_lshl_b32 s21, s7, 12
    s_add_u32 s21, s21, 98304
    v_add_u32 v18, s21, v1
    v_mul_u32_u24 v5, 49152, v7
    v_add_u32 v5, v5, v6
    v_and_b32 v9, 31, v0
    v_lshlrev_b32 v9, 6, v9
    v_lshl_add_u32 v9, v8, 5, v9
    s_lshl_b32 s24, s4, 11
    s_add_u32 s24, s24, 47185920
    s_lshl_b32 s26, s53, 8
    s_cmp_lg_u32 s3, 0
    s_cbranch_scc1 main_kernel_poll5p
    v_lshlrev_b32 v250, 2, v0
    s_mov_b32 s45, 0x200000
    s_add_u32 s44, s26, 48267264
    s_mov_b64 exec, 65535
main_kernel_poll5_0:
    buffer_load_dword v246, v250, s[8:11], s44 offen sc1
    s_waitcnt vmcnt(0)
    v_cmp_ne_u32 vcc, 1, v246
    s_sub_u32 s45, s45, 1
    s_cbranch_scc1 main_kernel_poll5d
    s_cmp_eq_u64 vcc, 0
    s_cbranch_scc0 main_kernel_poll5_0
    s_mov_b64 exec, -1
main_kernel_poll5d:
    s_mov_b64 exec, -1
    s_cmp_eq_u32 s84, 0
    s_cbranch_scc1 main_kernel_poll5p
    buffer_inv sc1
    s_waitcnt vmcnt(0)
main_kernel_poll5p:
    s_barrier
    buffer_load_dwordx4 v[24:27], v9, s[8:11], s24 offen offset:0 sc1
    buffer_load_dwordx4 v[28:31], v9, s[8:11], s24 offen offset:16 sc1
    buffer_load_dwordx4 v[32:35], v9, s[8:11], s24 offen offset:2048 sc1
    buffer_load_dwordx4 v[36:39], v9, s[8:11], s24 offen offset:2064 sc1
    s_mul_i32 s24, s4, 98304
    s_mul_i32 s25, s54, 3072
    s_add_u32 s24, s24, s25
    s_mul_i32 s25, s5, 1536
    s_add_u32 s24, s24, s25
    s_add_u32 s24, s24, 33554432
    s_add_u32 s25, s24, 98304
    s_barrier
    ds_read_b128 v[148:151], v18 offset:0
    ds_read_b128 v[152:155], v18 offset:2048
    ds_read_b128 v[136:139], v2 offset:0
    ds_read_b128 v[140:143], v2 offset:1024
    ds_read_b128 v[144:147], v2 offset:2048
    s_waitcnt lgkmcnt(2)
    v_mfma_f32_32x32x16_bf16 v[40:55], v[136:139], v[148:151], 0
    ds_read_b128 v[172:175], v18 offset:1024
    v_mfma_f32_32x32x16_bf16 v[88:103], v[136:139], v[152:155], 0
    ds_read_b128 v[176:179], v18 offset:3072
    s_waitcnt lgkmcnt(3)
    v_mfma_f32_32x32x16_bf16 v[56:71], v[140:143], v[148:151], 0
    ds_read_b128 v[160:163], v2 offset:6144
    v_mfma_f32_32x32x16_bf16 v[104:119], v[140:143], v[152:155], 0
    ds_read_b128 v[164:167], v2 offset:7168
    s_waitcnt lgkmcnt(4)
    v_mfma_f32_32x32x16_bf16 v[72:87], v[144:147], v[148:151], 0
    ds_read_b128 v[168:171], v2 offset:8192
    v_mfma_f32_32x32x16_bf16 v[120:135], v[144:147], v[152:155], 0
    s_waitcnt lgkmcnt(2)
    v_mfma_f32_32x32x16_bf16 v[40:55], v[160:163], v[172:175], v[40:55]
    s_barrier
    ds_read_b128 v[148:151], v18 offset:8192
    v_mfma_f32_32x32x16_bf16 v[88:103], v[160:163], v[176:179], v[88:103]
    ds_read_b128 v[152:155], v18 offset:10240
    s_waitcnt lgkmcnt(3)
    v_mfma_f32_32x32x16_bf16 v[56:71], v[164:167], v[172:175], v[56:71]
    ds_read_b128 v[136:139], v2 offset:12288
    v_mfma_f32_32x32x16_bf16 v[104:119], v[164:167], v[176:179], v[104:119]
    ds_read_b128 v[140:143], v2 offset:13312
    s_waitcnt lgkmcnt(4)
    v_mfma_f32_32x32x16_bf16 v[72:87], v[168:171], v[172:175], v[72:87]
    ds_read_b128 v[144:147], v2 offset:14336
    v_mfma_f32_32x32x16_bf16 v[120:135], v[168:171], v[176:179], v[120:135]
    s_waitcnt lgkmcnt(2)
    v_mfma_f32_32x32x16_bf16 v[40:55], v[136:139], v[148:151], v[40:55]
    ds_read_b128 v[172:175], v18 offset:9216
    v_mfma_f32_32x32x16_bf16 v[88:103], v[136:139], v[152:155], v[88:103]
    ds_read_b128 v[176:179], v18 offset:11264
    s_waitcnt lgkmcnt(3)
    v_mfma_f32_32x32x16_bf16 v[56:71], v[140:143], v[148:151], v[56:71]
    ds_read_b128 v[160:163], v2 offset:18432
    v_mfma_f32_32x32x16_bf16 v[104:119], v[140:143], v[152:155], v[104:119]
    ds_read_b128 v[164:167], v2 offset:19456
    s_waitcnt lgkmcnt(4)
    v_mfma_f32_32x32x16_bf16 v[72:87], v[144:147], v[148:151], v[72:87]
    ds_read_b128 v[168:171], v2 offset:20480
    v_mfma_f32_32x32x16_bf16 v[120:135], v[144:147], v[152:155], v[120:135]
    s_waitcnt lgkmcnt(2)
    v_mfma_f32_32x32x16_bf16 v[40:55], v[160:163], v[172:175], v[40:55]
    s_barrier
    ds_read_b128 v[148:151], v18 offset:16384
    v_mfma_f32_32x32x16_bf16 v[88:103], v[160:163], v[176:179], v[88:103]
    ds_read_b128 v[152:155], v18 offset:18432
    s_waitcnt lgkmcnt(3)
    v_mfma_f32_32x32x16_bf16 v[56:71], v[164:167], v[172:175], v[56:71]
    ds_read_b128 v[136:139], v2 offset:24576
    v_mfma_f32_32x32x16_bf16 v[104:119], v[164:167], v[176:179], v[104:119]
    ds_read_b128 v[140:143], v2 offset:25600
    s_waitcnt lgkmcnt(4)
    v_mfma_f32_32x32x16_bf16 v[72:87], v[168:171], v[172:175], v[72:87]
    ds_read_b128 v[144:147], v2 offset:26624
    v_mfma_f32_32x32x16_bf16 v[120:135], v[168:171], v[176:179], v[120:135]
    s_waitcnt lgkmcnt(2)
    v_mfma_f32_32x32x16_bf16 v[40:55], v[136:139], v[148:151], v[40:55]
    ds_read_b128 v[172:175], v18 offset:17408
    v_mfma_f32_32x32x16_bf16 v[88:103], v[136:139], v[152:155], v[88:103]
    ds_read_b128 v[176:179], v18 offset:19456
    s_waitcnt lgkmcnt(3)
    v_mfma_f32_32x32x16_bf16 v[56:71], v[140:143], v[148:151], v[56:71]
    ds_read_b128 v[160:163], v2 offset:30720
    v_mfma_f32_32x32x16_bf16 v[104:119], v[140:143], v[152:155], v[104:119]
    ds_read_b128 v[164:167], v2 offset:31744
    s_waitcnt lgkmcnt(4)
    v_mfma_f32_32x32x16_bf16 v[72:87], v[144:147], v[148:151], v[72:87]
    ds_read_b128 v[168:171], v2 offset:32768
    v_mfma_f32_32x32x16_bf16 v[120:135], v[144:147], v[152:155], v[120:135]
    s_waitcnt lgkmcnt(2)
    v_mfma_f32_32x32x16_bf16 v[40:55], v[160:163], v[172:175], v[40:55]
    s_barrier
    ds_read_b128 v[148:151], v18 offset:24576
    v_mfma_f32_32x32x16_bf16 v[88:103], v[160:163], v[176:179], v[88:103]
    ds_read_b128 v[152:155], v18 offset:26624
    s_waitcnt lgkmcnt(3)
    v_mfma_f32_32x32x16_bf16 v[56:71], v[164:167], v[172:175], v[56:71]
    ds_read_b128 v[136:139], v2 offset:36864
    v_mfma_f32_32x32x16_bf16 v[104:119], v[164:167], v[176:179], v[104:119]
    ds_read_b128 v[140:143], v2 offset:37888
    s_waitcnt lgkmcnt(4)
    v_mfma_f32_32x32x16_bf16 v[72:87], v[168:171], v[172:175], v[72:87]
    ds_read_b128 v[144:147], v2 offset:38912
    v_mfma_f32_32x32x16_bf16 v[120:135], v[168:171], v[176:179], v[120:135]
    s_waitcnt lgkmcnt(2)
    v_mfma_f32_32x32x16_bf16 v[40:55], v[136:139], v[148:151], v[40:55]
    ds_read_b128 v[172:175], v18 offset:25600
    v_mfma_f32_32x32x16_bf16 v[88:103], v[136:139], v[152:155], v[88:103]
    ds_read_b128 v[176:179], v18 offset:27648
    s_waitcnt lgkmcnt(3)
    v_mfma_f32_32x32x16_bf16 v[56:71], v[140:143], v[148:151], v[56:71]
    ds_read_b128 v[160:163], v2 offset:43008
    v_mfma_f32_32x32x16_bf16 v[104:119], v[140:143], v[152:155], v[104:119]
    ds_read_b128 v[164:167], v2 offset:44032
    s_waitcnt lgkmcnt(4)
    v_mfma_f32_32x32x16_bf16 v[72:87], v[144:147], v[148:151], v[72:87]
    ds_read_b128 v[168:171], v2 offset:45056
    v_mfma_f32_32x32x16_bf16 v[120:135], v[144:147], v[152:155], v[120:135]
    s_waitcnt lgkmcnt(2)
    v_mfma_f32_32x32x16_bf16 v[40:55], v[160:163], v[172:175], v[40:55]
    s_barrier
    ds_read_b128 v[148:151], v18 offset:32768
    v_mfma_f32_32x32x16_bf16 v[88:103], v[160:163], v[176:179], v[88:103]
    ds_read_b128 v[152:155], v18 offset:34816
    s_waitcnt lgkmcnt(3)
    v_mfma_f32_32x32x16_bf16 v[56:71], v[164:167], v[172:175], v[56:71]
    ds_read_b128 v[136:139], v2 offset:49152
    v_mfma_f32_32x32x16_bf16 v[104:119], v[164:167], v[176:179], v[104:119]
    ds_read_b128 v[140:143], v2 offset:50176
    s_waitcnt lgkmcnt(4)
    v_mfma_f32_32x32x16_bf16 v[72:87], v[168:171], v[172:175], v[72:87]
    ds_read_b128 v[144:147], v2 offset:51200
    v_mfma_f32_32x32x16_bf16 v[120:135], v[168:171], v[176:179], v[120:135]
    s_waitcnt lgkmcnt(2)
    v_mfma_f32_32x32x16_bf16 v[40:55], v[136:139], v[148:151], v[40:55]
    ds_read_b128 v[172:175], v18 offset:33792
    v_mfma_f32_32x32x16_bf16 v[88:103], v[136:139], v[152:155], v[88:103]
    ds_read_b128 v[176:179], v18 offset:35840
    s_waitcnt lgkmcnt(3)
    v_mfma_f32_32x32x16_bf16 v[56:71], v[140:143], v[148:151], v[56:71]
    ds_read_b128 v[160:163], v2 offset:55296
    v_mfma_f32_32x32x16_bf16 v[104:119], v[140:143], v[152:155], v[104:119]
    ds_read_b128 v[164:167], v2 offset:56320
    s_waitcnt lgkmcnt(4)
    v_mfma_f32_32x32x16_bf16 v[72:87], v[144:147], v[148:151], v[72:87]
    ds_read_b128 v[168:171], v2 offset:57344
    v_mfma_f32_32x32x16_bf16 v[120:135], v[144:147], v[152:155], v[120:135]
    s_waitcnt lgkmcnt(2)
    v_mfma_f32_32x32x16_bf16 v[40:55], v[160:163], v[172:175], v[40:55]
    s_barrier
    ds_read_b128 v[148:151], v18 offset:40960
    v_mfma_f32_32x32x16_bf16 v[88:103], v[160:163], v[176:179], v[88:103]
    ds_read_b128 v[152:155], v18 offset:43008
    s_waitcnt lgkmcnt(3)
    v_mfma_f32_32x32x16_bf16 v[56:71], v[164:167], v[172:175], v[56:71]
    ds_read_b128 v[136:139], v2 offset:61440
    v_mfma_f32_32x32x16_bf16 v[104:119], v[164:167], v[176:179], v[104:119]
    ds_read_b128 v[140:143], v2 offset:62464
    s_waitcnt lgkmcnt(4)
    v_mfma_f32_32x32x16_bf16 v[72:87], v[168:171], v[172:175], v[72:87]
    ds_read_b128 v[144:147], v2 offset:63488
    v_mfma_f32_32x32x16_bf16 v[120:135], v[168:171], v[176:179], v[120:135]
    s_waitcnt lgkmcnt(2)
    v_mfma_f32_32x32x16_bf16 v[40:55], v[136:139], v[148:151], v[40:55]
    ds_read_b128 v[172:175], v18 offset:41984
    v_mfma_f32_32x32x16_bf16 v[88:103], v[136:139], v[152:155], v[88:103]
    ds_read_b128 v[176:179], v18 offset:44032
    s_waitcnt lgkmcnt(3)
    v_mfma_f32_32x32x16_bf16 v[56:71], v[140:143], v[148:151], v[56:71]
    ds_read_b128 v[160:163], v3 offset:2048
    v_mfma_f32_32x32x16_bf16 v[104:119], v[140:143], v[152:155], v[104:119]
    ds_read_b128 v[164:167], v3 offset:3072
    s_waitcnt lgkmcnt(4)
    v_mfma_f32_32x32x16_bf16 v[72:87], v[144:147], v[148:151], v[72:87]
    ds_read_b128 v[168:171], v3 offset:4096
    v_mfma_f32_32x32x16_bf16 v[120:135], v[144:147], v[152:155], v[120:135]
    s_waitcnt lgkmcnt(2)
    v_mfma_f32_32x32x16_bf16 v[40:55], v[160:163], v[172:175], v[40:55]
    s_barrier
    ds_read_b128 v[148:151], v18 offset:49152
    v_mfma_f32_32x32x16_bf16 v[88:103], v[160:163], v[176:179], v[88:103]
    ds_read_b128 v[152:155], v18 offset:51200
    s_waitcnt lgkmcnt(3)
    v_mfma_f32_32x32x16_bf16 v[56:71], v[164:167], v[172:175], v[56:71]
    ds_read_b128 v[136:139], v3 offset:8192
    v_mfma_f32_32x32x16_bf16 v[104:119], v[164:167], v[176:179], v[104:119]
    ds_read_b128 v[140:143], v3 offset:9216
    s_waitcnt lgkmcnt(4)
    v_mfma_f32_32x32x16_bf16 v[72:87], v[168:171], v[172:175], v[72:87]
    ds_read_b128 v[144:147], v3 offset:10240
    v_mfma_f32_32x32x16_bf16 v[120:135], v[168:171], v[176:179], v[120:135]
    s_waitcnt lgkmcnt(2)
    v_mfma_f32_32x32x16_bf16 v[40:55], v[136:139], v[148:151], v[40:55]
    ds_read_b128 v[172:175], v18 offset:50176
    v_mfma_f32_32x32x16_bf16 v[88:103], v[136:139], v[152:155], v[88:103]
    ds_read_b128 v[176:179], v18 offset:52224
    s_waitcnt lgkmcnt(3)
    v_mfma_f32_32x32x16_bf16 v[56:71], v[140:143], v[148:151], v[56:71]
    ds_read_b128 v[160:163], v3 offset:14336
    v_mfma_f32_32x32x16_bf16 v[104:119], v[140:143], v[152:155], v[104:119]
    ds_read_b128 v[164:167], v3 offset:15360
    s_waitcnt lgkmcnt(4)
    v_mfma_f32_32x32x16_bf16 v[72:87], v[144:147], v[148:151], v[72:87]
    ds_read_b128 v[168:171], v3 offset:16384
    v_mfma_f32_32x32x16_bf16 v[120:135], v[144:147], v[152:155], v[120:135]
    s_waitcnt lgkmcnt(2)
    v_mfma_f32_32x32x16_bf16 v[40:55], v[160:163], v[172:175], v[40:55]
    s_barrier
    ds_read_b128 v[148:151], v18 offset:57344
    v_mfma_f32_32x32x16_bf16 v[88:103], v[160:163], v[176:179], v[88:103]
    ds_read_b128 v[152:155], v18 offset:59392
    s_waitcnt lgkmcnt(3)
    v_mfma_f32_32x32x16_bf16 v[56:71], v[164:167], v[172:175], v[56:71]
    ds_read_b128 v[136:139], v3 offset:20480
    v_mfma_f32_32x32x16_bf16 v[104:119], v[164:167], v[176:179], v[104:119]
    ds_read_b128 v[140:143], v3 offset:21504
    s_waitcnt lgkmcnt(4)
    v_mfma_f32_32x32x16_bf16 v[72:87], v[168:171], v[172:175], v[72:87]
    ds_read_b128 v[144:147], v3 offset:22528
    v_mfma_f32_32x32x16_bf16 v[120:135], v[168:171], v[176:179], v[120:135]
    s_waitcnt lgkmcnt(2)
    v_mfma_f32_32x32x16_bf16 v[40:55], v[136:139], v[148:151], v[40:55]
    ds_read_b128 v[172:175], v18 offset:58368
    v_mfma_f32_32x32x16_bf16 v[88:103], v[136:139], v[152:155], v[88:103]
    ds_read_b128 v[176:179], v18 offset:60416
    s_waitcnt lgkmcnt(3)
    v_mfma_f32_32x32x16_bf16 v[56:71], v[140:143], v[148:151], v[56:71]
    ds_read_b128 v[160:163], v3 offset:26624
    v_mfma_f32_32x32x16_bf16 v[104:119], v[140:143], v[152:155], v[104:119]
    ds_read_b128 v[164:167], v3 offset:27648
    s_waitcnt lgkmcnt(4)
    v_mfma_f32_32x32x16_bf16 v[72:87], v[144:147], v[148:151], v[72:87]
    ds_read_b128 v[168:171], v3 offset:28672
    v_mfma_f32_32x32x16_bf16 v[120:135], v[144:147], v[152:155], v[120:135]
    s_waitcnt lgkmcnt(2)
    v_mfma_f32_32x32x16_bf16 v[40:55], v[160:163], v[172:175], v[40:55]
    s_barrier
    ds_read_b128 v[148:151], v18 offset:0
    v_mfma_f32_32x32x16_bf16 v[88:103], v[160:163], v[176:179], v[88:103]
    ds_read_b128 v[152:155], v18 offset:2048
    s_waitcnt lgkmcnt(3)
    v_mfma_f32_32x32x16_bf16 v[56:71], v[164:167], v[172:175], v[56:71]
    ds_read_b128 v[136:139], v2 offset:0
    v_mfma_f32_32x32x16_bf16 v[104:119], v[164:167], v[176:179], v[104:119]
    ds_read_b128 v[140:143], v2 offset:1024
    s_waitcnt lgkmcnt(4)
    v_mfma_f32_32x32x16_bf16 v[72:87], v[168:171], v[172:175], v[72:87]
    ds_read_b128 v[144:147], v2 offset:2048
    v_mfma_f32_32x32x16_bf16 v[120:135], v[168:171], v[176:179], v[120:135]
    s_waitcnt lgkmcnt(2)
    v_mfma_f32_32x32x16_bf16 v[40:55], v[136:139], v[148:151], v[40:55]
    ds_read_b128 v[172:175], v18 offset:1024
    v_mfma_f32_32x32x16_bf16 v[88:103], v[136:139], v[152:155], v[88:103]
    ds_read_b128 v[176:179], v18 offset:3072
    s_waitcnt lgkmcnt(3)
    v_mfma_f32_32x32x16_bf16 v[56:71], v[140:143], v[148:151], v[56:71]
    ds_read_b128 v[160:163], v2 offset:6144
    v_mfma_f32_32x32x16_bf16 v[104:119], v[140:143], v[152:155], v[104:119]
    ds_read_b128 v[164:167], v2 offset:7168
    s_waitcnt lgkmcnt(4)
    v_mfma_f32_32x32x16_bf16 v[72:87], v[144:147], v[148:151], v[72:87]
    ds_read_b128 v[168:171], v2 offset:8192
    v_mfma_f32_32x32x16_bf16 v[120:135], v[144:147], v[152:155], v[120:135]
    s_waitcnt lgkmcnt(2)
    v_mfma_f32_32x32x16_bf16 v[40:55], v[160:163], v[172:175], v[40:55]
    s_barrier
    ds_read_b128 v[148:151], v18 offset:8192
    v_mfma_f32_32x32x16_bf16 v[88:103], v[160:163], v[176:179], v[88:103]
    ds_read_b128 v[152:155], v18 offset:10240
    s_waitcnt lgkmcnt(3)
    v_mfma_f32_32x32x16_bf16 v[56:71], v[164:167], v[172:175], v[56:71]
    ds_read_b128 v[136:139], v2 offset:12288
    v_mfma_f32_32x32x16_bf16 v[104:119], v[164:167], v[176:179], v[104:119]
    ds_read_b128 v[140:143], v2 offset:13312
    s_waitcnt lgkmcnt(4)
    v_mfma_f32_32x32x16_bf16 v[72:87], v[168:171], v[172:175], v[72:87]
    ds_read_b128 v[144:147], v2 offset:14336
    v_mfma_f32_32x32x16_bf16 v[120:135], v[168:171], v[176:179], v[120:135]
    s_waitcnt lgkmcnt(2)
    v_mfma_f32_32x32x16_bf16 v[40:55], v[136:139], v[148:151], v[40:55]
    ds_read_b128 v[172:175], v18 offset:9216
    v_mfma_f32_32x32x16_bf16 v[88:103], v[136:139], v[152:155], v[88:103]
    ds_read_b128 v[176:179], v18 offset:11264
    s_waitcnt lgkmcnt(3)
    v_mfma_f32_32x32x16_bf16 v[56:71], v[140:143], v[148:151], v[56:71]
    ds_read_b128 v[160:163], v2 offset:18432
    v_mfma_f32_32x32x16_bf16 v[104:119], v[140:143], v[152:155], v[104:119]
    ds_read_b128 v[164:167], v2 offset:19456
    s_waitcnt lgkmcnt(4)
    v_mfma_f32_32x32x16_bf16 v[72:87], v[144:147], v[148:151], v[72:87]
    ds_read_b128 v[168:171], v2 offset:20480
    v_mfma_f32_32x32x16_bf16 v[120:135], v[144:147], v[152:155], v[120:135]
    s_waitcnt lgkmcnt(2)
    v_mfma_f32_32x32x16_bf16 v[40:55], v[160:163], v[172:175], v[40:55]
    s_barrier
    ds_read_b128 v[148:151], v18 offset:16384
    v_mfma_f32_32x32x16_bf16 v[88:103], v[160:163], v[176:179], v[88:103]
    ds_read_b128 v[152:155], v18 offset:18432
    s_waitcnt lgkmcnt(3)
    v_mfma_f32_32x32x16_bf16 v[56:71], v[164:167], v[172:175], v[56:71]
    ds_read_b128 v[136:139], v2 offset:24576
    v_mfma_f32_32x32x16_bf16 v[104:119], v[164:167], v[176:179], v[104:119]
    ds_read_b128 v[140:143], v2 offset:25600
    s_waitcnt lgkmcnt(4)
    v_mfma_f32_32x32x16_bf16 v[72:87], v[168:171], v[172:175], v[72:87]
    ds_read_b128 v[144:147], v2 offset:26624
    v_mfma_f32_32x32x16_bf16 v[120:135], v[168:171], v[176:179], v[120:135]
    s_waitcnt lgkmcnt(2)
    v_mfma_f32_32x32x16_bf16 v[40:55], v[136:139], v[148:151], v[40:55]
    ds_read_b128 v[172:175], v18 offset:17408
    v_mfma_f32_32x32x16_bf16 v[88:103], v[136:139], v[152:155], v[88:103]
    ds_read_b128 v[176:179], v18 offset:19456
    s_waitcnt lgkmcnt(3)
    v_mfma_f32_32x32x16_bf16 v[56:71], v[140:143], v[148:151], v[56:71]
    ds_read_b128 v[160:163], v2 offset:30720
    v_mfma_f32_32x32x16_bf16 v[104:119], v[140:143], v[152:155], v[104:119]
    ds_read_b128 v[164:167], v2 offset:31744
    s_waitcnt lgkmcnt(4)
    v_mfma_f32_32x32x16_bf16 v[72:87], v[144:147], v[148:151], v[72:87]
    ds_read_b128 v[168:171], v2 offset:32768
    v_mfma_f32_32x32x16_bf16 v[120:135], v[144:147], v[152:155], v[120:135]
    s_waitcnt lgkmcnt(2)
    v_mfma_f32_32x32x16_bf16 v[40:55], v[160:163], v[172:175], v[40:55]
    s_barrier
    ds_read_b128 v[148:151], v18 offset:24576
    v_mfma_f32_32x32x16_bf16 v[88:103], v[160:163], v[176:179], v[88:103]
    ds_read_b128 v[152:155], v18 offset:26624
    s_waitcnt lgkmcnt(3)
    v_mfma_f32_32x32x16_bf16 v[56:71], v[164:167], v[172:175], v[56:71]
    ds_read_b128 v[136:139], v2 offset:36864
    v_mfma_f32_32x32x16_bf16 v[104:119], v[164:167], v[176:179], v[104:119]
    ds_read_b128 v[140:143], v2 offset:37888
    s_waitcnt lgkmcnt(4)
    v_mfma_f32_32x32x16_bf16 v[72:87], v[168:171], v[172:175], v[72:87]
    ds_read_b128 v[144:147], v2 offset:38912
    v_mfma_f32_32x32x16_bf16 v[120:135], v[168:171], v[176:179], v[120:135]
    s_waitcnt lgkmcnt(2)
    v_mfma_f32_32x32x16_bf16 v[40:55], v[136:139], v[148:151], v[40:55]
    ds_read_b128 v[172:175], v18 offset:25600
    v_mfma_f32_32x32x16_bf16 v[88:103], v[136:139], v[152:155], v[88:103]
    ds_read_b128 v[176:179], v18 offset:27648
    s_waitcnt lgkmcnt(3)
    v_mfma_f32_32x32x16_bf16 v[56:71], v[140:143], v[148:151], v[56:71]
    ds_read_b128 v[160:163], v2 offset:43008
    v_mfma_f32_32x32x16_bf16 v[104:119], v[140:143], v[152:155], v[104:119]
    ds_read_b128 v[164:167], v2 offset:44032
    s_waitcnt lgkmcnt(4)
    v_mfma_f32_32x32x16_bf16 v[72:87], v[144:147], v[148:151], v[72:87]
    ds_read_b128 v[168:171], v2 offset:45056
    v_mfma_f32_32x32x16_bf16 v[120:135], v[144:147], v[152:155], v[120:135]
    s_waitcnt lgkmcnt(2)
    v_mfma_f32_32x32x16_bf16 v[40:55], v[160:163], v[172:175], v[40:55]
    s_barrier
    ds_read_b128 v[148:151], v18 offset:32768
    v_mfma_f32_32x32x16_bf16 v[88:103], v[160:163], v[176:179], v[88:103]
    ds_read_b128 v[152:155], v18 offset:34816
    s_waitcnt lgkmcnt(3)
    v_mfma_f32_32x32x16_bf16 v[56:71], v[164:167], v[172:175], v[56:71]
    ds_read_b128 v[136:139], v2 offset:49152
    v_mfma_f32_32x32x16_bf16 v[104:119], v[164:167], v[176:179], v[104:119]
    ds_read_b128 v[140:143], v2 offset:50176
    s_waitcnt lgkmcnt(4)
    v_mfma_f32_32x32x16_bf16 v[72:87], v[168:171], v[172:175], v[72:87]
    ds_read_b128 v[144:147], v2 offset:51200
    v_mfma_f32_32x32x16_bf16 v[120:135], v[168:171], v[176:179], v[120:135]
    s_waitcnt lgkmcnt(2)
    v_mfma_f32_32x32x16_bf16 v[40:55], v[136:139], v[148:151], v[40:55]
    ds_read_b128 v[172:175], v18 offset:33792
    v_mfma_f32_32x32x16_bf16 v[88:103], v[136:139], v[152:155], v[88:103]
    ds_read_b128 v[176:179], v18 offset:35840
    s_waitcnt lgkmcnt(3)
    v_mfma_f32_32x32x16_bf16 v[56:71], v[140:143], v[148:151], v[56:71]
    ds_read_b128 v[160:163], v2 offset:55296
    v_mfma_f32_32x32x16_bf16 v[104:119], v[140:143], v[152:155], v[104:119]
    ds_read_b128 v[164:167], v2 offset:56320
    s_waitcnt lgkmcnt(4)
    v_mfma_f32_32x32x16_bf16 v[72:87], v[144:147], v[148:151], v[72:87]
    ds_read_b128 v[168:171], v2 offset:57344
    v_mfma_f32_32x32x16_bf16 v[120:135], v[144:147], v[152:155], v[120:135]
    s_waitcnt lgkmcnt(2)
    v_mfma_f32_32x32x16_bf16 v[40:55], v[160:163], v[172:175], v[40:55]
    s_barrier
    ds_read_b128 v[148:151], v18 offset:40960
    v_mfma_f32_32x32x16_bf16 v[88:103], v[160:163], v[176:179], v[88:103]
    ds_read_b128 v[152:155], v18 offset:43008
    s_waitcnt lgkmcnt(3)
    v_mfma_f32_32x32x16_bf16 v[56:71], v[164:167], v[172:175], v[56:71]
    ds_read_b128 v[136:139], v2 offset:61440
    v_mfma_f32_32x32x16_bf16 v[104:119], v[164:167], v[176:179], v[104:119]
    ds_read_b128 v[140:143], v2 offset:62464
    s_waitcnt lgkmcnt(4)
    v_mfma_f32_32x32x16_bf16 v[72:87], v[168:171], v[172:175], v[72:87]
    ds_read_b128 v[144:147], v2 offset:63488
    v_mfma_f32_32x32x16_bf16 v[120:135], v[168:171], v[176:179], v[120:135]
    s_waitcnt lgkmcnt(2)
    v_mfma_f32_32x32x16_bf16 v[40:55], v[136:139], v[148:151], v[40:55]
    ds_read_b128 v[172:175], v18 offset:41984
    v_mfma_f32_32x32x16_bf16 v[88:103], v[136:139], v[152:155], v[88:103]
    ds_read_b128 v[176:179], v18 offset:44032
    s_waitcnt lgkmcnt(3)
    v_mfma_f32_32x32x16_bf16 v[56:71], v[140:143], v[148:151], v[56:71]
    ds_read_b128 v[160:163], v3 offset:2048
    v_mfma_f32_32x32x16_bf16 v[104:119], v[140:143], v[152:155], v[104:119]
    ds_read_b128 v[164:167], v3 offset:3072
    s_waitcnt lgkmcnt(4)
    v_mfma_f32_32x32x16_bf16 v[72:87], v[144:147], v[148:151], v[72:87]
    ds_read_b128 v[168:171], v3 offset:4096
    v_mfma_f32_32x32x16_bf16 v[120:135], v[144:147], v[152:155], v[120:135]
    s_waitcnt lgkmcnt(2)
    v_mfma_f32_32x32x16_bf16 v[40:55], v[160:163], v[172:175], v[40:55]
    s_barrier
    ds_read_b128 v[148:151], v18 offset:49152
    v_mfma_f32_32x32x16_bf16 v[88:103], v[160:163], v[176:179], v[88:103]
    ds_read_b128 v[152:155], v18 offset:51200
    s_waitcnt lgkmcnt(3)
    v_mfma_f32_32x32x16_bf16 v[56:71], v[164:167], v[172:175], v[56:71]
    ds_read_b128 v[136:139], v3 offset:8192
    v_mfma_f32_32x32x16_bf16 v[104:119], v[164:167], v[176:179], v[104:119]
    ds_read_b128 v[140:143], v3 offset:9216
    s_waitcnt lgkmcnt(4)
    v_mfma_f32_32x32x16_bf16 v[72:87], v[168:171], v[172:175], v[72:87]
    ds_read_b128 v[144:147], v3 offset:10240
    v_mfma_f32_32x32x16_bf16 v[120:135], v[168:171], v[176:179], v[120:135]
    s_waitcnt lgkmcnt(2)
    v_mfma_f32_32x32x16_bf16 v[40:55], v[136:139], v[148:151], v[40:55]
    ds_read_b128 v[172:175], v18 offset:50176
    v_mfma_f32_32x32x16_bf16 v[88:103], v[136:139], v[152:155], v[88:103]
    ds_read_b128 v[176:179], v18 offset:52224
    s_waitcnt lgkmcnt(3)
    v_mfma_f32_32x32x16_bf16 v[56:71], v[140:143], v[148:151], v[56:71]
    ds_read_b128 v[160:163], v3 offset:14336
    v_mfma_f32_32x32x16_bf16 v[104:119], v[140:143], v[152:155], v[104:119]
    ds_read_b128 v[164:167], v3 offset:15360
    s_waitcnt lgkmcnt(4)
    v_mfma_f32_32x32x16_bf16 v[72:87], v[144:147], v[148:151], v[72:87]
    ds_read_b128 v[168:171], v3 offset:16384
    v_mfma_f32_32x32x16_bf16 v[120:135], v[144:147], v[152:155], v[120:135]
    s_waitcnt lgkmcnt(2)
    v_mfma_f32_32x32x16_bf16 v[40:55], v[160:163], v[172:175], v[40:55]
    s_barrier
    ds_read_b128 v[148:151], v18 offset:57344
    v_mfma_f32_32x32x16_bf16 v[88:103], v[160:163], v[176:179], v[88:103]
    ds_read_b128 v[152:155], v18 offset:59392
    s_waitcnt lgkmcnt(3)
    v_mfma_f32_32x32x16_bf16 v[56:71], v[164:167], v[172:175], v[56:71]
    ds_read_b128 v[136:139], v3 offset:20480
    v_mfma_f32_32x32x16_bf16 v[104:119], v[164:167], v[176:179], v[104:119]
    ds_read_b128 v[140:143], v3 offset:21504
    s_waitcnt lgkmcnt(4)
    v_mfma_f32_32x32x16_bf16 v[72:87], v[168:171], v[172:175], v[72:87]
    ds_read_b128 v[144:147], v3 offset:22528
    v_mfma_f32_32x32x16_bf16 v[120:135], v[168:171], v[176:179], v[120:135]
    s_waitcnt lgkmcnt(2)
    v_mfma_f32_32x32x16_bf16 v[40:55], v[136:139], v[148:151], v[40:55]
    ds_read_b128 v[172:175], v18 offset:58368
    v_mfma_f32_32x32x16_bf16 v[88:103], v[136:139], v[152:155], v[88:103]
    ds_read_b128 v[176:179], v18 offset:60416
    s_waitcnt lgkmcnt(3)
    v_mfma_f32_32x32x16_bf16 v[56:71], v[140:143], v[148:151], v[56:71]
    ds_read_b128 v[160:163], v3 offset:26624
    v_mfma_f32_32x32x16_bf16 v[104:119], v[140:143], v[152:155], v[104:119]
    ds_read_b128 v[164:167], v3 offset:27648
    s_waitcnt lgkmcnt(4)
    v_mfma_f32_32x32x16_bf16 v[72:87], v[144:147], v[148:151], v[72:87]
    ds_read_b128 v[168:171], v3 offset:28672
    v_mfma_f32_32x32x16_bf16 v[120:135], v[144:147], v[152:155], v[120:135]
    s_waitcnt lgkmcnt(2)
    v_mfma_f32_32x32x16_bf16 v[40:55], v[160:163], v[172:175], v[40:55]
    s_barrier
    ds_read_b128 v[148:151], v18 offset:0
    v_mfma_f32_32x32x16_bf16 v[88:103], v[160:163], v[176:179], v[88:103]
    ds_read_b128 v[152:155], v18 offset:2048
    s_waitcnt lgkmcnt(3)
    v_mfma_f32_32x32x16_bf16 v[56:71], v[164:167], v[172:175], v[56:71]
    ds_read_b128 v[136:139], v2 offset:0
    v_mfma_f32_32x32x16_bf16 v[104:119], v[164:167], v[176:179], v[104:119]
    ds_read_b128 v[140:143], v2 offset:1024
    s_waitcnt lgkmcnt(4)
    v_mfma_f32_32x32x16_bf16 v[72:87], v[168:171], v[172:175], v[72:87]
    ds_read_b128 v[144:147], v2 offset:2048
    v_mfma_f32_32x32x16_bf16 v[120:135], v[168:171], v[176:179], v[120:135]
    s_waitcnt lgkmcnt(2)
    v_mfma_f32_32x32x16_bf16 v[40:55], v[136:139], v[148:151], v[40:55]
    ds_read_b128 v[172:175], v18 offset:1024
    v_mfma_f32_32x32x16_bf16 v[88:103], v[136:139], v[152:155], v[88:103]
    ds_read_b128 v[176:179], v18 offset:3072
    s_waitcnt lgkmcnt(3)
    v_mfma_f32_32x32x16_bf16 v[56:71], v[140:143], v[148:151], v[56:71]
    ds_read_b128 v[160:163], v2 offset:6144
    v_mfma_f32_32x32x16_bf16 v[104:119], v[140:143], v[152:155], v[104:119]
    ds_read_b128 v[164:167], v2 offset:7168
    s_waitcnt lgkmcnt(4)
    v_mfma_f32_32x32x16_bf16 v[72:87], v[144:147], v[148:151], v[72:87]
    ds_read_b128 v[168:171], v2 offset:8192
    v_mfma_f32_32x32x16_bf16 v[120:135], v[144:147], v[152:155], v[120:135]
    s_waitcnt lgkmcnt(2)
    v_mfma_f32_32x32x16_bf16 v[40:55], v[160:163], v[172:175], v[40:55]
    s_barrier
    ds_read_b128 v[148:151], v18 offset:8192
    v_mfma_f32_32x32x16_bf16 v[88:103], v[160:163], v[176:179], v[88:103]
    ds_read_b128 v[152:155], v18 offset:10240
    s_waitcnt lgkmcnt(3)
    v_mfma_f32_32x32x16_bf16 v[56:71], v[164:167], v[172:175], v[56:71]
    ds_read_b128 v[136:139], v2 offset:12288
    v_mfma_f32_32x32x16_bf16 v[104:119], v[164:167], v[176:179], v[104:119]
    ds_read_b128 v[140:143], v2 offset:13312
    s_waitcnt lgkmcnt(4)
    v_mfma_f32_32x32x16_bf16 v[72:87], v[168:171], v[172:175], v[72:87]
    ds_read_b128 v[144:147], v2 offset:14336
    v_mfma_f32_32x32x16_bf16 v[120:135], v[168:171], v[176:179], v[120:135]
    s_waitcnt lgkmcnt(2)
    v_mfma_f32_32x32x16_bf16 v[40:55], v[136:139], v[148:151], v[40:55]
    ds_read_b128 v[172:175], v18 offset:9216
    v_mfma_f32_32x32x16_bf16 v[88:103], v[136:139], v[152:155], v[88:103]
    ds_read_b128 v[176:179], v18 offset:11264
    s_waitcnt lgkmcnt(3)
    v_mfma_f32_32x32x16_bf16 v[56:71], v[140:143], v[148:151], v[56:71]
    ds_read_b128 v[160:163], v2 offset:18432
    v_mfma_f32_32x32x16_bf16 v[104:119], v[140:143], v[152:155], v[104:119]
    ds_read_b128 v[164:167], v2 offset:19456
    s_waitcnt lgkmcnt(4)
    v_mfma_f32_32x32x16_bf16 v[72:87], v[144:147], v[148:151], v[72:87]
    ds_read_b128 v[168:171], v2 offset:20480
    v_mfma_f32_32x32x16_bf16 v[120:135], v[144:147], v[152:155], v[120:135]
    s_waitcnt lgkmcnt(2)
    v_mfma_f32_32x32x16_bf16 v[40:55], v[160:163], v[172:175], v[40:55]
    s_barrier
    ds_read_b128 v[148:151], v18 offset:16384
    v_mfma_f32_32x32x16_bf16 v[88:103], v[160:163], v[176:179], v[88:103]
    ds_read_b128 v[152:155], v18 offset:18432
    s_waitcnt lgkmcnt(3)
    v_mfma_f32_32x32x16_bf16 v[56:71], v[164:167], v[172:175], v[56:71]
    ds_read_b128 v[136:139], v2 offset:24576
    v_mfma_f32_32x32x16_bf16 v[104:119], v[164:167], v[176:179], v[104:119]
    ds_read_b128 v[140:143], v2 offset:25600
    s_waitcnt lgkmcnt(4)
    v_mfma_f32_32x32x16_bf16 v[72:87], v[168:171], v[172:175], v[72:87]
    ds_read_b128 v[144:147], v2 offset:26624
    v_mfma_f32_32x32x16_bf16 v[120:135], v[168:171], v[176:179], v[120:135]
    s_waitcnt lgkmcnt(2)
    v_mfma_f32_32x32x16_bf16 v[40:55], v[136:139], v[148:151], v[40:55]
    ds_read_b128 v[172:175], v18 offset:17408
    v_mfma_f32_32x32x16_bf16 v[88:103], v[136:139], v[152:155], v[88:103]
    ds_read_b128 v[176:179], v18 offset:19456
    s_waitcnt lgkmcnt(3)
    v_mfma_f32_32x32x16_bf16 v[56:71], v[140:143], v[148:151], v[56:71]
    ds_read_b128 v[160:163], v2 offset:30720
    v_mfma_f32_32x32x16_bf16 v[104:119], v[140:143], v[152:155], v[104:119]
    ds_read_b128 v[164:167], v2 offset:31744
    s_waitcnt lgkmcnt(4)
    v_mfma_f32_32x32x16_bf16 v[72:87], v[144:147], v[148:151], v[72:87]
    ds_read_b128 v[168:171], v2 offset:32768
    v_mfma_f32_32x32x16_bf16 v[120:135], v[144:147], v[152:155], v[120:135]
    s_waitcnt lgkmcnt(2)
    v_mfma_f32_32x32x16_bf16 v[40:55], v[160:163], v[172:175], v[40:55]
    s_barrier
    ds_read_b128 v[148:151], v18 offset:24576
    v_mfma_f32_32x32x16_bf16 v[88:103], v[160:163], v[176:179], v[88:103]
    ds_read_b128 v[152:155], v18 offset:26624
    s_waitcnt lgkmcnt(3)
    v_mfma_f32_32x32x16_bf16 v[56:71], v[164:167], v[172:175], v[56:71]
    ds_read_b128 v[136:139], v2 offset:36864
    v_mfma_f32_32x32x16_bf16 v[104:119], v[164:167], v[176:179], v[104:119]
    ds_read_b128 v[140:143], v2 offset:37888
    s_waitcnt lgkmcnt(4)
    v_mfma_f32_32x32x16_bf16 v[72:87], v[168:171], v[172:175], v[72:87]
    ds_read_b128 v[144:147], v2 offset:38912
    v_mfma_f32_32x32x16_bf16 v[120:135], v[168:171], v[176:179], v[120:135]
    s_waitcnt lgkmcnt(2)
    v_mfma_f32_32x32x16_bf16 v[40:55], v[136:139], v[148:151], v[40:55]
    ds_read_b128 v[172:175], v18 offset:25600
    v_mfma_f32_32x32x16_bf16 v[88:103], v[136:139], v[152:155], v[88:103]
    ds_read_b128 v[176:179], v18 offset:27648
    s_waitcnt lgkmcnt(3)
    v_mfma_f32_32x32x16_bf16 v[56:71], v[140:143], v[148:151], v[56:71]
    ds_read_b128 v[160:163], v2 offset:43008
    v_mfma_f32_32x32x16_bf16 v[104:119], v[140:143], v[152:155], v[104:119]
    ds_read_b128 v[164:167], v2 offset:44032
    s_waitcnt lgkmcnt(4)
    v_mfma_f32_32x32x16_bf16 v[72:87], v[144:147], v[148:151], v[72:87]
    ds_read_b128 v[168:171], v2 offset:45056
    v_mfma_f32_32x32x16_bf16 v[120:135], v[144:147], v[152:155], v[120:135]
    s_waitcnt lgkmcnt(2)
    v_mfma_f32_32x32x16_bf16 v[40:55], v[160:163], v[172:175], v[40:55]
    v_mfma_f32_32x32x16_bf16 v[88:103], v[160:163], v[176:179], v[88:103]
    s_waitcnt lgkmcnt(1)
    v_mfma_f32_32x32x16_bf16 v[56:71], v[164:167], v[172:175], v[56:71]
    v_mfma_f32_32x32x16_bf16 v[104:119], v[164:167], v[176:179], v[104:119]
    s_waitcnt lgkmcnt(0)
    v_mfma_f32_32x32x16_bf16 v[72:87], v[168:171], v[172:175], v[72:87]
    v_mfma_f32_32x32x16_bf16 v[120:135], v[168:171], v[176:179], v[120:135]
    s_waitcnt lgkmcnt(0)
    s_barrier
    s_waitcnt vmcnt(0)
    v_pk_add_f32 v[24:25], v[24:25], v[26:27]
    v_pk_add_f32 v[28:29], v[28:29], v[30:31]
    v_pk_add_f32 v[24:25], v[24:25], v[28:29]
    v_mov_b32 v26, v24
    s_nop 1
    v_permlane32_swap_b32 v24, v26
    s_nop 1
    v_add_f32 v24, v24, v26
    v_mov_b32 v27, v25
    s_nop 1
    v_permlane32_swap_b32 v25, v27
    s_nop 1
    v_add_f32 v25, v25, v27
    v_mul_f32 v24, 0x3acccccd, v24
    v_mul_f32 v26, 0x3acccccd, v25
    v_fma_f32 v26, -v24, v24, v26
    v_add_f32 v26, 0x3727c5ac, v26
    v_rsq_f32 v28, v26
    v_mov_b32 v27, v26
    v_mul_f32 v24, 0xc0135761, v28
    v_mul_f32 v28, v28, v28
    v_mov_b32 v25, v24
    v_mul_f32 v28, v28, v24
    v_mul_f32 v28, 0x3d372713, v28
    v_mov_b32 v29, v28
    v_pk_add_f32 v[32:33], v[32:33], v[34:35]
    v_pk_add_f32 v[36:37], v[36:37], v[38:39]
    v_pk_add_f32 v[32:33], v[32:33], v[36:37]
    v_mov_b32 v34, v32
    s_nop 1
    v_permlane32_swap_b32 v32, v34
    s_nop 1
    v_add_f32 v32, v32, v34
    v_mov_b32 v35, v33
    s_nop 1
    v_permlane32_swap_b32 v33, v35
    s_nop 1
    v_add_f32 v33, v33, v35
    v_mul_f32 v32, 0x3acccccd, v32
    v_mul_f32 v34, 0x3acccccd, v33
    v_fma_f32 v34, -v32, v32, v34
    v_add_f32 v34, 0x3727c5ac, v34
    v_rsq_f32 v36, v34
    v_mov_b32 v35, v34
    v_mul_f32 v32, 0xc0135761, v36
    v_mul_f32 v36, v36, v36
    v_mov_b32 v33, v32
    v_mul_f32 v36, v36, v32
    v_mul_f32 v36, 0x3d372713, v36
    v_mov_b32 v37, v36
    v_pk_mul_f32 v[136:137], v[40:41], v[40:41]
    v_pk_mul_f32 v[138:139], v[42:43], v[42:43]
    v_pk_mul_f32 v[140:141], v[44:45], v[44:45]
    v_pk_mul_f32 v[142:143], v[46:47], v[46:47]
    v_pk_fma_f32 v[136:137], v[136:137], v[28:29], v[24:25]
    v_pk_fma_f32 v[138:139], v[138:139], v[28:29], v[24:25]
    v_pk_fma_f32 v[140:141], v[140:141], v[28:29], v[24:25]
    v_pk_fma_f32 v[142:143], v[142:143], v[28:29], v[24:25]
    v_pk_mul_f32 v[136:137], v[136:137], v[40:41]
    v_pk_mul_f32 v[138:139], v[138:139], v[42:43]
    v_pk_mul_f32 v[140:141], v[140:141], v[44:45]
    v_pk_mul_f32 v[142:143], v[142:143], v[46:47]
    v_exp_f32 v136, v136
    v_exp_f32 v137, v137
    v_exp_f32 v138, v138
    v_exp_f32 v139, v139
    v_exp_f32 v140, v140
    v_exp_f32 v141, v141
    v_exp_f32 v142, v142
    v_exp_f32 v143, v143
    v_pk_mul_f32 v[144:145], v[40:41], v[48:49]
    v_pk_mul_f32 v[146:147], v[42:43], v[50:51]
    v_pk_mul_f32 v[148:149], v[44:45], v[52:53]
    v_pk_mul_f32 v[150:151], v[46:47], v[54:55]
    v_pk_fma_f32 v[136:137], v[136:137], v[26:27], v[26:27]
    v_pk_fma_f32 v[138:139], v[138:139], v[26:27], v[26:27]
    v_pk_fma_f32 v[140:141], v[140:141], v[26:27], v[26:27]
    v_pk_fma_f32 v[142:143], v[142:143], v[26:27], v[26:27]
    v_rcp_f32 v136, v136
    v_rcp_f32 v137, v137
    v_rcp_f32 v138, v138
    v_rcp_f32 v139, v139
    v_rcp_f32 v140, v140
    v_rcp_f32 v141, v141
    v_rcp_f32 v142, v142
    v_rcp_f32 v143, v143
    s_nop 0
    v_pk_mul_f32 v[136:137], v[136:137], v[144:145]
    v_pk_mul_f32 v[138:139], v[138:139], v[146:147]
    v_pk_mul_f32 v[140:141], v[140:141], v[148:149]
    v_pk_mul_f32 v[142:143], v[142:143], v[150:151]
    v_cvt_pk_bf16_f32 v152, v136, v137
    v_cvt_pk_bf16_f32 v153, v138, v139
    v_cvt_pk_bf16_f32 v154, v140, v141
    v_cvt_pk_bf16_f32 v155, v142, v143
    buffer_store_dwordx4 v[152:155], v5, s[8:11], s24 offen offset:0 sc1
    v_pk_mul_f32 v[160:161], v[56:57], v[56:57]
    v_pk_mul_f32 v[162:163], v[58:59], v[58:59]
    v_pk_mul_f32 v[164:165], v[60:61], v[60:61]
    v_pk_mul_f32 v[166:167], v[62:63], v[62:63]
    v_pk_fma_f32 v[160:161], v[160:161], v[28:29], v[24:25]
    v_pk_fma_f32 v[162:163], v[162:163], v[28:29], v[24:25]
    v_pk_fma_f32 v[164:165], v[164:165], v[28:29], v[24:25]
    v_pk_fma_f32 v[166:167], v[166:167], v[28:29], v[24:25]
    v_pk_mul_f32 v[160:161], v[160:161], v[56:57]
    v_pk_mul_f32 v[162:163], v[162:163], v[58:59]
    v_pk_mul_f32 v[164:165], v[164:165], v[60:61]
    v_pk_mul_f32 v[166:167], v[166:167], v[62:63]
    v_exp_f32 v160, v160
    v_exp_f32 v161, v161
    v_exp_f32 v162, v162
    v_exp_f32 v163, v163
    v_exp_f32 v164, v164
    v_exp_f32 v165, v165
    v_exp_f32 v166, v166
    v_exp_f32 v167, v167
    v_pk_mul_f32 v[168:169], v[56:57], v[64:65]
    v_pk_mul_f32 v[170:171], v[58:59], v[66:67]
    v_pk_mul_f32 v[172:173], v[60:61], v[68:69]
    v_pk_mul_f32 v[174:175], v[62:63], v[70:71]
    v_pk_fma_f32 v[160:161], v[160:161], v[26:27], v[26:27]
    v_pk_fma_f32 v[162:163], v[162:163], v[26:27], v[26:27]
    v_pk_fma_f32 v[164:165], v[164:165], v[26:27], v[26:27]
    v_pk_fma_f32 v[166:167], v[166:167], v[26:27], v[26:27]
    v_rcp_f32 v160, v160
    v_rcp_f32 v161, v161
    v_rcp_f32 v162, v162
    v_rcp_f32 v163, v163
    v_rcp_f32 v164, v164
    v_rcp_f32 v165, v165
    v_rcp_f32 v166, v166
    v_rcp_f32 v167, v167
    s_nop 0
    v_pk_mul_f32 v[160:161], v[160:161], v[168:169]
    v_pk_mul_f32 v[162:163], v[162:163], v[170:171]
    v_pk_mul_f32 v[164:165], v[164:165], v[172:173]
    v_pk_mul_f32 v[166:167], v[166:167], v[174:175]
    v_cvt_pk_bf16_f32 v176, v160, v161
    v_cvt_pk_bf16_f32 v177, v162, v163
    v_cvt_pk_bf16_f32 v178, v164, v165
    v_cvt_pk_bf16_f32 v179, v166, v167
    buffer_store_dwordx4 v[176:179], v5, s[8:11], s24 offen offset:512 sc1
    v_pk_mul_f32 v[136:137], v[72:73], v[72:73]
    v_pk_mul_f32 v[138:139], v[74:75], v[74:75]
    v_pk_mul_f32 v[140:141], v[76:77], v[76:77]
    v_pk_mul_f32 v[142:143], v[78:79], v[78:79]
    v_pk_fma_f32 v[136:137], v[136:137], v[28:29], v[24:25]
    v_pk_fma_f32 v[138:139], v[138:139], v[28:29], v[24:25]
    v_pk_fma_f32 v[140:141], v[140:141], v[28:29], v[24:25]
    v_pk_fma_f32 v[142:143], v[142:143], v[28:29], v[24:25]
    v_pk_mul_f32 v[136:137], v[136:137], v[72:73]
    v_pk_mul_f32 v[138:139], v[138:139], v[74:75]
    v_pk_mul_f32 v[140:141], v[140:141], v[76:77]
    v_pk_mul_f32 v[142:143], v[142:143], v[78:79]
    v_exp_f32 v136, v136
    v_exp_f32 v137, v137
    v_exp_f32 v138, v138
    v_exp_f32 v139, v139
    v_exp_f32 v140, v140
    v_exp_f32 v141, v141
    v_exp_f32 v142, v142
    v_exp_f32 v143, v143
    v_pk_mul_f32 v[144:145], v[72:73], v[80:81]
    v_pk_mul_f32 v[146:147], v[74:75], v[82:83]
    v_pk_mul_f32 v[148:149], v[76:77], v[84:85]
    v_pk_mul_f32 v[150:151], v[78:79], v[86:87]
    v_pk_fma_f32 v[136:137], v[136:137], v[26:27], v[26:27]
    v_pk_fma_f32 v[138:139], v[138:139], v[26:27], v[26:27]
    v_pk_fma_f32 v[140:141], v[140:141], v[26:27], v[26:27]
    v_pk_fma_f32 v[142:143], v[142:143], v[26:27], v[26:27]
    v_rcp_f32 v136, v136
    v_rcp_f32 v137, v137
    v_rcp_f32 v138, v138
    v_rcp_f32 v139, v139
    v_rcp_f32 v140, v140
    v_rcp_f32 v141, v141
    v_rcp_f32 v142, v142
    v_rcp_f32 v143, v143
    s_nop 0
    v_pk_mul_f32 v[136:137], v[136:137], v[144:145]
    v_pk_mul_f32 v[138:139], v[138:139], v[146:147]
    v_pk_mul_f32 v[140:141], v[140:141], v[148:149]
    v_pk_mul_f32 v[142:143], v[142:143], v[150:151]
    v_cvt_pk_bf16_f32 v152, v136, v137
    v_cvt_pk_bf16_f32 v153, v138, v139
    v_cvt_pk_bf16_f32 v154, v140, v141
    v_cvt_pk_bf16_f32 v155, v142, v143
    buffer_store_dwordx4 v[152:155], v5, s[8:11], s24 offen offset:1024 sc1
    v_pk_mul_f32 v[160:161], v[88:89], v[88:89]
    v_pk_mul_f32 v[162:163], v[90:91], v[90:91]
    v_pk_mul_f32 v[164:165], v[92:93], v[92:93]
    v_pk_mul_f32 v[166:167], v[94:95], v[94:95]
    v_pk_fma_f32 v[160:161], v[160:161], v[36:37], v[32:33]
    v_pk_fma_f32 v[162:163], v[162:163], v[36:37], v[32:33]
    v_pk_fma_f32 v[164:165], v[164:165], v[36:37], v[32:33]
    v_pk_fma_f32 v[166:167], v[166:167], v[36:37], v[32:33]
    v_pk_mul_f32 v[160:161], v[160:161], v[88:89]
    v_pk_mul_f32 v[162:163], v[162:163], v[90:91]
    v_pk_mul_f32 v[164:165], v[164:165], v[92:93]
    v_pk_mul_f32 v[166:167], v[166:167], v[94:95]
    v_exp_f32 v160, v160
    v_exp_f32 v161, v161
    v_exp_f32 v162, v162
    v_exp_f32 v163, v163
    v_exp_f32 v164, v164
    v_exp_f32 v165, v165
    v_exp_f32 v166, v166
    v_exp_f32 v167, v167
    v_pk_mul_f32 v[168:169], v[88:89], v[96:97]
    v_pk_mul_f32 v[170:171], v[90:91], v[98:99]
    v_pk_mul_f32 v[172:173], v[92:93], v[100:101]
    v_pk_mul_f32 v[174:175], v[94:95], v[102:103]
    v_pk_fma_f32 v[160:161], v[160:161], v[34:35], v[34:35]
    v_pk_fma_f32 v[162:163], v[162:163], v[34:35], v[34:35]
    v_pk_fma_f32 v[164:165], v[164:165], v[34:35], v[34:35]
    v_pk_fma_f32 v[166:167], v[166:167], v[34:35], v[34:35]
    v_rcp_f32 v160, v160
    v_rcp_f32 v161, v161
    v_rcp_f32 v162, v162
    v_rcp_f32 v163, v163
    v_rcp_f32 v164, v164
    v_rcp_f32 v165, v165
    v_rcp_f32 v166, v166
    v_rcp_f32 v167, v167
    s_nop 0
    v_pk_mul_f32 v[160:161], v[160:161], v[168:169]
    v_pk_mul_f32 v[162:163], v[162:163], v[170:171]
    v_pk_mul_f32 v[164:165], v[164:165], v[172:173]
    v_pk_mul_f32 v[166:167], v[166:167], v[174:175]
    v_cvt_pk_bf16_f32 v176, v160, v161
    v_cvt_pk_bf16_f32 v177, v162, v163
    v_cvt_pk_bf16_f32 v178, v164, v165
    v_cvt_pk_bf16_f32 v179, v166, v167
    buffer_store_dwordx4 v[176:179], v5, s[8:11], s25 offen offset:0 sc1
    v_pk_mul_f32 v[136:137], v[104:105], v[104:105]
    v_pk_mul_f32 v[138:139], v[106:107], v[106:107]
    v_pk_mul_f32 v[140:141], v[108:109], v[108:109]
    v_pk_mul_f32 v[142:143], v[110:111], v[110:111]
    v_pk_fma_f32 v[136:137], v[136:137], v[36:37], v[32:33]
    v_pk_fma_f32 v[138:139], v[138:139], v[36:37], v[32:33]
    v_pk_fma_f32 v[140:141], v[140:141], v[36:37], v[32:33]
    v_pk_fma_f32 v[142:143], v[142:143], v[36:37], v[32:33]
    v_pk_mul_f32 v[136:137], v[136:137], v[104:105]
    v_pk_mul_f32 v[138:139], v[138:139], v[106:107]
    v_pk_mul_f32 v[140:141], v[140:141], v[108:109]
    v_pk_mul_f32 v[142:143], v[142:143], v[110:111]
    v_exp_f32 v136, v136
    v_exp_f32 v137, v137
    v_exp_f32 v138, v138
    v_exp_f32 v139, v139
    v_exp_f32 v140, v140
    v_exp_f32 v141, v141
    v_exp_f32 v142, v142
    v_exp_f32 v143, v143
    v_pk_mul_f32 v[144:145], v[104:105], v[112:113]
    v_pk_mul_f32 v[146:147], v[106:107], v[114:115]
    v_pk_mul_f32 v[148:149], v[108:109], v[116:117]
    v_pk_mul_f32 v[150:151], v[110:111], v[118:119]
    v_pk_fma_f32 v[136:137], v[136:137], v[34:35], v[34:35]
    v_pk_fma_f32 v[138:139], v[138:139], v[34:35], v[34:35]
    v_pk_fma_f32 v[140:141], v[140:141], v[34:35], v[34:35]
    v_pk_fma_f32 v[142:143], v[142:143], v[34:35], v[34:35]
    v_rcp_f32 v136, v136
    v_rcp_f32 v137, v137
    v_rcp_f32 v138, v138
    v_rcp_f32 v139, v139
    v_rcp_f32 v140, v140
    v_rcp_f32 v141, v141
    v_rcp_f32 v142, v142
    v_rcp_f32 v143, v143
    s_nop 0
    v_pk_mul_f32 v[136:137], v[136:137], v[144:145]
    v_pk_mul_f32 v[138:139], v[138:139], v[146:147]
    v_pk_mul_f32 v[140:141], v[140:141], v[148:149]
    v_pk_mul_f32 v[142:143], v[142:143], v[150:151]
    v_cvt_pk_bf16_f32 v152, v136, v137
    v_cvt_pk_bf16_f32 v153, v138, v139
    v_cvt_pk_bf16_f32 v154, v140, v141
    v_cvt_pk_bf16_f32 v155, v142, v143
    buffer_store_dwordx4 v[152:155], v5, s[8:11], s25 offen offset:512 sc1
    v_pk_mul_f32 v[160:161], v[120:121], v[120:121]
    v_pk_mul_f32 v[162:163], v[122:123], v[122:123]
    v_pk_mul_f32 v[164:165], v[124:125], v[124:125]
    v_pk_mul_f32 v[166:167], v[126:127], v[126:127]
    v_pk_fma_f32 v[160:161], v[160:161], v[36:37], v[32:33]
    v_pk_fma_f32 v[162:163], v[162:163], v[36:37], v[32:33]
    v_pk_fma_f32 v[164:165], v[164:165], v[36:37], v[32:33]
    v_pk_fma_f32 v[166:167], v[166:167], v[36:37], v[32:33]
    v_pk_mul_f32 v[160:161], v[160:161], v[120:121]
    v_pk_mul_f32 v[162:163], v[162:163], v[122:123]
    v_pk_mul_f32 v[164:165], v[164:165], v[124:125]
    v_pk_mul_f32 v[166:167], v[166:167], v[126:127]
    v_exp_f32 v160, v160
    v_exp_f32 v161, v161
    v_exp_f32 v162, v162
    v_exp_f32 v163, v163
    v_exp_f32 v164, v164
    v_exp_f32 v165, v165
    v_exp_f32 v166, v166
    v_exp_f32 v167, v167
    v_pk_mul_f32 v[168:169], v[120:121], v[128:129]
    v_pk_mul_f32 v[170:171], v[122:123], v[130:131]
    v_pk_mul_f32 v[172:173], v[124:125], v[132:133]
    v_pk_mul_f32 v[174:175], v[126:127], v[134:135]
    v_pk_fma_f32 v[160:161], v[160:161], v[34:35], v[34:35]
    v_pk_fma_f32 v[162:163], v[162:163], v[34:35], v[34:35]
    v_pk_fma_f32 v[164:165], v[164:165], v[34:35], v[34:35]
    v_pk_fma_f32 v[166:167], v[166:167], v[34:35], v[34:35]
    v_rcp_f32 v160, v160
    v_rcp_f32 v161, v161
    v_rcp_f32 v162, v162
    v_rcp_f32 v163, v163
    v_rcp_f32 v164, v164
    v_rcp_f32 v165, v165
    v_rcp_f32 v166, v166
    v_rcp_f32 v167, v167
    s_nop 0
    v_pk_mul_f32 v[160:161], v[160:161], v[168:169]
    v_pk_mul_f32 v[162:163], v[162:163], v[170:171]
    v_pk_mul_f32 v[164:165], v[164:165], v[172:173]
    v_pk_mul_f32 v[166:167], v[166:167], v[174:175]
    v_cvt_pk_bf16_f32 v176, v160, v161
    v_cvt_pk_bf16_f32 v177, v162, v163
    v_cvt_pk_bf16_f32 v178, v164, v165
    v_cvt_pk_bf16_f32 v179, v166, v167
    buffer_store_dwordx4 v[176:179], v5, s[8:11], s25 offen offset:1024 sc1
    s_waitcnt vmcnt(0)
    s_barrier
    s_cmp_lg_u32 s3, 0
    s_cbranch_scc1 main_kernel_sig6
    s_add_u32 s44, s55, 48283648
    v_mov_b32 v246, 1
    s_mov_b64 exec, 1
    s_cmp_lg_u32 s84, 0
    s_cbranch_scc1 main_kernel_sig6s
    buffer_store_dword v246, off, s[8:11], s44
    s_branch main_kernel_sig6e
main_kernel_sig6s:
    buffer_wbl2 sc1
    s_waitcnt vmcnt(0)
    buffer_store_dword v246, off, s[8:11], s44 sc1
main_kernel_sig6e:
    s_mov_b64 exec, -1
main_kernel_sig6:
    v_lshlrev_b32 v1, 4, v0
    v_and_b32 v6, 15, v0
    v_lshrrev_b32 v7, 4, v0
    s_and_b32 s7, s3, 1
    s_lshr_b32 s5, s3, 1
    s_lshl_b32 s4, s50, 2
    s_lshl_b32 s20, s7, 1
    s_add_u32 s4, s4, s20
    s_mul_i32 s22, s4, 49152
    s_lshl_b32 s20, s5, 10
    s_add_u32 s22, s22, s20
    s_add_u32 s22, s22, 33554432
    s_add_u32 s4, s4, s5
    s_mul_i32 s20, s5, 5120
    v_add_u32 v2, s20, v1
    v_add_u32 v3, 0x10000, v2
    v_add_u32 v4, 0x20000, v2
    v_add_u32 v5, 49152, v1
    v_lshrrev_b32 v10, 1, v7
    v_and_b32 v11, 1, v7
    v_lshlrev_b32 v8, 8, v10
    v_lshl_add_u32 v8, v6, 4, v8
    v_lshl_add_u32 v9, v11, 9, v8
    v_lshl_add_u32 v8, v11, 3, v8
    s_mul_i32 s24, s4, 20480
    s_mul_i32 s26, s51, 2560
    s_add_u32 s24, s24, s26
    s_add_u32 s25, s24, 8388608
    buffer_load_dwordx2 v[232:233], v8, s[8:11], s25 offen offset:0 sc1
    buffer_load_dwordx2 v[234:235], v8, s[8:11], s25 offen offset:512 sc1
    buffer_load_dwordx2 v[236:237], v8, s[8:11], s25 offen offset:1024 sc1
    buffer_load_dwordx2 v[238:239], v8, s[8:11], s25 offen offset:1536 sc1
    buffer_load_dwordx2 v[240:241], v8, s[8:11], s25 offen offset:2048 sc1
    s_lshr_b32 s26, s50, 1
    s_lshl_b32 s26, s26, 8
    s_cmp_lg_u32 s3, 0
    s_cbranch_scc1 main_kernel_poll7p
    v_lshlrev_b32 v250, 2, v0
    s_mov_b32 s45, 0x200000
    s_add_u32 s44, s26, 48283648
    s_mov_b64 exec, 65535
main_kernel_poll7_0:
    buffer_load_dword v246, v250, s[8:11], s44 offen sc1
    s_waitcnt vmcnt(0)
    v_cmp_ne_u32 vcc, 1, v246
    s_sub_u32 s45, s45, 1
    s_cbranch_scc1 main_kernel_poll7d
    s_cmp_eq_u64 vcc, 0
    s_cbranch_scc0 main_kernel_poll7_0
    s_mov_b64 exec, -1
main_kernel_poll7d:
    s_mov_b64 exec, -1
    s_cmp_eq_u32 s84, 0
    s_cbranch_scc1 main_kernel_poll7p
    buffer_inv sc1
    s_waitcnt vmcnt(0)
main_kernel_poll7p:
    s_barrier
    s_add_u32 s23, s22, 0
    buffer_load_dwordx4 v[24:27], v1, s[8:11], s23 offen sc1
    buffer_load_dwordx4 v[28:31], v5, s[8:11], s23 offen sc1
    s_add_u32 s23, s22, 2048
    buffer_load_dwordx4 v[32:35], v1, s[8:11], s23 offen sc1
    buffer_load_dwordx4 v[36:39], v5, s[8:11], s23 offen sc1
    s_add_u32 s23, s22, 4096
    buffer_load_dwordx4 v[40:43], v1, s[8:11], s23 offen sc1
    buffer_load_dwordx4 v[44:47], v5, s[8:11], s23 offen sc1
    s_add_u32 s23, s22, 6144
    buffer_load_dwordx4 v[48:51], v1, s[8:11], s23 offen sc1
    buffer_load_dwordx4 v[52:55], v5, s[8:11], s23 offen sc1
    s_add_u32 s23, s22, 8192
    buffer_load_dwordx4 v[56:59], v1, s[8:11], s23 offen sc1
    buffer_load_dwordx4 v[60:63], v5, s[8:11], s23 offen sc1
    s_add_u32 s23, s22, 10240
    buffer_load_dwordx4 v[64:67], v1, s[8:11], s23 offen sc1
    buffer_load_dwordx4 v[68:71], v5, s[8:11], s23 offen sc1
    s_add_u32 s23, s22, 12288
    buffer_load_dwordx4 v[72:75], v1, s[8:11], s23 offen sc1
    buffer_load_dwordx4 v[76:79], v5, s[8:11], s23 offen sc1
    s_add_u32 s23, s22, 14336
    buffer_load_dwordx4 v[80:83], v1, s[8:11], s23 offen sc1
    buffer_load_dwordx4 v[84:87], v5, s[8:11], s23 offen sc1
    s_add_u32 s23, s22, 16384
    buffer_load_dwordx4 v[88:91], v1, s[8:11], s23 offen sc1
    buffer_load_dwordx4 v[92:95], v5, s[8:11], s23 offen sc1
    s_add_u32 s23, s22, 18432
    buffer_load_dwordx4 v[96:99], v1, s[8:11], s23 offen sc1
    buffer_load_dwordx4 v[100:103], v5, s[8:11], s23 offen sc1
    s_add_u32 s23, s22, 20480
    buffer_load_dwordx4 v[104:107], v1, s[8:11], s23 offen sc1
    buffer_load_dwordx4 v[108:111], v5, s[8:11], s23 offen sc1
    s_add_u32 s23, s22, 22528
    buffer_load_dwordx4 v[112:115], v1, s[8:11], s23 offen sc1
    buffer_load_dwordx4 v[116:119], v5, s[8:11], s23 offen sc1
    s_add_u32 s23, s22, 24576
    buffer_load_dwordx4 v[120:123], v1, s[8:11], s23 offen sc1
    buffer_load_dwordx4 v[124:127], v5, s[8:11], s23 offen sc1
    s_add_u32 s23, s22, 26624
    buffer_load_dwordx4 v[128:131], v1, s[8:11], s23 offen sc1
    buffer_load_dwordx4 v[132:135], v5, s[8:11], s23 offen sc1
    s_add_u32 s23, s22, 28672
    buffer_load_dwordx4 v[136:139], v1, s[8:11], s23 offen sc1
    buffer_load_dwordx4 v[140:143], v5, s[8:11], s23 offen sc1
    s_add_u32 s23, s22, 30720
    buffer_load_dwordx4 v[144:147], v1, s[8:11], s23 offen sc1
    buffer_load_dwordx4 v[148:151], v5, s[8:11], s23 offen sc1
    s_barrier
    ds_read_b128 v[152:155], v2 offset:0
    ds_read_b128 v[156:159], v2 offset:1024
    ds_read_b128 v[160:163], v2 offset:2048
    ds_read_b128 v[164:167], v2 offset:3072
    ds_read_b128 v[168:171], v2 offset:4096
    s_waitcnt vmcnt(30)
    s_waitcnt lgkmcnt(4)
    v_mfma_f32_16x16x32_bf16 v[192:195], v[152:155], v[24:27], 0
    v_mfma_f32_16x16x32_bf16 v[212:215], v[152:155], v[28:31], 0
    ds_read_b128 v[172:175], v2 offset:10240
    s_waitcnt lgkmcnt(4)
    v_mfma_f32_16x16x32_bf16 v[196:199], v[156:159], v[24:27], 0
    v_mfma_f32_16x16x32_bf16 v[216:219], v[156:159], v[28:31], 0
    ds_read_b128 v[176:179], v2 offset:11264
    s_waitcnt lgkmcnt(4)
    v_mfma_f32_16x16x32_bf16 v[200:203], v[160:163], v[24:27], 0
    v_mfma_f32_16x16x32_bf16 v[220:223], v[160:163], v[28:31], 0
    ds_read_b128 v[180:183], v2 offset:12288
    s_waitcnt lgkmcnt(4)
    v_mfma_f32_16x16x32_bf16 v[204:207], v[164:167], v[24:27], 0
    v_mfma_f32_16x16x32_bf16 v[224:227], v[164:167], v[28:31], 0
    ds_read_b128 v[184:187], v2 offset:13312
    s_waitcnt lgkmcnt(4)
    v_mfma_f32_16x16x32_bf16 v[208:211], v[168:171], v[24:27], 0
    v_mfma_f32_16x16x32_bf16 v[228:231], v[168:171], v[28:31], 0
    ds_read_b128 v[188:191], v2 offset:14336
    s_add_u32 s23, s22, 32768
    buffer_load_dwordx4 v[24:27], v1, s[8:11], s23 offen sc1
    buffer_load_dwordx4 v[28:31], v5, s[8:11], s23 offen sc1
    s_waitcnt vmcnt(30)
    s_waitcnt lgkmcnt(4)
    v_mfma_f32_16x16x32_bf16 v[192:195], v[172:175], v[32:35], v[192:195]
    v_mfma_f32_16x16x32_bf16 v[212:215], v[172:175], v[36:39], v[212:215]
    s_barrier
    ds_read_b128 v[152:155], v2 offset:20480
    s_waitcnt lgkmcnt(4)
    v_mfma_f32_16x16x32_bf16 v[196:199], v[176:179], v[32:35], v[196:199]
    v_mfma_f32_16x16x32_bf16 v[216:219], v[176:179], v[36:39], v[216:219]
    ds_read_b128 v[156:159], v2 offset:21504
    s_waitcnt lgkmcnt(4)
    v_mfma_f32_16x16x32_bf16 v[200:203], v[180:183], v[32:35], v[200:203]
    v_mfma_f32_16x16x32_bf16 v[220:223], v[180:183], v[36:39], v[220:223]
    ds_read_b128 v[160:163], v2 offset:22528
    s_waitcnt lgkmcnt(4)
    v_mfma_f32_16x16x32_bf16 v[204:207], v[184:187], v[32:35], v[204:207]
    v_mfma_f32_16x16x32_bf16 v[224:227], v[184:187], v[36:39], v[224:227]
    ds_read_b128 v[164:167], v2 offset:23552
    s_waitcnt lgkmcnt(4)
    v_mfma_f32_16x16x32_bf16 v[208:211], v[188:191], v[32:35], v[208:211]
    v_mfma_f32_16x16x32_bf16 v[228:231], v[188:191], v[36:39], v[228:231]
    ds_read_b128 v[168:171], v2 offset:24576
    s_add_u32 s23, s22, 34816
    buffer_load_dwordx4 v[32:35], v1, s[8:11], s23 offen sc1
    buffer_load_dwordx4 v[36:39], v5, s[8:11], s23 offen sc1
    s_waitcnt vmcnt(30)
    s_waitcnt lgkmcnt(4)
    v_mfma_f32_16x16x32_bf16 v[192:195], v[152:155], v[40:43], v[192:195]
    v_mfma_f32_16x16x32_bf16 v[212:215], v[152:155], v[44:47], v[212:215]
    ds_read_b128 v[172:175], v2 offset:30720
    s_waitcnt lgkmcnt(4)
    v_mfma_f32_16x16x32_bf16 v[196:199], v[156:159], v[40:43], v[196:199]
    v_mfma_f32_16x16x32_bf16 v[216:219], v[156:159], v[44:47], v[216:219]
    ds_read_b128 v[176:179], v2 offset:31744
    s_waitcnt lgkmcnt(4)
    v_mfma_f32_16x16x32_bf16 v[200:203], v[160:163], v[40:43], v[200:203]
    v_mfma_f32_16x16x32_bf16 v[220:223], v[160:163], v[44:47], v[220:223]
    ds_read_b128 v[180:183], v2 offset:32768
    s_waitcnt lgkmcnt(4)
    v_mfma_f32_16x16x32_bf16 v[204:207], v[164:167], v[40:43], v[204:207]
    v_mfma_f32_16x16x32_bf16 v[224:227], v[164:167], v[44:47], v[224:227]
    ds_read_b128 v[184:187], v2 offset:33792
    s_waitcnt lgkmcnt(4)
    v_mfma_f32_16x16x32_bf16 v[208:211], v[168:171], v[40:43], v[208:211]
    v_mfma_f32_16x16x32_bf16 v[228:231], v[168:171], v[44:47], v[228:231]
    ds_read_b128 v[188:191], v2 offset:34816
    s_add_u32 s23, s22, 36864
    buffer_load_dwordx4 v[40:43], v1, s[8:11], s23 offen sc1
    buffer_load_dwordx4 v[44:47], v5, s[8:11], s23 offen sc1
    s_waitcnt vmcnt(30)
    s_waitcnt lgkmcnt(4)
    v_mfma_f32_16x16x32_bf16 v[192:195], v[172:175], v[48:51], v[192:195]
    v_mfma_f32_16x16x32_bf16 v[212:215], v[172:175], v[52:55], v[212:215]
    s_barrier
    ds_read_b128 v[152:155], v2 offset:40960
    s_waitcnt lgkmcnt(4)
    v_mfma_f32_16x16x32_bf16 v[196:199], v[176:179], v[48:51], v[196:199]
    v_mfma_f32_16x16x32_bf16 v[216:219], v[176:179], v[52:55], v[216:219]
    ds_read_b128 v[156:159], v2 offset:41984
    s_waitcnt lgkmcnt(4)
    v_mfma_f32_16x16x32_bf16 v[200:203], v[180:183], v[48:51], v[200:203]
    v_mfma_f32_16x16x32_bf16 v[220:223], v[180:183], v[52:55], v[220:223]
    ds_read_b128 v[160:163], v2 offset:43008
    s_waitcnt lgkmcnt(4)
    v_mfma_f32_16x16x32_bf16 v[204:207], v[184:187], v[48:51], v[204:207]
    v_mfma_f32_16x16x32_bf16 v[224:227], v[184:187], v[52:55], v[224:227]
    ds_read_b128 v[164:167], v2 offset:44032
    s_waitcnt lgkmcnt(4)
    v_mfma_f32_16x16x32_bf16 v[208:211], v[188:191], v[48:51], v[208:211]
    v_mfma_f32_16x16x32_bf16 v[228:231], v[188:191], v[52:55], v[228:231]
    ds_read_b128 v[168:171], v2 offset:45056
    s_add_u32 s23, s22, 38912
    buffer_load_dwordx4 v[48:51], v1, s[8:11], s23 offen sc1
    buffer_load_dwordx4 v[52:55], v5, s[8:11], s23 offen sc1
    s_waitcnt vmcnt(30)
    s_waitcnt lgkmcnt(4)
    v_mfma_f32_16x16x32_bf16 v[192:195], v[152:155], v[56:59], v[192:195]
    v_mfma_f32_16x16x32_bf16 v[212:215], v[152:155], v[60:63], v[212:215]
    ds_read_b128 v[172:175], v2 offset:51200
    s_waitcnt lgkmcnt(4)
    v_mfma_f32_16x16x32_bf16 v[196:199], v[156:159], v[56:59], v[196:199]
    v_mfma_f32_16x16x32_bf16 v[216:219], v[156:159], v[60:63], v[216:219]
    ds_read_b128 v[176:179], v2 offset:52224
    s_waitcnt lgkmcnt(4)
    v_mfma_f32_16x16x32_bf16 v[200:203], v[160:163], v[56:59], v[200:203]
    v_mfma_f32_16x16x32_bf16 v[220:223], v[160:163], v[60:63], v[220:223]
    ds_read_b128 v[180:183], v2 offset:53248
    s_waitcnt lgkmcnt(4)
    v_mfma_f32_16x16x32_bf16 v[204:207], v[164:167], v[56:59], v[204:207]
    v_mfma_f32_16x16x32_bf16 v[224:227], v[164:167], v[60:63], v[224:227]
    ds_read_b128 v[184:187], v2 offset:54272
    s_waitcnt lgkmcnt(4)
    v_mfma_f32_16x16x32_bf16 v[208:211], v[168:171], v[56:59], v[208:211]
    v_mfma_f32_16x16x32_bf16 v[228:231], v[168:171], v[60:63], v[228:231]
    ds_read_b128 v[188:191], v2 offset:55296
    s_add_u32 s23, s22, 40960
    buffer_load_dwordx4 v[56:59], v1, s[8:11], s23 offen sc1
    buffer_load_dwordx4 v[60:63], v5, s[8:11], s23 offen sc1
    s_waitcnt vmcnt(30)
    s_waitcnt lgkmcnt(4)
    v_mfma_f32_16x16x32_bf16 v[192:195], v[172:175], v[64:67], v[192:195]
    v_mfma_f32_16x16x32_bf16 v[212:215], v[172:175], v[68:71], v[212:215]
    s_barrier
    ds_read_b128 v[152:155], v2 offset:61440
    s_waitcnt lgkmcnt(4)
    v_mfma_f32_16x16x32_bf16 v[196:199], v[176:179], v[64:67], v[196:199]
    v_mfma_f32_16x16x32_bf16 v[216:219], v[176:179], v[68:71], v[216:219]
    ds_read_b128 v[156:159], v2 offset:62464
    s_waitcnt lgkmcnt(4)
    v_mfma_f32_16x16x32_bf16 v[200:203], v[180:183], v[64:67], v[200:203]
    v_mfma_f32_16x16x32_bf16 v[220:223], v[180:183], v[68:71], v[220:223]
    ds_read_b128 v[160:163], v2 offset:63488
    s_waitcnt lgkmcnt(4)
    v_mfma_f32_16x16x32_bf16 v[204:207], v[184:187], v[64:67], v[204:207]
    v_mfma_f32_16x16x32_bf16 v[224:227], v[184:187], v[68:71], v[224:227]
    ds_read_b128 v[164:167], v2 offset:64512
    s_waitcnt lgkmcnt(4)
    v_mfma_f32_16x16x32_bf16 v[208:211], v[188:191], v[64:67], v[208:211]
    v_mfma_f32_16x16x32_bf16 v[228:231], v[188:191], v[68:71], v[228:231]
    ds_read_b128 v[168:171], v3 offset:0
    s_add_u32 s23, s22, 43008
    buffer_load_dwordx4 v[64:67], v1, s[8:11], s23 offen sc1
    buffer_load_dwordx4 v[68:71], v5, s[8:11], s23 offen sc1
    s_waitcnt vmcnt(30)
    s_waitcnt lgkmcnt(4)
    v_mfma_f32_16x16x32_bf16 v[192:195], v[152:155], v[72:75], v[192:195]
    v_mfma_f32_16x16x32_bf16 v[212:215], v[152:155], v[76:79], v[212:215]
    ds_read_b128 v[172:175], v3 offset:6144
    s_waitcnt lgkmcnt(4)
    v_mfma_f32_16x16x32_bf16 v[196:199], v[156:159], v[72:75], v[196:199]
    v_mfma_f32_16x16x32_bf16 v[216:219], v[156:159], v[76:79], v[216:219]
    ds_read_b128 v[176:179], v3 offset:7168
    s_waitcnt lgkmcnt(4)
    v_mfma_f32_16x16x32_bf16 v[200:203], v[160:163], v[72:75], v[200:203]
    v_mfma_f32_16x16x32_bf16 v[220:223], v[160:163], v[76:79], v[220:223]
    ds_read_b128 v[180:183], v3 offset:8192
    s_waitcnt lgkmcnt(4)
    v_mfma_f32_16x16x32_bf16 v[204:207], v[164:167], v[72:75], v[204:207]
    v_mfma_f32_16x16x32_bf16 v[224:227], v[164:167], v[76:79], v[224:227]
    ds_read_b128 v[184:187], v3 offset:9216
    s_waitcnt lgkmcnt(4)
    v_mfma_f32_16x16x32_bf16 v[208:211], v[168:171], v[72:75], v[208:211]
    v_mfma_f32_16x16x32_bf16 v[228:231], v[168:171], v[76:79], v[228:231]
    ds_read_b128 v[188:191], v3 offset:10240
    s_add_u32 s23, s22, 45056
    buffer_load_dwordx4 v[72:75], v1, s[8:11], s23 offen sc1
    buffer_load_dwordx4 v[76:79], v5, s[8:11], s23 offen sc1
    s_waitcnt vmcnt(30)
    s_waitcnt lgkmcnt(4)
    v_mfma_f32_16x16x32_bf16 v[192:195], v[172:175], v[80:83], v[192:195]
    v_mfma_f32_16x16x32_bf16 v[212:215], v[172:175], v[84:87], v[212:215]
    s_barrier
    ds_read_b128 v[152:155], v3 offset:16384
    s_waitcnt lgkmcnt(4)
    v_mfma_f32_16x16x32_bf16 v[196:199], v[176:179], v[80:83], v[196:199]
    v_mfma_f32_16x16x32_bf16 v[216:219], v[176:179], v[84:87], v[216:219]
    ds_read_b128 v[156:159], v3 offset:17408
    s_waitcnt lgkmcnt(4)
    v_mfma_f32_16x16x32_bf16 v[200:203], v[180:183], v[80:83], v[200:203]
    v_mfma_f32_16x16x32_bf16 v[220:223], v[180:183], v[84:87], v[220:223]
    ds_read_b128 v[160:163], v3 offset:18432
    s_waitcnt lgkmcnt(4)
    v_mfma_f32_16x16x32_bf16 v[204:207], v[184:187], v[80:83], v[204:207]
    v_mfma_f32_16x16x32_bf16 v[224:227], v[184:187], v[84:87], v[224:227]
    ds_read_b128 v[164:167], v3 offset:19456
    s_waitcnt lgkmcnt(4)
    v_mfma_f32_16x16x32_bf16 v[208:211], v[188:191], v[80:83], v[208:211]
    v_mfma_f32_16x16x32_bf16 v[228:231], v[188:191], v[84:87], v[228:231]
    ds_read_b128 v[168:171], v3 offset:20480
    s_add_u32 s23, s22, 47104
    buffer_load_dwordx4 v[80:83], v1, s[8:11], s23 offen sc1
    buffer_load_dwordx4 v[84:87], v5, s[8:11], s23 offen sc1
    v_lshlrev_b32 v244, 7, v0
    s_mov_b64 exec, 1048575
    s_lshl_b32 s26, s4, 10
    s_add_u32 s26, s26, 47185920
    s_mov_b64 exec, 0xff
    buffer_load_dword v245, v244, s[8:11], s26 offen sc1
    s_mov_b64 exec, -1
    s_waitcnt vmcnt(31)
    s_waitcnt lgkmcnt(4)
    v_mfma_f32_16x16x32_bf16 v[192:195], v[152:155], v[88:91], v[192:195]
    v_mfma_f32_16x16x32_bf16 v[212:215], v[152:155], v[92:95], v[212:215]
    ds_read_b128 v[172:175], v3 offset:26624
    s_waitcnt lgkmcnt(4)
    v_mfma_f32_16x16x32_bf16 v[196:199], v[156:159], v[88:91], v[196:199]
    v_mfma_f32_16x16x32_bf16 v[216:219], v[156:159], v[92:95], v[216:219]
    ds_read_b128 v[176:179], v3 offset:27648
    s_waitcnt lgkmcnt(4)
    v_mfma_f32_16x16x32_bf16 v[200:203], v[160:163], v[88:91], v[200:203]
    v_mfma_f32_16x16x32_bf16 v[220:223], v[160:163], v[92:95], v[220:223]
    ds_read_b128 v[180:183], v3 offset:28672
    s_waitcnt lgkmcnt(4)
    v_mfma_f32_16x16x32_bf16 v[204:207], v[164:167], v[88:91], v[204:207]
    v_mfma_f32_16x16x32_bf16 v[224:227], v[164:167], v[92:95], v[224:227]
    ds_read_b128 v[184:187], v3 offset:29696
    s_waitcnt lgkmcnt(4)
    v_mfma_f32_16x16x32_bf16 v[208:211], v[168:171], v[88:91], v[208:211]
    v_mfma_f32_16x16x32_bf16 v[228:231], v[168:171], v[92:95], v[228:231]
    ds_read_b128 v[188:191], v3 offset:30720
    s_waitcnt vmcnt(29)
    s_waitcnt lgkmcnt(4)
    v_mfma_f32_16x16x32_bf16 v[192:195], v[172:175], v[96:99], v[192:195]
    v_mfma_f32_16x16x32_bf16 v[212:215], v[172:175], v[100:103], v[212:215]
    s_barrier
    ds_read_b128 v[152:155], v3 offset:36864
    s_waitcnt lgkmcnt(4)
    v_mfma_f32_16x16x32_bf16 v[196:199], v[176:179], v[96:99], v[196:199]
    v_mfma_f32_16x16x32_bf16 v[216:219], v[176:179], v[100:103], v[216:219]
    ds_read_b128 v[156:159], v3 offset:37888
    s_waitcnt lgkmcnt(4)
    v_mfma_f32_16x16x32_bf16 v[200:203], v[180:183], v[96:99], v[200:203]
    v_mfma_f32_16x16x32_bf16 v[220:223], v[180:183], v[100:103], v[220:223]
    ds_read_b128 v[160:163], v3 offset:38912
    s_waitcnt lgkmcnt(4)
    v_mfma_f32_16x16x32_bf16 v[204:207], v[184:187], v[96:99], v[204:207]
    v_mfma_f32_16x16x32_bf16 v[224:227], v[184:187], v[100:103], v[224:227]
    ds_read_b128 v[164:167], v3 offset:39936
    s_waitcnt lgkmcnt(4)
    v_mfma_f32_16x16x32_bf16 v[208:211], v[188:191], v[96:99], v[208:211]
    v_mfma_f32_16x16x32_bf16 v[228:231], v[188:191], v[100:103], v[228:231]
    ds_read_b128 v[168:171], v3 offset:40960
    s_waitcnt vmcnt(27)
    s_waitcnt lgkmcnt(4)
    v_mfma_f32_16x16x32_bf16 v[192:195], v[152:155], v[104:107], v[192:195]
    v_mfma_f32_16x16x32_bf16 v[212:215], v[152:155], v[108:111], v[212:215]
    ds_read_b128 v[172:175], v3 offset:47104
    s_waitcnt lgkmcnt(4)
    v_mfma_f32_16x16x32_bf16 v[196:199], v[156:159], v[104:107], v[196:199]
    v_mfma_f32_16x16x32_bf16 v[216:219], v[156:159], v[108:111], v[216:219]
    ds_read_b128 v[176:179], v3 offset:48128
    s_waitcnt lgkmcnt(4)
    v_mfma_f32_16x16x32_bf16 v[200:203], v[160:163], v[104:107], v[200:203]
    v_mfma_f32_16x16x32_bf16 v[220:223], v[160:163], v[108:111], v[220:223]
    ds_read_b128 v[180:183], v3 offset:49152
    s_waitcnt lgkmcnt(4)
    v_mfma_f32_16x16x32_bf16 v[204:207], v[164:167], v[104:107], v[204:207]
    v_mfma_f32_16x16x32_bf16 v[224:227], v[164:167], v[108:111], v[224:227]
    ds_read_b128 v[184:187], v3 offset:50176
    s_waitcnt lgkmcnt(4)
    v_mfma_f32_16x16x32_bf16 v[208:211], v[168:171], v[104:107], v[208:211]
    v_mfma_f32_16x16x32_bf16 v[228:231], v[168:171], v[108:111], v[228:231]
    ds_read_b128 v[188:191], v3 offset:51200
    s_waitcnt vmcnt(25)
    s_waitcnt lgkmcnt(4)
    v_mfma_f32_16x16x32_bf16 v[192:195], v[172:175], v[112:115], v[192:195]
    v_mfma_f32_16x16x32_bf16 v[212:215], v[172:175], v[116:119], v[212:215]
    s_barrier
    ds_read_b128 v[152:155], v3 offset:57344
    s_waitcnt lgkmcnt(4)
    v_mfma_f32_16x16x32_bf16 v[196:199], v[176:179], v[112:115], v[196:199]
    v_mfma_f32_16x16x32_bf16 v[216:219], v[176:179], v[116:119], v[216:219]
    ds_read_b128 v[156:159], v3 offset:58368
    s_waitcnt lgkmcnt(4)
    v_mfma_f32_16x16x32_bf16 v[200:203], v[180:183], v[112:115], v[200:203]
    v_mfma_f32_16x16x32_bf16 v[220:223], v[180:183], v[116:119], v[220:223]
    ds_read_b128 v[160:163], v3 offset:59392
    s_waitcnt lgkmcnt(4)
    v_mfma_f32_16x16x32_bf16 v[204:207], v[184:187], v[112:115], v[204:207]
    v_mfma_f32_16x16x32_bf16 v[224:227], v[184:187], v[116:119], v[224:227]
    ds_read_b128 v[164:167], v3 offset:60416
    s_waitcnt lgkmcnt(4)
    v_mfma_f32_16x16x32_bf16 v[208:211], v[188:191], v[112:115], v[208:211]
    v_mfma_f32_16x16x32_bf16 v[228:231], v[188:191], v[116:119], v[228:231]
    ds_read_b128 v[168:171], v3 offset:61440
    s_waitcnt vmcnt(23)
    s_waitcnt lgkmcnt(4)
    v_mfma_f32_16x16x32_bf16 v[192:195], v[152:155], v[120:123], v[192:195]
    v_mfma_f32_16x16x32_bf16 v[212:215], v[152:155], v[124:127], v[212:215]
    ds_read_b128 v[172:175], v2 offset:0
    s_waitcnt lgkmcnt(4)
    v_mfma_f32_16x16x32_bf16 v[196:199], v[156:159], v[120:123], v[196:199]
    v_mfma_f32_16x16x32_bf16 v[216:219], v[156:159], v[124:127], v[216:219]
    ds_read_b128 v[176:179], v2 offset:1024
    s_waitcnt lgkmcnt(4)
    v_mfma_f32_16x16x32_bf16 v[200:203], v[160:163], v[120:123], v[200:203]
    v_mfma_f32_16x16x32_bf16 v[220:223], v[160:163], v[124:127], v[220:223]
    ds_read_b128 v[180:183], v2 offset:2048
    s_waitcnt lgkmcnt(4)
    v_mfma_f32_16x16x32_bf16 v[204:207], v[164:167], v[120:123], v[204:207]
    v_mfma_f32_16x16x32_bf16 v[224:227], v[164:167], v[124:127], v[224:227]
    ds_read_b128 v[184:187], v2 offset:3072
    s_waitcnt lgkmcnt(4)
    v_mfma_f32_16x16x32_bf16 v[208:211], v[168:171], v[120:123], v[208:211]
    v_mfma_f32_16x16x32_bf16 v[228:231], v[168:171], v[124:127], v[228:231]
    ds_read_b128 v[188:191], v2 offset:4096
    s_waitcnt vmcnt(21)
    s_waitcnt lgkmcnt(4)
    v_mfma_f32_16x16x32_bf16 v[192:195], v[172:175], v[128:131], v[192:195]
    v_mfma_f32_16x16x32_bf16 v[212:215], v[172:175], v[132:135], v[212:215]
    s_barrier
    ds_read_b128 v[152:155], v2 offset:10240
    s_waitcnt lgkmcnt(4)
    v_mfma_f32_16x16x32_bf16 v[196:199], v[176:179], v[128:131], v[196:199]
    v_mfma_f32_16x16x32_bf16 v[216:219], v[176:179], v[132:135], v[216:219]
    ds_read_b128 v[156:159], v2 offset:11264
    s_waitcnt lgkmcnt(4)
    v_mfma_f32_16x16x32_bf16 v[200:203], v[180:183], v[128:131], v[200:203]
    v_mfma_f32_16x16x32_bf16 v[220:223], v[180:183], v[132:135], v[220:223]
    ds_read_b128 v[160:163], v2 offset:12288
    s_waitcnt lgkmcnt(4)
    v_mfma_f32_16x16x32_bf16 v[204:207], v[184:187], v[128:131], v[204:207]
    v_mfma_f32_16x16x32_bf16 v[224:227], v[184:187], v[132:135], v[224:227]
    ds_read_b128 v[164:167], v2 offset:13312
    s_waitcnt lgkmcnt(4)
    v_mfma_f32_16x16x32_bf16 v[208:211], v[188:191], v[128:131], v[208:211]
    v_mfma_f32_16x16x32_bf16 v[228:231], v[188:191], v[132:135], v[228:231]
    ds_read_b128 v[168:171], v2 offset:14336
    s_waitcnt vmcnt(19)
    s_waitcnt lgkmcnt(4)
    v_mfma_f32_16x16x32_bf16 v[192:195], v[152:155], v[136:139], v[192:195]
    v_mfma_f32_16x16x32_bf16 v[212:215], v[152:155], v[140:143], v[212:215]
    ds_read_b128 v[172:175], v2 offset:20480
    s_waitcnt lgkmcnt(4)
    v_mfma_f32_16x16x32_bf16 v[196:199], v[156:159], v[136:139], v[196:199]
    v_mfma_f32_16x16x32_bf16 v[216:219], v[156:159], v[140:143], v[216:219]
    ds_read_b128 v[176:179], v2 offset:21504
    s_waitcnt lgkmcnt(4)
    v_mfma_f32_16x16x32_bf16 v[200:203], v[160:163], v[136:139], v[200:203]
    v_mfma_f32_16x16x32_bf16 v[220:223], v[160:163], v[140:143], v[220:223]
    ds_read_b128 v[180:183], v2 offset:22528
    s_waitcnt lgkmcnt(4)
    v_mfma_f32_16x16x32_bf16 v[204:207], v[164:167], v[136:139], v[204:207]
    v_mfma_f32_16x16x32_bf16 v[224:227], v[164:167], v[140:143], v[224:227]
    ds_read_b128 v[184:187], v2 offset:23552
    s_waitcnt lgkmcnt(4)
    v_mfma_f32_16x16x32_bf16 v[208:211], v[168:171], v[136:139], v[208:211]
    v_mfma_f32_16x16x32_bf16 v[228:231], v[168:171], v[140:143], v[228:231]
    ds_read_b128 v[188:191], v2 offset:24576
    s_waitcnt vmcnt(17)
    s_waitcnt lgkmcnt(4)
    v_mfma_f32_16x16x32_bf16 v[192:195], v[172:175], v[144:147], v[192:195]
    v_mfma_f32_16x16x32_bf16 v[212:215], v[172:175], v[148:151], v[212:215]
    s_barrier
    ds_read_b128 v[152:155], v2 offset:30720
    s_waitcnt lgkmcnt(4)
    v_mfma_f32_16x16x32_bf16 v[196:199], v[176:179], v[144:147], v[196:199]
    v_mfma_f32_16x16x32_bf16 v[216:219], v[176:179], v[148:151], v[216:219]
    ds_read_b128 v[156:159], v2 offset:31744
    s_waitcnt lgkmcnt(4)
    v_mfma_f32_16x16x32_bf16 v[200:203], v[180:183], v[144:147], v[200:203]
    v_mfma_f32_16x16x32_bf16 v[220:223], v[180:183], v[148:151], v[220:223]
    ds_read_b128 v[160:163], v2 offset:32768
    s_waitcnt lgkmcnt(4)
    v_mfma_f32_16x16x32_bf16 v[204:207], v[184:187], v[144:147], v[204:207]
    v_mfma_f32_16x16x32_bf16 v[224:227], v[184:187], v[148:151], v[224:227]
    ds_read_b128 v[164:167], v2 offset:33792
    s_waitcnt lgkmcnt(4)
    v_mfma_f32_16x16x32_bf16 v[208:211], v[188:191], v[144:147], v[208:211]
    v_mfma_f32_16x16x32_bf16 v[228:231], v[188:191], v[148:151], v[228:231]
    ds_read_b128 v[168:171], v2 offset:34816
    s_waitcnt vmcnt(15)
    s_waitcnt lgkmcnt(4)
    v_mfma_f32_16x16x32_bf16 v[192:195], v[152:155], v[24:27], v[192:195]
    v_mfma_f32_16x16x32_bf16 v[212:215], v[152:155], v[28:31], v[212:215]
    ds_read_b128 v[172:175], v2 offset:40960
    s_waitcnt lgkmcnt(4)
    v_mfma_f32_16x16x32_bf16 v[196:199], v[156:159], v[24:27], v[196:199]
    v_mfma_f32_16x16x32_bf16 v[216:219], v[156:159], v[28:31], v[216:219]
    ds_read_b128 v[176:179], v2 offset:41984
    s_waitcnt lgkmcnt(4)
    v_mfma_f32_16x16x32_bf16 v[200:203], v[160:163], v[24:27], v[200:203]
    v_mfma_f32_16x16x32_bf16 v[220:223], v[160:163], v[28:31], v[220:223]
    ds_read_b128 v[180:183], v2 offset:43008
    s_waitcnt lgkmcnt(4)
    v_mfma_f32_16x16x32_bf16 v[204:207], v[164:167], v[24:27], v[204:207]
    v_mfma_f32_16x16x32_bf16 v[224:227], v[164:167], v[28:31], v[224:227]
    ds_read_b128 v[184:187], v2 offset:44032
    s_waitcnt lgkmcnt(4)
    v_mfma_f32_16x16x32_bf16 v[208:211], v[168:171], v[24:27], v[208:211]
    v_mfma_f32_16x16x32_bf16 v[228:231], v[168:171], v[28:31], v[228:231]
    ds_read_b128 v[188:191], v2 offset:45056
    s_waitcnt vmcnt(13)
    s_waitcnt lgkmcnt(4)
    v_mfma_f32_16x16x32_bf16 v[192:195], v[172:175], v[32:35], v[192:195]
    v_mfma_f32_16x16x32_bf16 v[212:215], v[172:175], v[36:39], v[212:215]
    s_barrier
    ds_read_b128 v[152:155], v2 offset:51200
    s_waitcnt lgkmcnt(4)
    v_mfma_f32_16x16x32_bf16 v[196:199], v[176:179], v[32:35], v[196:199]
    v_mfma_f32_16x16x32_bf16 v[216:219], v[176:179], v[36:39], v[216:219]
    ds_read_b128 v[156:159], v2 offset:52224
    s_waitcnt lgkmcnt(4)
    v_mfma_f32_16x16x32_bf16 v[200:203], v[180:183], v[32:35], v[200:203]
    v_mfma_f32_16x16x32_bf16 v[220:223], v[180:183], v[36:39], v[220:223]
    ds_read_b128 v[160:163], v2 offset:53248
    s_waitcnt lgkmcnt(4)
    v_mfma_f32_16x16x32_bf16 v[204:207], v[184:187], v[32:35], v[204:207]
    v_mfma_f32_16x16x32_bf16 v[224:227], v[184:187], v[36:39], v[224:227]
    ds_read_b128 v[164:167], v2 offset:54272
    s_waitcnt lgkmcnt(4)
    v_mfma_f32_16x16x32_bf16 v[208:211], v[188:191], v[32:35], v[208:211]
    v_mfma_f32_16x16x32_bf16 v[228:231], v[188:191], v[36:39], v[228:231]
    ds_read_b128 v[168:171], v2 offset:55296
    s_waitcnt vmcnt(11)
    s_waitcnt lgkmcnt(4)
    v_mfma_f32_16x16x32_bf16 v[192:195], v[152:155], v[40:43], v[192:195]
    v_mfma_f32_16x16x32_bf16 v[212:215], v[152:155], v[44:47], v[212:215]
    ds_read_b128 v[172:175], v2 offset:61440
    s_waitcnt lgkmcnt(4)
    v_mfma_f32_16x16x32_bf16 v[196:199], v[156:159], v[40:43], v[196:199]
    v_mfma_f32_16x16x32_bf16 v[216:219], v[156:159], v[44:47], v[216:219]
    ds_read_b128 v[176:179], v2 offset:62464
    s_waitcnt lgkmcnt(4)
    v_mfma_f32_16x16x32_bf16 v[200:203], v[160:163], v[40:43], v[200:203]
    v_mfma_f32_16x16x32_bf16 v[220:223], v[160:163], v[44:47], v[220:223]
    ds_read_b128 v[180:183], v2 offset:63488
    s_waitcnt lgkmcnt(4)
    v_mfma_f32_16x16x32_bf16 v[204:207], v[164:167], v[40:43], v[204:207]
    v_mfma_f32_16x16x32_bf16 v[224:227], v[164:167], v[44:47], v[224:227]
    ds_read_b128 v[184:187], v2 offset:64512
    s_waitcnt lgkmcnt(4)
    v_mfma_f32_16x16x32_bf16 v[208:211], v[168:171], v[40:43], v[208:211]
    v_mfma_f32_16x16x32_bf16 v[228:231], v[168:171], v[44:47], v[228:231]
    ds_read_b128 v[188:191], v3 offset:0
    s_waitcnt vmcnt(9)
    s_waitcnt lgkmcnt(4)
    v_mfma_f32_16x16x32_bf16 v[192:195], v[172:175], v[48:51], v[192:195]
    v_mfma_f32_16x16x32_bf16 v[212:215], v[172:175], v[52:55], v[212:215]
    s_barrier
    ds_read_b128 v[152:155], v3 offset:6144
    s_waitcnt lgkmcnt(4)
    v_mfma_f32_16x16x32_bf16 v[196:199], v[176:179], v[48:51], v[196:199]
    v_mfma_f32_16x16x32_bf16 v[216:219], v[176:179], v[52:55], v[216:219]
    ds_read_b128 v[156:159], v3 offset:7168
    s_waitcnt lgkmcnt(4)
    v_mfma_f32_16x16x32_bf16 v[200:203], v[180:183], v[48:51], v[200:203]
    v_mfma_f32_16x16x32_bf16 v[220:223], v[180:183], v[52:55], v[220:223]
    ds_read_b128 v[160:163], v3 offset:8192
    s_waitcnt lgkmcnt(4)
    v_mfma_f32_16x16x32_bf16 v[204:207], v[184:187], v[48:51], v[204:207]
    v_mfma_f32_16x16x32_bf16 v[224:227], v[184:187], v[52:55], v[224:227]
    ds_read_b128 v[164:167], v3 offset:9216
    s_waitcnt lgkmcnt(4)
    v_mfma_f32_16x16x32_bf16 v[208:211], v[188:191], v[48:51], v[208:211]
    v_mfma_f32_16x16x32_bf16 v[228:231], v[188:191], v[52:55], v[228:231]
    ds_read_b128 v[168:171], v3 offset:10240
    s_waitcnt vmcnt(7)
    s_waitcnt lgkmcnt(4)
    v_mfma_f32_16x16x32_bf16 v[192:195], v[152:155], v[56:59], v[192:195]
    v_mfma_f32_16x16x32_bf16 v[212:215], v[152:155], v[60:63], v[212:215]
    ds_read_b128 v[172:175], v3 offset:16384
    s_waitcnt lgkmcnt(4)
    v_mfma_f32_16x16x32_bf16 v[196:199], v[156:159], v[56:59], v[196:199]
    v_mfma_f32_16x16x32_bf16 v[216:219], v[156:159], v[60:63], v[216:219]
    ds_read_b128 v[176:179], v3 offset:17408
    s_waitcnt lgkmcnt(4)
    v_mfma_f32_16x16x32_bf16 v[200:203], v[160:163], v[56:59], v[200:203]
    v_mfma_f32_16x16x32_bf16 v[220:223], v[160:163], v[60:63], v[220:223]
    ds_read_b128 v[180:183], v3 offset:18432
    s_waitcnt lgkmcnt(4)
    v_mfma_f32_16x16x32_bf16 v[204:207], v[164:167], v[56:59], v[204:207]
    v_mfma_f32_16x16x32_bf16 v[224:227], v[164:167], v[60:63], v[224:227]
    ds_read_b128 v[184:187], v3 offset:19456
    s_waitcnt lgkmcnt(4)
    v_mfma_f32_16x16x32_bf16 v[208:211], v[168:171], v[56:59], v[208:211]
    v_mfma_f32_16x16x32_bf16 v[228:231], v[168:171], v[60:63], v[228:231]
    ds_read_b128 v[188:191], v3 offset:20480
    s_waitcnt vmcnt(5)
    s_waitcnt lgkmcnt(4)
    v_mfma_f32_16x16x32_bf16 v[192:195], v[172:175], v[64:67], v[192:195]
    v_mfma_f32_16x16x32_bf16 v[212:215], v[172:175], v[68:71], v[212:215]
    s_barrier
    ds_read_b128 v[152:155], v3 offset:26624
    s_waitcnt lgkmcnt(4)
    v_mfma_f32_16x16x32_bf16 v[196:199], v[176:179], v[64:67], v[196:199]
    v_mfma_f32_16x16x32_bf16 v[216:219], v[176:179], v[68:71], v[216:219]
    ds_read_b128 v[156:159], v3 offset:27648
    s_waitcnt lgkmcnt(4)
    v_mfma_f32_16x16x32_bf16 v[200:203], v[180:183], v[64:67], v[200:203]
    v_mfma_f32_16x16x32_bf16 v[220:223], v[180:183], v[68:71], v[220:223]
    ds_read_b128 v[160:163], v3 offset:28672
    s_waitcnt lgkmcnt(4)
    v_mfma_f32_16x16x32_bf16 v[204:207], v[184:187], v[64:67], v[204:207]
    v_mfma_f32_16x16x32_bf16 v[224:227], v[184:187], v[68:71], v[224:227]
    ds_read_b128 v[164:167], v3 offset:29696
    s_waitcnt lgkmcnt(4)
    v_mfma_f32_16x16x32_bf16 v[208:211], v[188:191], v[64:67], v[208:211]
    v_mfma_f32_16x16x32_bf16 v[228:231], v[188:191], v[68:71], v[228:231]
    ds_read_b128 v[168:171], v3 offset:30720
    s_waitcnt vmcnt(3)
    s_waitcnt lgkmcnt(4)
    v_mfma_f32_16x16x32_bf16 v[192:195], v[152:155], v[72:75], v[192:195]
    v_mfma_f32_16x16x32_bf16 v[212:215], v[152:155], v[76:79], v[212:215]
    ds_read_b128 v[172:175], v3 offset:36864
    s_waitcnt lgkmcnt(4)
    v_mfma_f32_16x16x32_bf16 v[196:199], v[156:159], v[72:75], v[196:199]
    v_mfma_f32_16x16x32_bf16 v[216:219], v[156:159], v[76:79], v[216:219]
    ds_read_b128 v[176:179], v3 offset:37888
    s_waitcnt lgkmcnt(4)
    v_mfma_f32_16x16x32_bf16 v[200:203], v[160:163], v[72:75], v[200:203]
    v_mfma_f32_16x16x32_bf16 v[220:223], v[160:163], v[76:79], v[220:223]
    ds_read_b128 v[180:183], v3 offset:38912
    s_waitcnt lgkmcnt(4)
    v_mfma_f32_16x16x32_bf16 v[204:207], v[164:167], v[72:75], v[204:207]
    v_mfma_f32_16x16x32_bf16 v[224:227], v[164:167], v[76:79], v[224:227]
    ds_read_b128 v[184:187], v3 offset:39936
    s_waitcnt lgkmcnt(4)
    v_mfma_f32_16x16x32_bf16 v[208:211], v[168:171], v[72:75], v[208:211]
    v_mfma_f32_16x16x32_bf16 v[228:231], v[168:171], v[76:79], v[228:231]
    ds_read_b128 v[188:191], v3 offset:40960
    s_waitcnt vmcnt(1)
    s_waitcnt lgkmcnt(4)
    v_mfma_f32_16x16x32_bf16 v[192:195], v[172:175], v[80:83], v[192:195]
    v_mfma_f32_16x16x32_bf16 v[212:215], v[172:175], v[84:87], v[212:215]
    s_waitcnt lgkmcnt(3)
    v_mfma_f32_16x16x32_bf16 v[196:199], v[176:179], v[80:83], v[196:199]
    v_mfma_f32_16x16x32_bf16 v[216:219], v[176:179], v[84:87], v[216:219]
    s_waitcnt lgkmcnt(2)
    v_mfma_f32_16x16x32_bf16 v[200:203], v[180:183], v[80:83], v[200:203]
    v_mfma_f32_16x16x32_bf16 v[220:223], v[180:183], v[84:87], v[220:223]
    s_waitcnt lgkmcnt(1)
    v_mfma_f32_16x16x32_bf16 v[204:207], v[184:187], v[80:83], v[204:207]
    v_mfma_f32_16x16x32_bf16 v[224:227], v[184:187], v[84:87], v[224:227]
    s_waitcnt lgkmcnt(0)
    v_mfma_f32_16x16x32_bf16 v[208:211], v[188:191], v[80:83], v[208:211]
    v_mfma_f32_16x16x32_bf16 v[228:231], v[188:191], v[84:87], v[228:231]
    s_mul_i32 s20, s3, 5120
    s_xor_b32 s21, s3, 2
    s_mul_i32 s21, s21, 5120
    s_add_u32 s20, s20, 139264
    s_add_u32 s21, s21, 139264
    v_add_u32 v2, s20, v1
    v_add_u32 v3, s21, v1
    s_cmp_eq_u32 s5, 0
    s_cbranch_scc1 main_kernel_kh0_4
    ds_write_b128 v2, v[192:195] offset:0
    ds_write_b128 v2, v[196:199] offset:1024
    ds_write_b128 v2, v[200:203] offset:2048
    ds_write_b128 v2, v[204:207] offset:3072
    ds_write_b128 v2, v[208:211] offset:4096
    s_nop 0
    v_pk_mov_b32 v[192:193], v[212:213], v[212:213] op_sel:[0,1]
    v_pk_mov_b32 v[194:195], v[214:215], v[214:215] op_sel:[0,1]
    v_pk_mov_b32 v[196:197], v[216:217], v[216:217] op_sel:[0,1]
    v_pk_mov_b32 v[198:199], v[218:219], v[218:219] op_sel:[0,1]
    v_pk_mov_b32 v[200:201], v[220:221], v[220:221] op_sel:[0,1]
    v_pk_mov_b32 v[202:203], v[222:223], v[222:223] op_sel:[0,1]
    v_pk_mov_b32 v[204:205], v[224:225], v[224:225] op_sel:[0,1]
    v_pk_mov_b32 v[206:207], v[226:227], v[226:227] op_sel:[0,1]
    v_pk_mov_b32 v[208:209], v[228:229], v[228:229] op_sel:[0,1]
    v_pk_mov_b32 v[210:211], v[230:231], v[230:231] op_sel:[0,1]
    s_branch main_kernel_red_4
main_kernel_kh0_4:
    ds_write_b128 v2, v[212:215] offset:0
    ds_write_b128 v2, v[216:219] offset:1024
    ds_write_b128 v2, v[220:223] offset:2048
    ds_write_b128 v2, v[224:227] offset:3072
    ds_write_b128 v2, v[228:231] offset:4096
main_kernel_red_4:
    s_waitcnt lgkmcnt(0)
    s_barrier
    ds_read_b128 v[212:215], v3 offset:0
    ds_read_b128 v[216:219], v3 offset:1024
    ds_read_b128 v[220:223], v3 offset:2048
    ds_read_b128 v[224:227], v3 offset:3072
    ds_read_b128 v[228:231], v3 offset:4096
    v_lshlrev_b32 v24, 16, v232
    v_and_b32 v25, 0xffff0000, v232
    v_lshlrev_b32 v26, 16, v233
    v_and_b32 v27, 0xffff0000, v233
    v_pk_add_f32 v[192:193], v[24:25], v[192:193]
    v_pk_add_f32 v[194:195], v[26:27], v[194:195]
    v_lshlrev_b32 v28, 16, v234
    v_and_b32 v29, 0xffff0000, v234
    v_lshlrev_b32 v30, 16, v235
    v_and_b32 v31, 0xffff0000, v235
    v_pk_add_f32 v[196:197], v[28:29], v[196:197]
    v_pk_add_f32 v[198:199], v[30:31], v[198:199]
    v_lshlrev_b32 v32, 16, v236
    v_and_b32 v33, 0xffff0000, v236
    v_lshlrev_b32 v34, 16, v237
    v_and_b32 v35, 0xffff0000, v237
    v_pk_add_f32 v[200:201], v[32:33], v[200:201]
    v_pk_add_f32 v[202:203], v[34:35], v[202:203]
    v_lshlrev_b32 v36, 16, v238
    v_and_b32 v37, 0xffff0000, v238
    v_lshlrev_b32 v38, 16, v239
    v_and_b32 v39, 0xffff0000, v239
    v_pk_add_f32 v[204:205], v[36:37], v[204:205]
    v_pk_add_f32 v[206:207], v[38:39], v[206:207]
    v_lshlrev_b32 v40, 16, v240
    v_and_b32 v41, 0xffff0000, v240
    v_lshlrev_b32 v42, 16, v241
    v_and_b32 v43, 0xffff0000, v241
    v_pk_add_f32 v[208:209], v[40:41], v[208:209]
    v_pk_add_f32 v[210:211], v[42:43], v[210:211]
    s_add_u32 s25, s24, 8388608
    s_waitcnt lgkmcnt(4)
    v_pk_add_f32 v[192:193], v[192:193], v[212:213]
    v_pk_add_f32 v[194:195], v[194:195], v[214:215]
    v_cvt_pk_bf16_f32 v152, v192, v193
    v_cvt_pk_bf16_f32 v153, v194, v195
    s_waitcnt lgkmcnt(3)
    v_pk_add_f32 v[196:197], v[196:197], v[216:217]
    v_pk_add_f32 v[198:199], v[198:199], v[218:219]
    v_cvt_pk_bf16_f32 v154, v196, v197
    v_cvt_pk_bf16_f32 v155, v198, v199
    s_nop 1
    v_permlane16_swap_b32 v152, v154
    v_permlane16_swap_b32 v153, v155
    buffer_store_dwordx4 v[152:155], v9, s[8:11], s25 offen offset:0
    s_waitcnt lgkmcnt(2)
    v_pk_add_f32 v[200:201], v[200:201], v[220:221]
    v_pk_add_f32 v[202:203], v[202:203], v[222:223]
    v_cvt_pk_bf16_f32 v156, v200, v201
    v_cvt_pk_bf16_f32 v157, v202, v203
    s_waitcnt lgkmcnt(1)
    v_pk_add_f32 v[204:205], v[204:205], v[224:225]
    v_pk_add_f32 v[206:207], v[206:207], v[226:227]
    v_cvt_pk_bf16_f32 v158, v204, v205
    v_cvt_pk_bf16_f32 v159, v206, v207
    s_nop 1
    v_permlane16_swap_b32 v156, v158
    v_permlane16_swap_b32 v157, v159
    buffer_store_dwordx4 v[156:159], v9, s[8:11], s25 offen offset:1024
    s_waitcnt lgkmcnt(0)
    v_pk_add_f32 v[208:209], v[208:209], v[228:229]
    v_pk_add_f32 v[210:211], v[210:211], v[230:231]
    v_cvt_pk_bf16_f32 v160, v208, v209
    v_cvt_pk_bf16_f32 v161, v210, v211
    buffer_store_dwordx2 v[160:161], v8, s[8:11], s25 offen offset:2048
    v_pk_add_f32 v[10:11], v[192:193], v[194:195]
    v_pk_mul_f32 v[12:13], v[192:193], v[192:193]
    v_pk_fma_f32 v[12:13], v[194:195], v[194:195], v[12:13]
    v_pk_add_f32 v[10:11], v[10:11], v[196:197]
    v_pk_fma_f32 v[12:13], v[196:197], v[196:197], v[12:13]
    v_pk_add_f32 v[10:11], v[10:11], v[198:199]
    v_pk_fma_f32 v[12:13], v[198:199], v[198:199], v[12:13]
    v_pk_add_f32 v[10:11], v[10:11], v[200:201]
    v_pk_fma_f32 v[12:13], v[200:201], v[200:201], v[12:13]
    v_pk_add_f32 v[10:11], v[10:11], v[202:203]
    v_pk_fma_f32 v[12:13], v[202:203], v[202:203], v[12:13]
    v_pk_add_f32 v[10:11], v[10:11], v[204:205]
    v_pk_fma_f32 v[12:13], v[204:205], v[204:205], v[12:13]
    v_pk_add_f32 v[10:11], v[10:11], v[206:207]
    v_pk_fma_f32 v[12:13], v[206:207], v[206:207], v[12:13]
    v_pk_add_f32 v[10:11], v[10:11], v[208:209]
    v_pk_fma_f32 v[12:13], v[208:209], v[208:209], v[12:13]
    v_pk_add_f32 v[10:11], v[10:11], v[210:211]
    v_pk_fma_f32 v[12:13], v[210:211], v[210:211], v[12:13]
    v_add_f32 v10, v10, v11
    v_add_f32 v11, v12, v13
    v_mov_b32 v12, v10
    s_nop 1
    v_permlane32_swap_b32 v10, v12
    s_nop 1
    v_add_f32 v10, v10, v12
    v_mov_b32 v13, v11
    s_nop 1
    v_permlane32_swap_b32 v11, v13
    s_nop 1
    v_add_f32 v11, v11, v13
    v_mov_b32 v12, v10
    s_nop 1
    v_permlane16_swap_b32 v10, v12
    s_nop 1
    v_add_f32 v10, v10, v12
    v_mov_b32 v13, v11
    s_nop 1
    v_permlane16_swap_b32 v11, v13
    s_nop 1
    v_add_f32 v11, v11, v13
    s_lshl_b32 s24, s4, 10
    s_lshl_b32 s25, s51, 3
    s_add_u32 s24, s24, s25
    s_add_u32 s24, s24, 47185920
    v_lshlrev_b32 v12, 6, v6
    s_mov_b64 exec, 0xffff
    buffer_store_dwordx2 v[10:11], v12, s[8:11], s24 offen
    s_mov_b64 exec, -1
    s_waitcnt vmcnt(0)
    s_barrier
    s_cmp_lg_u32 s3, 0
    s_cbranch_scc1 main_kernel_sig8
    s_add_u32 s44, s52, 48300032
    v_mov_b32 v246, 1
    s_mov_b64 exec, 1
    s_cmp_lg_u32 s84, 0
    s_cbranch_scc1 main_kernel_sig8s
    buffer_store_dword v246, off, s[8:11], s44
    s_branch main_kernel_sig8e
main_kernel_sig8s:
    buffer_wbl2 sc1
    s_waitcnt vmcnt(0)
    buffer_store_dword v246, off, s[8:11], s44 sc1
main_kernel_sig8e:
    s_mov_b64 exec, -1
main_kernel_sig8:
    v_lshlrev_b32 v1, 4, v0
    v_and_b32 v6, 15, v0
    v_lshrrev_b32 v7, 4, v0
    s_and_b32 s7, s3, 1
    s_lshr_b32 s5, s3, 1
    s_lshl_b32 s4, s50, 2
    s_lshl_b32 s20, s7, 1
    s_add_u32 s4, s4, s20
    s_mul_i32 s22, s4, 20480
    s_lshl_b32 s20, s5, 10
    s_add_u32 s22, s22, s20
    s_add_u32 s22, s22, 8388608
    s_add_u32 s4, s4, s5
    s_mul_i32 s20, s5, 6144
    v_add_u32 v2, s20, v1
    v_add_u32 v3, 0x10000, v2
    v_add_u32 v4, 0x20000, v2
    v_add_u32 v5, 20480, v1
    v_lshrrev_b32 v10, 1, v7
    v_and_b32 v11, 1, v7
    v_lshlrev_b32 v8, 8, v10
    v_lshl_add_u32 v8, v6, 4, v8
    v_lshl_add_u32 v9, v11, 9, v8
    v_lshl_add_u32 v8, v11, 3, v8
    s_cmp_lg_u32 s3, 0
    s_cbranch_scc1 main_kernel_poll9p
    v_lshlrev_b32 v250, 2, v0
    s_mov_b32 s45, 0x200000
    s_add_u32 s44, s59, 48300032
    s_mov_b64 exec, 255
main_kernel_poll9_0:
    buffer_load_dword v246, v250, s[8:11], s44 offen sc1
    s_waitcnt vmcnt(0)
    v_cmp_ne_u32 vcc, 1, v246
    s_sub_u32 s45, s45, 1
    s_cbranch_scc1 main_kernel_poll9d
    s_cmp_eq_u64 vcc, 0
    s_cbranch_scc0 main_kernel_poll9_0
    s_mov_b64 exec, -1
main_kernel_poll9d:
    s_mov_b64 exec, -1
    s_cmp_eq_u32 s84, 0
    s_cbranch_scc1 main_kernel_poll9p
    buffer_inv sc1
    s_waitcnt vmcnt(0)
main_kernel_poll9p:
    s_barrier
    s_lshl_b32 s26, s4, 10
    s_add_u32 s26, s26, 47185920
    v_lshlrev_b32 v12, 6, v6
    v_lshl_add_u32 v12, v7, 4, v12
    buffer_load_dwordx4 v[12:15], v12, s[8:11], s26 offen sc1
    s_add_u32 s23, s22, 0
    buffer_load_dwordx4 v[24:27], v1, s[8:11], s23 offen sc1
    buffer_load_dwordx4 v[28:31], v5, s[8:11], s23 offen sc1
    s_add_u32 s23, s22, 2048
    buffer_load_dwordx4 v[32:35], v1, s[8:11], s23 offen sc1
    buffer_load_dwordx4 v[36:39], v5, s[8:11], s23 offen sc1
    s_add_u32 s23, s22, 4096
    buffer_load_dwordx4 v[40:43], v1, s[8:11], s23 offen sc1
    buffer_load_dwordx4 v[44:47], v5, s[8:11], s23 offen sc1
    s_add_u32 s23, s22, 6144
    buffer_load_dwordx4 v[48:51], v1, s[8:11], s23 offen sc1
    buffer_load_dwordx4 v[52:55], v5, s[8:11], s23 offen sc1
    s_add_u32 s23, s22, 8192
    buffer_load_dwordx4 v[56:59], v1, s[8:11], s23 offen sc1
    buffer_load_dwordx4 v[60:63], v5, s[8:11], s23 offen sc1
    s_add_u32 s23, s22, 10240
    buffer_load_dwordx4 v[64:67], v1, s[8:11], s23 offen sc1
    buffer_load_dwordx4 v[68:71], v5, s[8:11], s23 offen sc1
    s_add_u32 s23, s22, 12288
    buffer_load_dwordx4 v[72:75], v1, s[8:11], s23 offen sc1
    buffer_load_dwordx4 v[76:79], v5, s[8:11], s23 offen sc1
    s_add_u32 s23, s22, 14336
    buffer_load_dwordx4 v[80:83], v1, s[8:11], s23 offen sc1
    buffer_load_dwordx4 v[84:87], v5, s[8:11], s23 offen sc1
    s_add_u32 s23, s22, 16384
    buffer_load_dwordx4 v[88:91], v1, s[8:11], s23 offen sc1
    buffer_load_dwordx4 v[92:95], v5, s[8:11], s23 offen sc1
    s_add_u32 s23, s22, 18432
    buffer_load_dwordx4 v[96:99], v1, s[8:11], s23 offen sc1
    buffer_load_dwordx4 v[100:103], v5, s[8:11], s23 offen sc1
    s_mov_b32 s28, 252314624
    s_mov_b32 s29, 606018068
    s_lshl_b32 s26, s51, 3
    s_lshr_b64 s[28:29], s[28:29], s26
    s_and_b32 s28, s28, 0xff
    s_lshl_b32 s28, s28, 9
    s_mul_i32 s26, s4, 20480
    s_add_u32 s26, s26, s28
    s_add_u32 s26, s26, 20970496
    v_lshlrev_b32 v244, 7, v0
    s_mov_b64 exec, 16777215
    buffer_load_dword v245, v244, s[8:11], s26 offen sc1
    s_mov_b64 exec, -1
    s_barrier
    ds_read_b128 v[104:107], v2 offset:0
    ds_read_b128 v[108:111], v2 offset:1024
    ds_read_b128 v[112:115], v2 offset:2048
    ds_read_b128 v[116:119], v2 offset:3072
    ds_read_b128 v[120:123], v2 offset:4096
    ds_read_b128 v[124:127], v2 offset:5120
    s_waitcnt vmcnt(19)
    s_waitcnt lgkmcnt(5)
    v_mfma_f32_16x16x32_bf16 v[152:155], v[104:107], v[24:27], 0
    v_mfma_f32_16x16x32_bf16 v[176:179], v[104:107], v[28:31], 0
    ds_read_b128 v[128:131], v2 offset:12288
    s_waitcnt lgkmcnt(5)
    v_mfma_f32_16x16x32_bf16 v[156:159], v[108:111], v[24:27], 0
    v_mfma_f32_16x16x32_bf16 v[180:183], v[108:111], v[28:31], 0
    ds_read_b128 v[132:135], v2 offset:13312
    s_waitcnt lgkmcnt(5)
    v_mfma_f32_16x16x32_bf16 v[160:163], v[112:115], v[24:27], 0
    v_mfma_f32_16x16x32_bf16 v[184:187], v[112:115], v[28:31], 0
    ds_read_b128 v[136:139], v2 offset:14336
    s_waitcnt lgkmcnt(5)
    v_mfma_f32_16x16x32_bf16 v[164:167], v[116:119], v[24:27], 0
    v_mfma_f32_16x16x32_bf16 v[188:191], v[116:119], v[28:31], 0
    ds_read_b128 v[140:143], v2 offset:15360
    s_waitcnt lgkmcnt(5)
    v_mfma_f32_16x16x32_bf16 v[168:171], v[120:123], v[24:27], 0
    v_mfma_f32_16x16x32_bf16 v[192:195], v[120:123], v[28:31], 0
    ds_read_b128 v[144:147], v2 offset:16384
    s_waitcnt lgkmcnt(5)
    v_mfma_f32_16x16x32_bf16 v[172:175], v[124:127], v[24:27], 0
    v_mfma_f32_16x16x32_bf16 v[196:199], v[124:127], v[28:31], 0
    ds_read_b128 v[148:151], v2 offset:17408
    s_waitcnt vmcnt(17)
    s_waitcnt lgkmcnt(5)
    v_mfma_f32_16x16x32_bf16 v[152:155], v[128:131], v[32:35], v[152:155]
    v_mfma_f32_16x16x32_bf16 v[176:179], v[128:131], v[36:39], v[176:179]
    s_barrier
    ds_read_b128 v[104:107], v2 offset:24576
    s_waitcnt lgkmcnt(5)
    v_mfma_f32_16x16x32_bf16 v[156:159], v[132:135], v[32:35], v[156:159]
    v_mfma_f32_16x16x32_bf16 v[180:183], v[132:135], v[36:39], v[180:183]
    ds_read_b128 v[108:111], v2 offset:25600
    s_waitcnt lgkmcnt(5)
    v_mfma_f32_16x16x32_bf16 v[160:163], v[136:139], v[32:35], v[160:163]
    v_mfma_f32_16x16x32_bf16 v[184:187], v[136:139], v[36:39], v[184:187]
    ds_read_b128 v[112:115], v2 offset:26624
    s_waitcnt lgkmcnt(5)
    v_mfma_f32_16x16x32_bf16 v[164:167], v[140:143], v[32:35], v[164:167]
    v_mfma_f32_16x16x32_bf16 v[188:191], v[140:143], v[36:39], v[188:191]
    ds_read_b128 v[116:119], v2 offset:27648
    s_waitcnt lgkmcnt(5)
    v_mfma_f32_16x16x32_bf16 v[168:171], v[144:147], v[32:35], v[168:171]
    v_mfma_f32_16x16x32_bf16 v[192:195], v[144:147], v[36:39], v[192:195]
    ds_read_b128 v[120:123], v2 offset:28672
    s_waitcnt lgkmcnt(5)
    v_mfma_f32_16x16x32_bf16 v[172:175], v[148:151], v[32:35], v[172:175]
    v_mfma_f32_16x16x32_bf16 v[196:199], v[148:151], v[36:39], v[196:199]
    ds_read_b128 v[124:127], v2 offset:29696
    s_waitcnt vmcnt(15)
    s_waitcnt lgkmcnt(5)
    v_mfma_f32_16x16x32_bf16 v[152:155], v[104:107], v[40:43], v[152:155]
    v_mfma_f32_16x16x32_bf16 v[176:179], v[104:107], v[44:47], v[176:179]
    ds_read_b128 v[128:131], v2 offset:36864
    s_waitcnt lgkmcnt(5)
    v_mfma_f32_16x16x32_bf16 v[156:159], v[108:111], v[40:43], v[156:159]
    v_mfma_f32_16x16x32_bf16 v[180:183], v[108:111], v[44:47], v[180:183]
    ds_read_b128 v[132:135], v2 offset:37888
    s_waitcnt lgkmcnt(5)
    v_mfma_f32_16x16x32_bf16 v[160:163], v[112:115], v[40:43], v[160:163]
    v_mfma_f32_16x16x32_bf16 v[184:187], v[112:115], v[44:47], v[184:187]
    ds_read_b128 v[136:139], v2 offset:38912
    s_waitcnt lgkmcnt(5)
    v_mfma_f32_16x16x32_bf16 v[164:167], v[116:119], v[40:43], v[164:167]
    v_mfma_f32_16x16x32_bf16 v[188:191], v[116:119], v[44:47], v[188:191]
    ds_read_b128 v[140:143], v2 offset:39936
    s_waitcnt lgkmcnt(5)
    v_mfma_f32_16x16x32_bf16 v[168:171], v[120:123], v[40:43], v[168:171]
    v_mfma_f32_16x16x32_bf16 v[192:195], v[120:123], v[44:47], v[192:195]
    ds_read_b128 v[144:147], v2 offset:40960
    s_waitcnt lgkmcnt(5)
    v_mfma_f32_16x16x32_bf16 v[172:175], v[124:127], v[40:43], v[172:175]
    v_mfma_f32_16x16x32_bf16 v[196:199], v[124:127], v[44:47], v[196:199]
    ds_read_b128 v[148:151], v2 offset:41984
    s_waitcnt vmcnt(13)
    s_waitcnt lgkmcnt(5)
    v_mfma_f32_16x16x32_bf16 v[152:155], v[128:131], v[48:51], v[152:155]
    v_mfma_f32_16x16x32_bf16 v[176:179], v[128:131], v[52:55], v[176:179]
    s_barrier
    ds_read_b128 v[104:107], v2 offset:49152
    s_waitcnt lgkmcnt(5)
    v_mfma_f32_16x16x32_bf16 v[156:159], v[132:135], v[48:51], v[156:159]
    v_mfma_f32_16x16x32_bf16 v[180:183], v[132:135], v[52:55], v[180:183]
    ds_read_b128 v[108:111], v2 offset:50176
    s_waitcnt lgkmcnt(5)
    v_mfma_f32_16x16x32_bf16 v[160:163], v[136:139], v[48:51], v[160:163]
    v_mfma_f32_16x16x32_bf16 v[184:187], v[136:139], v[52:55], v[184:187]
    ds_read_b128 v[112:115], v2 offset:51200
    s_waitcnt lgkmcnt(5)
    v_mfma_f32_16x16x32_bf16 v[164:167], v[140:143], v[48:51], v[164:167]
    v_mfma_f32_16x16x32_bf16 v[188:191], v[140:143], v[52:55], v[188:191]
    ds_read_b128 v[116:119], v2 offset:52224
    s_waitcnt lgkmcnt(5)
    v_mfma_f32_16x16x32_bf16 v[168:171], v[144:147], v[48:51], v[168:171]
    v_mfma_f32_16x16x32_bf16 v[192:195], v[144:147], v[52:55], v[192:195]
    ds_read_b128 v[120:123], v2 offset:53248
    s_waitcnt lgkmcnt(5)
    v_mfma_f32_16x16x32_bf16 v[172:175], v[148:151], v[48:51], v[172:175]
    v_mfma_f32_16x16x32_bf16 v[196:199], v[148:151], v[52:55], v[196:199]
    ds_read_b128 v[124:127], v2 offset:54272
    s_waitcnt vmcnt(11)
    s_waitcnt lgkmcnt(5)
    v_mfma_f32_16x16x32_bf16 v[152:155], v[104:107], v[56:59], v[152:155]
    v_mfma_f32_16x16x32_bf16 v[176:179], v[104:107], v[60:63], v[176:179]
    ds_read_b128 v[128:131], v2 offset:61440
    s_waitcnt lgkmcnt(5)
    v_mfma_f32_16x16x32_bf16 v[156:159], v[108:111], v[56:59], v[156:159]
    v_mfma_f32_16x16x32_bf16 v[180:183], v[108:111], v[60:63], v[180:183]
    ds_read_b128 v[132:135], v2 offset:62464
    s_waitcnt lgkmcnt(5)
    v_mfma_f32_16x16x32_bf16 v[160:163], v[112:115], v[56:59], v[160:163]
    v_mfma_f32_16x16x32_bf16 v[184:187], v[112:115], v[60:63], v[184:187]
    ds_read_b128 v[136:139], v2 offset:63488
    s_waitcnt lgkmcnt(5)
    v_mfma_f32_16x16x32_bf16 v[164:167], v[116:119], v[56:59], v[164:167]
    v_mfma_f32_16x16x32_bf16 v[188:191], v[116:119], v[60:63], v[188:191]
    ds_read_b128 v[140:143], v2 offset:64512
    s_waitcnt lgkmcnt(5)
    v_mfma_f32_16x16x32_bf16 v[168:171], v[120:123], v[56:59], v[168:171]
    v_mfma_f32_16x16x32_bf16 v[192:195], v[120:123], v[60:63], v[192:195]
    ds_read_b128 v[144:147], v3 offset:0
    s_waitcnt lgkmcnt(5)
    v_mfma_f32_16x16x32_bf16 v[172:175], v[124:127], v[56:59], v[172:175]
    v_mfma_f32_16x16x32_bf16 v[196:199], v[124:127], v[60:63], v[196:199]
    ds_read_b128 v[148:151], v3 offset:1024
    s_waitcnt vmcnt(9)
    s_waitcnt lgkmcnt(5)
    v_mfma_f32_16x16x32_bf16 v[152:155], v[128:131], v[64:67], v[152:155]
    v_mfma_f32_16x16x32_bf16 v[176:179], v[128:131], v[68:71], v[176:179]
    s_barrier
    ds_read_b128 v[104:107], v3 offset:8192
    s_waitcnt lgkmcnt(5)
    v_mfma_f32_16x16x32_bf16 v[156:159], v[132:135], v[64:67], v[156:159]
    v_mfma_f32_16x16x32_bf16 v[180:183], v[132:135], v[68:71], v[180:183]
    ds_read_b128 v[108:111], v3 offset:9216
    s_waitcnt lgkmcnt(5)
    v_mfma_f32_16x16x32_bf16 v[160:163], v[136:139], v[64:67], v[160:163]
    v_mfma_f32_16x16x32_bf16 v[184:187], v[136:139], v[68:71], v[184:187]
    ds_read_b128 v[112:115], v3 offset:10240
    s_waitcnt lgkmcnt(5)
    v_mfma_f32_16x16x32_bf16 v[164:167], v[140:143], v[64:67], v[164:167]
    v_mfma_f32_16x16x32_bf16 v[188:191], v[140:143], v[68:71], v[188:191]
    ds_read_b128 v[116:119], v3 offset:11264
    s_waitcnt lgkmcnt(5)
    v_mfma_f32_16x16x32_bf16 v[168:171], v[144:147], v[64:67], v[168:171]
    v_mfma_f32_16x16x32_bf16 v[192:195], v[144:147], v[68:71], v[192:195]
    ds_read_b128 v[120:123], v3 offset:12288
    s_waitcnt lgkmcnt(5)
    v_mfma_f32_16x16x32_bf16 v[172:175], v[148:151], v[64:67], v[172:175]
    v_mfma_f32_16x16x32_bf16 v[196:199], v[148:151], v[68:71], v[196:199]
    ds_read_b128 v[124:127], v3 offset:13312
    s_waitcnt vmcnt(7)
    s_waitcnt lgkmcnt(5)
    v_mfma_f32_16x16x32_bf16 v[152:155], v[104:107], v[72:75], v[152:155]
    v_mfma_f32_16x16x32_bf16 v[176:179], v[104:107], v[76:79], v[176:179]
    ds_read_b128 v[128:131], v3 offset:20480
    s_waitcnt lgkmcnt(5)
    v_mfma_f32_16x16x32_bf16 v[156:159], v[108:111], v[72:75], v[156:159]
    v_mfma_f32_16x16x32_bf16 v[180:183], v[108:111], v[76:79], v[180:183]
    ds_read_b128 v[132:135], v3 offset:21504
    s_waitcnt lgkmcnt(5)
    v_mfma_f32_16x16x32_bf16 v[160:163], v[112:115], v[72:75], v[160:163]
    v_mfma_f32_16x16x32_bf16 v[184:187], v[112:115], v[76:79], v[184:187]
    ds_read_b128 v[136:139], v3 offset:22528
    s_waitcnt lgkmcnt(5)
    v_mfma_f32_16x16x32_bf16 v[164:167], v[116:119], v[72:75], v[164:167]
    v_mfma_f32_16x16x32_bf16 v[188:191], v[116:119], v[76:79], v[188:191]
    ds_read_b128 v[140:143], v3 offset:23552
    s_waitcnt lgkmcnt(5)
    v_mfma_f32_16x16x32_bf16 v[168:171], v[120:123], v[72:75], v[168:171]
    v_mfma_f32_16x16x32_bf16 v[192:195], v[120:123], v[76:79], v[192:195]
    ds_read_b128 v[144:147], v3 offset:24576
    s_waitcnt lgkmcnt(5)
    v_mfma_f32_16x16x32_bf16 v[172:175], v[124:127], v[72:75], v[172:175]
    v_mfma_f32_16x16x32_bf16 v[196:199], v[124:127], v[76:79], v[196:199]
    ds_read_b128 v[148:151], v3 offset:25600
    s_waitcnt vmcnt(5)
    s_waitcnt lgkmcnt(5)
    v_mfma_f32_16x16x32_bf16 v[152:155], v[128:131], v[80:83], v[152:155]
    v_mfma_f32_16x16x32_bf16 v[176:179], v[128:131], v[84:87], v[176:179]
    s_barrier
    ds_read_b128 v[104:107], v3 offset:32768
    s_waitcnt lgkmcnt(5)
    v_mfma_f32_16x16x32_bf16 v[156:159], v[132:135], v[80:83], v[156:159]
    v_mfma_f32_16x16x32_bf16 v[180:183], v[132:135], v[84:87], v[180:183]
    ds_read_b128 v[108:111], v3 offset:33792
    s_waitcnt lgkmcnt(5)
    v_mfma_f32_16x16x32_bf16 v[160:163], v[136:139], v[80:83], v[160:163]
    v_mfma_f32_16x16x32_bf16 v[184:187], v[136:139], v[84:87], v[184:187]
    ds_read_b128 v[112:115], v3 offset:34816
    s_waitcnt lgkmcnt(5)
    v_mfma_f32_16x16x32_bf16 v[164:167], v[140:143], v[80:83], v[164:167]
    v_mfma_f32_16x16x32_bf16 v[188:191], v[140:143], v[84:87], v[188:191]
    ds_read_b128 v[116:119], v3 offset:35840
    s_waitcnt lgkmcnt(5)
    v_mfma_f32_16x16x32_bf16 v[168:171], v[144:147], v[80:83], v[168:171]
    v_mfma_f32_16x16x32_bf16 v[192:195], v[144:147], v[84:87], v[192:195]
    ds_read_b128 v[120:123], v3 offset:36864
    s_waitcnt lgkmcnt(5)
    v_mfma_f32_16x16x32_bf16 v[172:175], v[148:151], v[80:83], v[172:175]
    v_mfma_f32_16x16x32_bf16 v[196:199], v[148:151], v[84:87], v[196:199]
    ds_read_b128 v[124:127], v3 offset:37888
    s_waitcnt vmcnt(3)
    s_waitcnt lgkmcnt(5)
    v_mfma_f32_16x16x32_bf16 v[152:155], v[104:107], v[88:91], v[152:155]
    v_mfma_f32_16x16x32_bf16 v[176:179], v[104:107], v[92:95], v[176:179]
    ds_read_b128 v[128:131], v3 offset:45056
    s_waitcnt lgkmcnt(5)
    v_mfma_f32_16x16x32_bf16 v[156:159], v[108:111], v[88:91], v[156:159]
    v_mfma_f32_16x16x32_bf16 v[180:183], v[108:111], v[92:95], v[180:183]
    ds_read_b128 v[132:135], v3 offset:46080
    s_waitcnt lgkmcnt(5)
    v_mfma_f32_16x16x32_bf16 v[160:163], v[112:115], v[88:91], v[160:163]
    v_mfma_f32_16x16x32_bf16 v[184:187], v[112:115], v[92:95], v[184:187]
    ds_read_b128 v[136:139], v3 offset:47104
    s_waitcnt lgkmcnt(5)
    v_mfma_f32_16x16x32_bf16 v[164:167], v[116:119], v[88:91], v[164:167]
    v_mfma_f32_16x16x32_bf16 v[188:191], v[116:119], v[92:95], v[188:191]
    ds_read_b128 v[140:143], v3 offset:48128
    s_waitcnt lgkmcnt(5)
    v_mfma_f32_16x16x32_bf16 v[168:171], v[120:123], v[88:91], v[168:171]
    v_mfma_f32_16x16x32_bf16 v[192:195], v[120:123], v[92:95], v[192:195]
    ds_read_b128 v[144:147], v3 offset:49152
    s_waitcnt lgkmcnt(5)
    v_mfma_f32_16x16x32_bf16 v[172:175], v[124:127], v[88:91], v[172:175]
    v_mfma_f32_16x16x32_bf16 v[196:199], v[124:127], v[92:95], v[196:199]
    ds_read_b128 v[148:151], v3 offset:50176
    s_waitcnt vmcnt(1)
    s_waitcnt lgkmcnt(5)
    v_mfma_f32_16x16x32_bf16 v[152:155], v[128:131], v[96:99], v[152:155]
    v_mfma_f32_16x16x32_bf16 v[176:179], v[128:131], v[100:103], v[176:179]
    s_waitcnt lgkmcnt(4)
    v_mfma_f32_16x16x32_bf16 v[156:159], v[132:135], v[96:99], v[156:159]
    v_mfma_f32_16x16x32_bf16 v[180:183], v[132:135], v[100:103], v[180:183]
    s_waitcnt lgkmcnt(3)
    v_mfma_f32_16x16x32_bf16 v[160:163], v[136:139], v[96:99], v[160:163]
    v_mfma_f32_16x16x32_bf16 v[184:187], v[136:139], v[100:103], v[184:187]
    s_waitcnt lgkmcnt(2)
    v_mfma_f32_16x16x32_bf16 v[164:167], v[140:143], v[96:99], v[164:167]
    v_mfma_f32_16x16x32_bf16 v[188:191], v[140:143], v[100:103], v[188:191]
    s_waitcnt lgkmcnt(1)
    v_mfma_f32_16x16x32_bf16 v[168:171], v[144:147], v[96:99], v[168:171]
    v_mfma_f32_16x16x32_bf16 v[192:195], v[144:147], v[100:103], v[192:195]
    s_waitcnt lgkmcnt(0)
    v_mfma_f32_16x16x32_bf16 v[172:175], v[148:151], v[96:99], v[172:175]
    v_mfma_f32_16x16x32_bf16 v[196:199], v[148:151], v[100:103], v[196:199]
    s_mul_i32 s20, s3, 6144
    s_xor_b32 s21, s3, 2
    s_mul_i32 s21, s21, 6144
    s_add_u32 s20, s20, 139264
    s_add_u32 s21, s21, 139264
    v_add_u32 v2, s20, v1
    v_add_u32 v3, s21, v1
    s_cmp_eq_u32 s5, 0
    s_cbranch_scc1 main_kernel_kh0_5
    ds_write_b128 v2, v[152:155] offset:0
    ds_write_b128 v2, v[156:159] offset:1024
    ds_write_b128 v2, v[160:163] offset:2048
    ds_write_b128 v2, v[164:167] offset:3072
    ds_write_b128 v2, v[168:171] offset:4096
    ds_write_b128 v2, v[172:175] offset:5120
    s_nop 0
    v_pk_mov_b32 v[152:153], v[176:177], v[176:177] op_sel:[0,1]
    v_pk_mov_b32 v[154:155], v[178:179], v[178:179] op_sel:[0,1]
    v_pk_mov_b32 v[156:157], v[180:181], v[180:181] op_sel:[0,1]
    v_pk_mov_b32 v[158:159], v[182:183], v[182:183] op_sel:[0,1]
    v_pk_mov_b32 v[160:161], v[184:185], v[184:185] op_sel:[0,1]
    v_pk_mov_b32 v[162:163], v[186:187], v[186:187] op_sel:[0,1]
    v_pk_mov_b32 v[164:165], v[188:189], v[188:189] op_sel:[0,1]
    v_pk_mov_b32 v[166:167], v[190:191], v[190:191] op_sel:[0,1]
    v_pk_mov_b32 v[168:169], v[192:193], v[192:193] op_sel:[0,1]
    v_pk_mov_b32 v[170:171], v[194:195], v[194:195] op_sel:[0,1]
    v_pk_mov_b32 v[172:173], v[196:197], v[196:197] op_sel:[0,1]
    v_pk_mov_b32 v[174:175], v[198:199], v[198:199] op_sel:[0,1]
    s_branch main_kernel_red_5
main_kernel_kh0_5:
    ds_write_b128 v2, v[176:179] offset:0
    ds_write_b128 v2, v[180:183] offset:1024
    ds_write_b128 v2, v[184:187] offset:2048
    ds_write_b128 v2, v[188:191] offset:3072
    ds_write_b128 v2, v[192:195] offset:4096
    ds_write_b128 v2, v[196:199] offset:5120
main_kernel_red_5:
    s_waitcnt lgkmcnt(0)
    s_barrier
    ds_read_b128 v[176:179], v3 offset:0
    ds_read_b128 v[180:183], v3 offset:1024
    ds_read_b128 v[184:187], v3 offset:2048
    ds_read_b128 v[188:191], v3 offset:3072
    ds_read_b128 v[192:195], v3 offset:4096
    ds_read_b128 v[196:199], v3 offset:5120
    v_add_f32 v10, v12, v14
    v_add_f32 v12, v13, v15
    v_mov_b32 v11, v10
    s_nop 1
    v_permlane32_swap_b32 v10, v11
    s_nop 1
    v_add_f32 v10, v10, v11
    v_mov_b32 v13, v12
    s_nop 1
    v_permlane32_swap_b32 v12, v13
    s_nop 1
    v_add_f32 v12, v12, v13
    v_mov_b32 v11, v10
    s_nop 1
    v_permlane16_swap_b32 v10, v11
    s_nop 1
    v_add_f32 v10, v10, v11
    v_mov_b32 v13, v12
    s_nop 1
    v_permlane16_swap_b32 v12, v13
    s_nop 1
    v_add_f32 v12, v12, v13
    v_mul_f32 v10, 0x3acccccd, v10
    v_mul_f32 v12, 0x3acccccd, v12
    v_fma_f32 v12, -v10, v10, v12
    v_add_f32 v12, 0x3727c5ac, v12
    v_rsq_f32 v12, v12
    s_mov_b32 s28, 252314624
    s_mov_b32 s29, 606018068
    s_lshl_b32 s26, s51, 3
    s_lshr_b64 s[28:29], s[28:29], s26
    s_and_b32 s28, s28, 0xff
    s_lshl_b32 s28, s28, 9
    s_mul_i32 s24, s4, 20480
    s_add_u32 s24, s24, s28
    s_add_u32 s24, s24, 20970496
    v_mul_f32 v10, 0x3ea52b5c, v12
    v_mov_b32 v13, v12
    v_mov_b32 v11, v10
    s_waitcnt lgkmcnt(0)
    v_pk_add_f32 v[152:153], v[152:153], v[176:177]
    v_pk_add_f32 v[154:155], v[154:155], v[178:179]
    v_pk_add_f32 v[156:157], v[156:157], v[180:181]
    v_pk_add_f32 v[158:159], v[158:159], v[182:183]
    v_pk_add_f32 v[160:161], v[160:161], v[184:185]
    v_pk_add_f32 v[162:163], v[162:163], v[186:187]
    v_pk_add_f32 v[164:165], v[164:165], v[188:189]
    v_pk_add_f32 v[166:167], v[166:167], v[190:191]
    v_pk_add_f32 v[168:169], v[168:169], v[192:193]
    v_pk_add_f32 v[170:171], v[170:171], v[194:195]
    v_pk_add_f32 v[172:173], v[172:173], v[196:197]
    v_pk_add_f32 v[174:175], v[174:175], v[198:199]
    s_cmp_lt_u32 s51, 2
    s_cbranch_scc1 main_kernel_kv5
    v_pk_mul_f32 v[152:153], v[152:153], v[10:11]
    v_pk_mul_f32 v[154:155], v[154:155], v[10:11]
    v_cvt_pk_bf16_f32 v104, v152, v153
    v_cvt_pk_bf16_f32 v105, v154, v155
    v_pk_mul_f32 v[156:157], v[156:157], v[10:11]
    v_pk_mul_f32 v[158:159], v[158:159], v[10:11]
    v_cvt_pk_bf16_f32 v106, v156, v157
    v_cvt_pk_bf16_f32 v107, v158, v159
    s_nop 1
    v_permlane16_swap_b32 v104, v106
    v_permlane16_swap_b32 v105, v107
    buffer_store_dwordx4 v[104:107], v9, s[8:11], s24 offen offset:0
    s_branch main_kernel_qrest5
main_kernel_kv5:
    v_pk_mul_f32 v[152:153], v[152:153], v[12:13]
    v_pk_mul_f32 v[154:155], v[154:155], v[12:13]
    v_pk_mul_f32 v[156:157], v[156:157], v[12:13]
    v_pk_mul_f32 v[158:159], v[158:159], v[12:13]
    s_lshr_b32 s26, s4, 1
    s_mul_i32 s26, s26, 2560
    s_add_u32 s26, s26, 46399488
    s_and_b32 s25, s4, 1
    v_cvt_pk_bf16_f32 v104, v152, v153
    v_cvt_pk_bf16_f32 v105, v154, v155
    v_cvt_pk_bf16_f32 v106, v156, v157
    v_cvt_pk_bf16_f32 v107, v158, v159
    s_cmp_eq_u32 s51, 1
    s_cbranch_scc1 main_kernel_v5
    s_lshl_b32 s25, s25, 4
    v_add_u32 v14, s25, v6
    v_lshrrev_b32 v15, 1, v7
    v_lshlrev_b32 v15, 9, v15
    v_lshl_add_u32 v15, v14, 4, v15
    v_and_b32 v16, 1, v7
    v_lshl_add_u32 v15, v16, 3, v15
    v_lshlrev_b32 v16, 3, v14
    v_add_u32 v15, s21, v15
    v_add_u32 v16, s21, v16
    ds_write_b64 v15, v[104:105]
    s_mov_b64 exec, 0xffff
    ds_write_b64 v16, v[106:107] offset:1024
    s_mov_b64 exec, -1
    v_lshlrev_b32 v15, 9, v7
    v_lshl_add_u32 v15, v6, 4, v15
    s_lshl_b32 s27, s25, 4
    s_lshl_b32 s25, s25, 3
    v_mov_b32 v16, s27
    s_mov_b32 exec_lo, 0
    v_mov_b32 v16, s25
    s_mov_b32 exec_lo, -1
    v_add_u32 v15, v15, v16
    v_add_u32 v16, s21, v15
    s_waitcnt lgkmcnt(0)
    ds_read_b128 v[20:23], v16
    v_mul_f32 v17, v152, v152
    v_fmac_f32 v17, v153, v153
    v_fmac_f32 v17, v154, v154
    v_fmac_f32 v17, v155, v155
    v_fmac_f32 v17, v156, v156
    v_fmac_f32 v17, v157, v157
    v_fmac_f32 v17, v158, v158
    v_fmac_f32 v17, v159, v159
    v_mov_b32 v18, v17
    s_nop 1
    v_permlane32_swap_b32 v17, v18
    s_nop 1
    v_add_f32 v17, v17, v18
    v_mov_b32 v18, v17
    s_nop 1
    v_permlane16_swap_b32 v17, v18
    s_nop 1
    v_add_f32 v17, v17, v18
    s_nop 1
    v_max_f32_dpp v17, v17, v17 row_ror:8 row_mask:0xf bank_mask:0xf
    s_nop 1
    v_max_f32_dpp v17, v17, v17 row_ror:4 row_mask:0xf bank_mask:0xf
    s_nop 1
    v_max_f32_dpp v17, v17, v17 row_ror:2 row_mask:0xf bank_mask:0xf
    s_nop 1
    v_max_f32_dpp v17, v17, v17 row_ror:1 row_mask:0xf bank_mask:0xf
    s_mov_b32 exec_hi, 0xff
    s_waitcnt lgkmcnt(0)
    buffer_store_dwordx4 v[20:23], v15, s[8:11], s26 offen sc1
    s_mov_b64 exec, 1
    s_lshl_b32 s25, s4, 2
    s_add_u32 s25, s25, 46665728
    buffer_store_dword v17, off, s[8:11], s25 sc1
    s_mov_b64 exec, -1
    s_branch main_kernel_qrest5
main_kernel_v5:
    s_mul_i32 s25, s25, 640
    s_add_u32 s26, s26, s25
    v_lshrrev_b32 v14, 2, v6
    v_and_b32 v15, 1, v14
    v_mul_u32_u24 v15, 320, v15
    v_lshrrev_b32 v14, 1, v14
    v_lshl_add_u32 v15, v14, 3, v15
    v_and_b32 v14, 3, v6
    v_lshl_add_u32 v15, v14, 1, v15
    v_lshl_add_u32 v15, v7, 6, v15
    v_add_u32 v15, s21, v15
    ds_write_b16 v15, v104 offset:0
    ds_write_b16_d16_hi v15, v104 offset:16
    ds_write_b16 v15, v105 offset:32
    ds_write_b16_d16_hi v15, v105 offset:48
    s_mov_b64 exec, 0xffff
    ds_write_b16 v15, v106 offset:256
    ds_write_b16_d16_hi v15, v106 offset:272
    ds_write_b16 v15, v107 offset:288
    ds_write_b16_d16_hi v15, v107 offset:304
    s_mov_b64 exec, -1
    s_waitcnt lgkmcnt(0)
    ds_read_b128 v[20:23], v3
    s_mov_b32 exec_hi, 0xff
    s_waitcnt lgkmcnt(0)
    buffer_store_dwordx4 v[20:23], v1, s[8:11], s26 offen offset:1280 sc1
    s_mov_b32 exec_hi, -1
main_kernel_qrest5:
    v_pk_mul_f32 v[160:161], v[160:161], v[10:11]
    v_pk_mul_f32 v[162:163], v[162:163], v[10:11]
    v_cvt_pk_bf16_f32 v108, v160, v161
    v_cvt_pk_bf16_f32 v109, v162, v163
    v_pk_mul_f32 v[164:165], v[164:165], v[10:11]
    v_pk_mul_f32 v[166:167], v[166:167], v[10:11]
    v_cvt_pk_bf16_f32 v110, v164, v165
    v_cvt_pk_bf16_f32 v111, v166, v167
    s_nop 1
    v_permlane16_swap_b32 v108, v110
    v_permlane16_swap_b32 v109, v111
    buffer_store_dwordx4 v[108:111], v9, s[8:11], s24 offen offset:1024
    v_pk_mul_f32 v[168:169], v[168:169], v[10:11]
    v_pk_mul_f32 v[170:171], v[170:171], v[10:11]
    v_cvt_pk_bf16_f32 v112, v168, v169
    v_cvt_pk_bf16_f32 v113, v170, v171
    v_pk_mul_f32 v[172:173], v[172:173], v[10:11]
    v_pk_mul_f32 v[174:175], v[174:175], v[10:11]
    v_cvt_pk_bf16_f32 v114, v172, v173
    v_cvt_pk_bf16_f32 v115, v174, v175
    s_nop 1
    v_permlane16_swap_b32 v112, v114
    v_permlane16_swap_b32 v113, v115
    buffer_store_dwordx4 v[112:115], v9, s[8:11], s24 offen offset:2048
    s_waitcnt vmcnt(0)
    s_barrier
    s_cmp_lg_u32 s3, 0
    s_cbranch_scc1 main_kernel_sig10
    s_add_u32 s44, s52, 48316416
    v_mov_b32 v246, 1
    s_cmp_ge_u32 s51, 2
    s_cbranch_scc1 main_kernel_sig10q
    s_lshl_b32 s45, s50, 1
    s_add_u32 s45, s45, s51
    s_lshl_b32 s45, s45, 2
    s_add_u32 s45, s45, 48324608
    v_lshlrev_b32 v247, 8, v0
    s_mov_b64 exec, 0xffff
    buffer_store_dword v246, v247, s[8:11], s45 offen sc1
main_kernel_sig10q:
    s_mov_b64 exec, 1
    s_cmp_lg_u32 s84, 0
    s_cbranch_scc1 main_kernel_sig10s
    buffer_store_dword v246, off, s[8:11], s44
    s_branch main_kernel_sig10e
main_kernel_sig10s:
    buffer_wbl2 sc1
    s_waitcnt vmcnt(0)
    buffer_store_dword v246, off, s[8:11], s44 sc1
main_kernel_sig10e:
    s_mov_b64 exec, -1
main_kernel_sig10:
main_kernel_j1:
    v_lshlrev_b32 v1, 4, v0
    s_mov_b32 s4, s56
    s_lshl_b32 s5, s57, 3
    s_add_u32 s5, s5, s3
    s_lshl_b32 s20, s3, 10
    s_add_u32 s21, s20, 46399488
    v_and_b32 v7, 31, v0
    v_lshrrev_b32 v8, 5, v0
    s_mul_i32 s6, s5, 5
    s_mul_i32 s22, s4, 40960
    v_lshrrev_b32 v9, 4, v7
    v_mul_u32_u24 v9, 20480, v9
    v_and_b32 v10, 15, v0
    v_lshl_add_u32 v9, v10, 4, v9
    v_lshl_add_u32 v10, v8, 1, s6
    v_lshrrev_b32 v11, 1, v10
    v_lshl_add_u32 v4, v11, 8, v9
    v_and_b32 v11, 1, v10
    v_lshl_add_u32 v4, v11, 3, v4
    v_add_u32 v10, 1, v10
    v_lshrrev_b32 v11, 1, v10
    v_lshl_add_u32 v5, v11, 8, v9
    v_and_b32 v11, 1, v10
    v_lshl_add_u32 v5, v11, 3, v5
    v_add_u32 v10, 4, v8
    v_add_u32 v10, s6, v10
    v_lshrrev_b32 v11, 1, v10
    v_lshl_add_u32 v6, v11, 8, v9
    v_and_b32 v11, 1, v10
    v_lshl_add_u32 v6, v11, 3, v6
    v_mov_b32 v12, 0x7fff0000
    v_cmp_eq_u32 vcc, 0, v8
    s_add_u32 s23, s22, 20971520
    s_mov_b32 s24, 46665728
    v_cndmask_b32 v6, v12, v6, vcc
    v_lshlrev_b32 v13, 3, v0
    s_and_b32 s26, s85, 15
    s_lshl_b32 s26, s26, 8
    s_add_u32 s26, s26, 0x2000
    s_andn2_b32 s27, s58, 31
    s_cmp_lg_u32 s3, 0
    s_cbranch_scc1 main_kernel_poll11p
    v_lshlrev_b32 v250, 2, v0
    s_mov_b32 s45, 0x200000
    s_add_u32 s44, s27, 48316416
    s_mov_b64 exec, 255
main_kernel_poll11_0:
    buffer_load_dword v246, v250, s[8:11], s44 offen sc1
    s_waitcnt vmcnt(0)
    v_cmp_ne_u32 vcc, 1, v246
    s_sub_u32 s45, s45, 1
    s_cbranch_scc1 main_kernel_poll11d
    s_cmp_eq_u64 vcc, 0
    s_cbranch_scc0 main_kernel_poll11_0
    s_mov_b64 exec, -1
    s_add_u32 s44, s26, 48316416
main_kernel_poll11_1:
    buffer_load_dword v246, v250, s[8:11], s44 offen sc1
    s_waitcnt vmcnt(0)
    v_cmp_ne_u32 vcc, 1, v246
    s_sub_u32 s45, s45, 1
    s_cbranch_scc1 main_kernel_poll11d
    s_cmp_eq_u64 vcc, 0
    s_cbranch_scc0 main_kernel_poll11_1
main_kernel_poll11d:
    s_mov_b64 exec, -1
    s_cmp_eq_u32 s84, 0
    s_cbranch_scc1 main_kernel_poll11p
    buffer_inv sc1
    s_waitcnt vmcnt(0)
main_kernel_poll11p:
    s_barrier
    buffer_load_dwordx2 v[88:89], v4, s[8:11], s23 offen sc1
    buffer_load_dwordx2 v[90:91], v5, s[8:11], s23 offen sc1
    buffer_load_dwordx2 v[92:93], v6, s[8:11], s23 offen sc1
    buffer_load_dwordx2 v[14:15], v13, s[8:11], s24 offen sc1
    v_mov_b32 v124, v1
    s_add_u32 m0, s20, 0
    s_add_u32 s25, s21, 0
    buffer_load_dwordx4 v124, s[8:11], s25 offen sc1 lds
    s_add_u32 m0, s20, 8192
    s_add_u32 s25, s21, 8192
    buffer_load_dwordx4 v124, s[8:11], s25 offen sc1 lds
    s_add_u32 m0, s20, 16384
    s_add_u32 s25, s21, 16384
    buffer_load_dwordx4 v124, s[8:11], s25 offen sc1 lds
    s_add_u32 m0, s20, 24576
    s_add_u32 s25, s21, 24576
    buffer_load_dwordx4 v124, s[8:11], s25 offen sc1 lds
    v_add_u32 v10, s6, v8
    v_lshrrev_b32 v11, 1, v10
    v_lshl_add_u32 v4, v11, 8, v9
    v_and_b32 v11, 1, v10
    v_lshl_add_u32 v4, v11, 3, v4
    v_add_u32 v5, 256, v4
    v_lshlrev_b32 v2, 3, v7
    v_mul_u32_u24 v3, 320, v8
    v_lshl_add_u32 v3, v7, 4, v3
    s_mov_b32 s30, 0x000fffff
    s_mov_b32 s31, 0x000fffff
    v_and_b32 v10, 27, v7
    v_cmp_eq_u32 vcc, 24, v10
    v_mov_b32 v11, 0x3f803f80
    s_nop 0
    v_cndmask_b32 v11, 0, v11, vcc
    v_mov_b32 v128, v11
    v_mov_b32 v129, v11
    v_mov_b32 v130, v11
    v_mov_b32 v131, v11
    v_mov_b32 v132, v11
    v_mov_b32 v133, v11
    v_mov_b32 v134, v11
    v_mov_b32 v135, v11
    v_mov_b32 v136, v11
    v_mov_b32 v137, v11
    v_mov_b32 v138, v11
    v_mov_b32 v139, v11
    v_mov_b32 v140, v11
    v_mov_b32 v141, v11
    v_mov_b32 v142, v11
    v_mov_b32 v143, v11
    v_mov_b32 v144, v11
    v_mov_b32 v145, v11
    v_mov_b32 v146, v11
    v_mov_b32 v147, v11
    v_mov_b32 v148, v11
    v_mov_b32 v149, v11
    v_mov_b32 v150, v11
    v_mov_b32 v151, v11
    v_mov_b32 v152, v11
    v_mov_b32 v153, v11
    v_mov_b32 v154, v11
    v_mov_b32 v155, v11
    v_mov_b32 v156, v11
    v_mov_b32 v157, v11
    v_mov_b32 v158, v11
    v_mov_b32 v159, v11
    s_waitcnt vmcnt(4)
    v_max_f32 v14, v14, v15
    v_mov_b32 v10, 0
    v_dot2_f32_bf16 v10, v88, v88, v10
    v_dot2_f32_bf16 v10, v89, v89, v10
    v_dot2_f32_bf16 v10, v90, v90, v10
    v_dot2_f32_bf16 v10, v91, v91, v10
    v_dot2_f32_bf16 v10, v92, v92, v10
    v_dot2_f32_bf16 v10, v93, v93, v10
    v_mov_b32 v15, v14
    s_nop 1
    v_permlane32_swap_b32 v14, v15
    s_nop 1
    v_max_f32 v14, v14, v15
    v_mov_b32 v15, v14
    s_nop 1
    v_permlane16_swap_b32 v14, v15
    s_nop 1
    v_max_f32 v14, v14, v15
    s_nop 1
    v_max_f32_dpp v14, v14, v14 row_ror:8 row_mask:0xf bank_mask:0xf
    s_nop 1
    v_max_f32_dpp v14, v14, v14 row_ror:4 row_mask:0xf bank_mask:0xf
    s_nop 1
    v_max_f32_dpp v14, v14, v14 row_ror:2 row_mask:0xf bank_mask:0xf
    s_nop 1
    v_max_f32_dpp v14, v14, v14 row_ror:1 row_mask:0xf bank_mask:0xf
    v_mov_b32 v11, v10
    s_nop 1
    v_permlane32_swap_b32 v10, v11
    s_nop 1
    v_add_f32 v10, v10, v11
    v_mul_f32 v10, v10, v14
    v_sqrt_f32 v10, v10
    s_mov_b32 s28, 0
    v_mul_f32 v10, 0xbf828f5c, v10
    s_waitcnt vmcnt(0)
    s_barrier
main_kernel_at1restart:
    v_mov_b32 v64, v10
    v_mov_b32 v48, 0
    v_mov_b32 v65, v10
    v_mov_b32 v49, 0
    v_mov_b32 v66, v10
    v_mov_b32 v50, 0
    v_mov_b32 v67, v10
    v_mov_b32 v51, 0
    v_mov_b32 v68, v10
    v_mov_b32 v52, 0
    v_mov_b32 v69, v10
    v_mov_b32 v53, 0
    v_mov_b32 v70, v10
    v_mov_b32 v54, 0
    v_mov_b32 v71, v10
    v_mov_b32 v55, 0
    v_mov_b32 v72, v10
    v_mov_b32 v56, 0
    v_mov_b32 v73, v10
    v_mov_b32 v57, 0
    v_mov_b32 v74, v10
    v_mov_b32 v58, 0
    v_mov_b32 v75, v10
    v_mov_b32 v59, 0
    v_mov_b32 v76, v10
    v_mov_b32 v60, 0
    v_mov_b32 v77, v10
    v_mov_b32 v61, 0
    v_mov_b32 v78, v10
    v_mov_b32 v62, 0
    v_mov_b32 v79, v10
    v_mov_b32 v63, 0
    ds_read_b128 v[96:99], v1 offset:0
    ds_read_b64 v[100:101], v2 offset:1024
    ds_read_b128 v[102:105], v1 offset:2560
    ds_read_b64 v[106:107], v2 offset:3584
    s_mov_b64 exec, s[30:31]
    ds_read_b128 v[128:131], v3 offset:1280
    ds_read_b128 v[132:135], v3 offset:1920
    s_mov_b64 exec, -1
    v_mov_b32 v84, 0
    v_mov_b32 v85, 0
    v_mov_b32 v86, 0
    v_mov_b32 v87, 0
    s_waitcnt lgkmcnt(4)
    v_mfma_f32_32x32x16_bf16 v[16:31], v[96:99], v[88:91], v[64:79]
    v_mfma_f32_32x32x8_bf16 v[16:31], v[100:101], v[92:93], v[16:31]
    s_mov_b32 s29, 0
    s_add_u32 s26, s20, 32768
    s_add_u32 s25, s21, 32768
    s_nop 7
    s_nop 1
    s_cmp_lg_u32 s28, 0
    s_cbranch_scc1 main_kernel_at1loop
main_kernel_at1loopa:
    s_setprio 3
    s_waitcnt lgkmcnt(0)
    v_mfma_f32_32x32x16_bf16 v[32:47], v[102:105], v[88:91], v[64:79]
    ds_read_b128 v[96:99], v1 offset:5120
    ds_read_b64 v[100:101], v2 offset:6144
    s_mov_b64 exec, s[30:31]
    ds_read_b128 v[136:139], v3 offset:3840
    ds_read_b128 v[140:143], v3 offset:4480
    s_mov_b64 exec, -1
    v_exp_f32 v16, v16
    v_exp_f32 v17, v17
    v_exp_f32 v18, v18
    v_exp_f32 v19, v19
    v_exp_f32 v20, v20
    v_mfma_f32_32x32x16_bf16 v[48:63], v[156:159], v[84:87], v[48:63]
    s_mov_b32 m0, s26
    s_add_u32 s26, s26, 8192
    buffer_load_dwordx4 v124, s[8:11], s25 offen sc1 lds
    s_add_u32 s25, s25, 8192
    v_exp_f32 v21, v21
    v_exp_f32 v22, v22
    v_exp_f32 v23, v23
    v_cvt_pk_bf16_f32 v80, v16, v17
    v_cvt_pk_bf16_f32 v81, v18, v19
    v_cvt_pk_bf16_f32 v82, v20, v21
    v_cvt_pk_bf16_f32 v83, v22, v23
    v_mfma_f32_32x32x8_bf16 v[32:47], v[106:107], v[92:93], v[32:47]
    v_exp_f32 v24, v24
    v_exp_f32 v25, v25
    v_exp_f32 v26, v26
    v_exp_f32 v27, v27
    v_exp_f32 v28, v28
    v_mfma_f32_32x32x16_bf16 v[48:63], v[128:131], v[80:83], v[48:63]
    v_exp_f32 v29, v29
    v_exp_f32 v30, v30
    v_exp_f32 v31, v31
    v_cvt_pk_bf16_f32 v84, v24, v25
    v_cvt_pk_bf16_f32 v85, v26, v27
    v_cvt_pk_bf16_f32 v86, v28, v29
    v_cvt_pk_bf16_f32 v87, v30, v31
    s_waitcnt lgkmcnt(0)
    v_mfma_f32_32x32x16_bf16 v[16:31], v[96:99], v[88:91], v[64:79]
    ds_read_b128 v[102:105], v1 offset:7680
    ds_read_b64 v[106:107], v2 offset:8704
    s_mov_b64 exec, s[30:31]
    ds_read_b128 v[144:147], v3 offset:6400
    ds_read_b128 v[148:151], v3 offset:7040
    s_mov_b64 exec, -1
    v_exp_f32 v32, v32
    v_exp_f32 v33, v33
    v_exp_f32 v34, v34
    v_exp_f32 v35, v35
    v_exp_f32 v36, v36
    v_mfma_f32_32x32x16_bf16 v[48:63], v[132:135], v[84:87], v[48:63]
    s_mov_b32 m0, s26
    s_add_u32 s26, s26, 8192
    buffer_load_dwordx4 v124, s[8:11], s25 offen sc1 lds
    s_add_u32 s25, s25, 8192
    v_exp_f32 v37, v37
    v_exp_f32 v38, v38
    v_exp_f32 v39, v39
    v_cvt_pk_bf16_f32 v80, v32, v33
    v_cvt_pk_bf16_f32 v81, v34, v35
    v_cvt_pk_bf16_f32 v82, v36, v37
    v_cvt_pk_bf16_f32 v83, v38, v39
    v_mfma_f32_32x32x8_bf16 v[16:31], v[100:101], v[92:93], v[16:31]
    v_exp_f32 v40, v40
    v_exp_f32 v41, v41
    v_exp_f32 v42, v42
    v_exp_f32 v43, v43
    v_exp_f32 v44, v44
    v_mfma_f32_32x32x16_bf16 v[48:63], v[136:139], v[80:83], v[48:63]
    v_exp_f32 v45, v45
    v_exp_f32 v46, v46
    v_exp_f32 v47, v47
    v_cvt_pk_bf16_f32 v84, v40, v41
    v_cvt_pk_bf16_f32 v85, v42, v43
    v_cvt_pk_bf16_f32 v86, v44, v45
    v_cvt_pk_bf16_f32 v87, v46, v47
    s_setprio 2
    s_waitcnt lgkmcnt(0)
    v_mfma_f32_32x32x16_bf16 v[32:47], v[102:105], v[88:91], v[64:79]
    ds_read_b128 v[96:99], v1 offset:10240
    ds_read_b64 v[100:101], v2 offset:11264
    s_mov_b64 exec, s[30:31]
    ds_read_b128 v[152:155], v3 offset:8960
    ds_read_b128 v[156:159], v3 offset:9600
    s_mov_b64 exec, -1
    v_exp_f32 v16, v16
    v_exp_f32 v17, v17
    v_exp_f32 v18, v18
    v_exp_f32 v19, v19
    v_exp_f32 v20, v20
    v_mfma_f32_32x32x16_bf16 v[48:63], v[140:143], v[84:87], v[48:63]
    s_mov_b32 m0, s26
    s_add_u32 s26, s26, 8192
    buffer_load_dwordx4 v124, s[8:11], s25 offen sc1 lds
    s_add_u32 s25, s25, 8192
    v_exp_f32 v21, v21
    v_exp_f32 v22, v22
    v_exp_f32 v23, v23
    v_cvt_pk_bf16_f32 v80, v16, v17
    v_cvt_pk_bf16_f32 v81, v18, v19
    v_cvt_pk_bf16_f32 v82, v20, v21
    v_cvt_pk_bf16_f32 v83, v22, v23
    v_mfma_f32_32x32x8_bf16 v[32:47], v[106:107], v[92:93], v[32:47]
    v_exp_f32 v24, v24
    v_exp_f32 v25, v25
    v_exp_f32 v26, v26
    v_exp_f32 v27, v27
    v_exp_f32 v28, v28
    v_mfma_f32_32x32x16_bf16 v[48:63], v[144:147], v[80:83], v[48:63]
    v_exp_f32 v29, v29
    v_exp_f32 v30, v30
    v_exp_f32 v31, v31
    v_cvt_pk_bf16_f32 v84, v24, v25
    v_cvt_pk_bf16_f32 v85, v26, v27
    v_cvt_pk_bf16_f32 v86, v28, v29
    v_cvt_pk_bf16_f32 v87, v30, v31
    s_waitcnt lgkmcnt(0)
    v_mfma_f32_32x32x16_bf16 v[16:31], v[96:99], v[88:91], v[64:79]
    ds_read_b128 v[102:105], v1 offset:12800
    ds_read_b64 v[106:107], v2 offset:13824
    s_mov_b64 exec, s[30:31]
    ds_read_b128 v[128:131], v3 offset:11520
    ds_read_b128 v[132:135], v3 offset:12160
    s_mov_b64 exec, -1
    v_exp_f32 v32, v32
    v_exp_f32 v33, v33
    v_exp_f32 v34, v34
    v_exp_f32 v35, v35
    v_exp_f32 v36, v36
    v_mfma_f32_32x32x16_bf16 v[48:63], v[148:151], v[84:87], v[48:63]
    s_mov_b32 m0, s26
    s_add_u32 s26, s26, 8192
    buffer_load_dwordx4 v124, s[8:11], s25 offen sc1 lds
    s_add_u32 s25, s25, 8192
    v_exp_f32 v37, v37
    v_exp_f32 v38, v38
    v_exp_f32 v39, v39
    v_cvt_pk_bf16_f32 v80, v32, v33
    v_cvt_pk_bf16_f32 v81, v34, v35
    v_cvt_pk_bf16_f32 v82, v36, v37
    v_cvt_pk_bf16_f32 v83, v38, v39
    v_mfma_f32_32x32x8_bf16 v[16:31], v[100:101], v[92:93], v[16:31]
    v_exp_f32 v40, v40
    v_exp_f32 v41, v41
    v_exp_f32 v42, v42
    v_exp_f32 v43, v43
    v_exp_f32 v44, v44
    v_mfma_f32_32x32x16_bf16 v[48:63], v[152:155], v[80:83], v[48:63]
    v_exp_f32 v45, v45
    v_exp_f32 v46, v46
    v_exp_f32 v47, v47
    v_cvt_pk_bf16_f32 v84, v40, v41
    v_cvt_pk_bf16_f32 v85, v42, v43
    v_cvt_pk_bf16_f32 v86, v44, v45
    v_cvt_pk_bf16_f32 v87, v46, v47
    s_setprio 1
    s_waitcnt lgkmcnt(0)
    v_mfma_f32_32x32x16_bf16 v[32:47], v[102:105], v[88:91], v[64:79]
    ds_read_b128 v[96:99], v1 offset:15360
    ds_read_b64 v[100:101], v2 offset:16384
    s_mov_b64 exec, s[30:31]
    ds_read_b128 v[136:139], v3 offset:14080
    ds_read_b128 v[140:143], v3 offset:14720
    s_mov_b64 exec, -1
    v_exp_f32 v16, v16
    v_exp_f32 v17, v17
    v_exp_f32 v18, v18
    v_exp_f32 v19, v19
    v_exp_f32 v20, v20
    v_mfma_f32_32x32x16_bf16 v[48:63], v[156:159], v[84:87], v[48:63]
    v_exp_f32 v21, v21
    v_exp_f32 v22, v22
    v_exp_f32 v23, v23
    v_cvt_pk_bf16_f32 v80, v16, v17
    v_cvt_pk_bf16_f32 v81, v18, v19
    v_cvt_pk_bf16_f32 v82, v20, v21
    v_cvt_pk_bf16_f32 v83, v22, v23
    v_mfma_f32_32x32x8_bf16 v[32:47], v[106:107], v[92:93], v[32:47]
    v_exp_f32 v24, v24
    v_exp_f32 v25, v25
    v_exp_f32 v26, v26
    v_exp_f32 v27, v27
    v_exp_f32 v28, v28
    v_mfma_f32_32x32x16_bf16 v[48:63], v[128:131], v[80:83], v[48:63]
    v_exp_f32 v29, v29
    v_exp_f32 v30, v30
    v_exp_f32 v31, v31
    v_cvt_pk_bf16_f32 v84, v24, v25
    v_cvt_pk_bf16_f32 v85, v26, v27
    v_cvt_pk_bf16_f32 v86, v28, v29
    v_cvt_pk_bf16_f32 v87, v30, v31
    s_waitcnt lgkmcnt(0)
    v_mfma_f32_32x32x16_bf16 v[16:31], v[96:99], v[88:91], v[64:79]
    ds_read_b128 v[102:105], v1 offset:17920
    ds_read_b64 v[106:107], v2 offset:18944
    s_mov_b64 exec, s[30:31]
    ds_read_b128 v[144:147], v3 offset:16640
    ds_read_b128 v[148:151], v3 offset:17280
    s_mov_b64 exec, -1
    v_exp_f32 v32, v32
    v_exp_f32 v33, v33
    v_exp_f32 v34, v34
    v_exp_f32 v35, v35
    v_exp_f32 v36, v36
    v_mfma_f32_32x32x16_bf16 v[48:63], v[132:135], v[84:87], v[48:63]
    v_exp_f32 v37, v37
    v_exp_f32 v38, v38
    v_exp_f32 v39, v39
    v_cvt_pk_bf16_f32 v80, v32, v33
    v_cvt_pk_bf16_f32 v81, v34, v35
    v_cvt_pk_bf16_f32 v82, v36, v37
    v_cvt_pk_bf16_f32 v83, v38, v39
    v_mfma_f32_32x32x8_bf16 v[16:31], v[100:101], v[92:93], v[16:31]
    v_exp_f32 v40, v40
    v_exp_f32 v41, v41
    v_exp_f32 v42, v42
    v_exp_f32 v43, v43
    v_exp_f32 v44, v44
    v_mfma_f32_32x32x16_bf16 v[48:63], v[136:139], v[80:83], v[48:63]
    v_exp_f32 v45, v45
    v_exp_f32 v46, v46
    v_exp_f32 v47, v47
    v_cvt_pk_bf16_f32 v84, v40, v41
    v_cvt_pk_bf16_f32 v85, v42, v43
    v_cvt_pk_bf16_f32 v86, v44, v45
    v_cvt_pk_bf16_f32 v87, v46, v47
    s_setprio 0
    s_waitcnt lgkmcnt(0)
    v_mfma_f32_32x32x16_bf16 v[32:47], v[102:105], v[88:91], v[64:79]
    ds_read_b128 v[96:99], v1 offset:20480
    ds_read_b64 v[100:101], v2 offset:21504
    s_mov_b64 exec, s[30:31]
    ds_read_b128 v[152:155], v3 offset:19200
    ds_read_b128 v[156:159], v3 offset:19840
    s_mov_b64 exec, -1
    v_exp_f32 v16, v16
    v_exp_f32 v17, v17
    v_exp_f32 v18, v18
    v_exp_f32 v19, v19
    v_exp_f32 v20, v20
    v_mfma_f32_32x32x16_bf16 v[48:63], v[140:143], v[84:87], v[48:63]
    v_exp_f32 v21, v21
    v_exp_f32 v22, v22
    v_exp_f32 v23, v23
    v_cvt_pk_bf16_f32 v80, v16, v17
    v_cvt_pk_bf16_f32 v81, v18, v19
    v_cvt_pk_bf16_f32 v82, v20, v21
    v_cvt_pk_bf16_f32 v83, v22, v23
    v_mfma_f32_32x32x8_bf16 v[32:47], v[106:107], v[92:93], v[32:47]
    v_exp_f32 v24, v24
    v_exp_f32 v25, v25
    v_exp_f32 v26, v26
    v_exp_f32 v27, v27
    v_exp_f32 v28, v28
    v_mfma_f32_32x32x16_bf16 v[48:63], v[144:147], v[80:83], v[48:63]
    v_exp_f32 v29, v29
    v_exp_f32 v30, v30
    v_exp_f32 v31, v31
    v_cvt_pk_bf16_f32 v84, v24, v25
    v_cvt_pk_bf16_f32 v85, v26, v27
    v_cvt_pk_bf16_f32 v86, v28, v29
    v_cvt_pk_bf16_f32 v87, v30, v31
    s_waitcnt lgkmcnt(0)
    v_mfma_f32_32x32x16_bf16 v[16:31], v[96:99], v[88:91], v[64:79]
    ds_read_b128 v[102:105], v1 offset:23040
    ds_read_b64 v[106:107], v2 offset:24064
    s_mov_b64 exec, s[30:31]
    ds_read_b128 v[128:131], v3 offset:21760
    ds_read_b128 v[132:135], v3 offset:22400
    s_mov_b64 exec, -1
    v_exp_f32 v32, v32
    v_exp_f32 v33, v33
    v_exp_f32 v34, v34
    v_exp_f32 v35, v35
    v_exp_f32 v36, v36
    v_mfma_f32_32x32x16_bf16 v[48:63], v[148:151], v[84:87], v[48:63]
    v_exp_f32 v37, v37
    v_exp_f32 v38, v38
    v_exp_f32 v39, v39
    v_cvt_pk_bf16_f32 v80, v32, v33
    v_cvt_pk_bf16_f32 v81, v34, v35
    v_cvt_pk_bf16_f32 v82, v36, v37
    v_cvt_pk_bf16_f32 v83, v38, v39
    v_mfma_f32_32x32x8_bf16 v[16:31], v[100:101], v[92:93], v[16:31]
    v_exp_f32 v40, v40
    v_exp_f32 v41, v41
    v_exp_f32 v42, v42
    v_exp_f32 v43, v43
    v_exp_f32 v44, v44
    v_mfma_f32_32x32x16_bf16 v[48:63], v[152:155], v[80:83], v[48:63]
    v_exp_f32 v45, v45
    v_exp_f32 v46, v46
    v_exp_f32 v47, v47
    v_cvt_pk_bf16_f32 v84, v40, v41
    v_cvt_pk_bf16_f32 v85, v42, v43
    v_cvt_pk_bf16_f32 v86, v44, v45
    v_cvt_pk_bf16_f32 v87, v46, v47
    v_add_u32 v1, 20480, v1
    v_add_u32 v2, 20480, v2
    v_add_u32 v3, 20480, v3
    s_add_u32 s29, s29, 1
    s_waitcnt vmcnt(0)
    s_barrier
    s_cmp_lt_u32 s3, 4
    s_cbranch_scc1 main_kernel_at1ra
    s_setprio 3
    s_cmp_lg_u32 s29, 1
    s_cbranch_scc1 main_kernel_at1ra1
    s_and_b32 s98, s3, 3
    s_mul_i32 s93, s98, 2560
    s_mul_i32 s92, s51, 102400
    s_add_u32 s92, s92, s93
    s_add_u32 s92, s92, 1048576
    s_add_u32 s97, s92, 0
    buffer_load_dwordx4 v[160:163], v124, s[8:11], s97 offen offset:0
    buffer_load_dwordx4 v[164:167], v124, s[8:11], s97 offen offset:1024
    s_mov_b32 exec_hi, 0
    buffer_load_dwordx4 v[168:171], v124, s[8:11], s97 offen offset:2048
    s_mov_b32 exec_hi, -1
    s_add_u32 s97, s92, 10240
    buffer_load_dwordx4 v[172:175], v124, s[8:11], s97 offen offset:0
    buffer_load_dwordx4 v[176:179], v124, s[8:11], s97 offen offset:1024
    s_mov_b32 exec_hi, 0
    buffer_load_dwordx4 v[180:183], v124, s[8:11], s97 offen offset:2048
    s_mov_b32 exec_hi, -1
    s_branch main_kernel_at1loopa
main_kernel_at1ra1:
    s_cmp_lg_u32 s29, 2
    s_cbranch_scc1 main_kernel_at1ra2
    s_add_u32 s97, s92, 20480
    buffer_load_dwordx4 v[184:187], v124, s[8:11], s97 offen offset:0
    buffer_load_dwordx4 v[188:191], v124, s[8:11], s97 offen offset:1024
    s_mov_b32 exec_hi, 0
    buffer_load_dwordx4 v[192:195], v124, s[8:11], s97 offen offset:2048
    s_mov_b32 exec_hi, -1
    s_add_u32 s97, s92, 30720
    buffer_load_dwordx4 v[196:199], v124, s[8:11], s97 offen offset:0
    buffer_load_dwordx4 v[200:203], v124, s[8:11], s97 offen offset:1024
    s_mov_b32 exec_hi, 0
    buffer_load_dwordx4 v[204:207], v124, s[8:11], s97 offen offset:2048
    s_mov_b32 exec_hi, -1
    s_add_u32 s97, s92, 40960
    buffer_load_dwordx4 v[208:211], v124, s[8:11], s97 offen offset:0
    buffer_load_dwordx4 v[212:215], v124, s[8:11], s97 offen offset:1024
    s_mov_b32 exec_hi, 0
    buffer_load_dwordx4 v[216:219], v124, s[8:11], s97 offen offset:2048
    s_mov_b32 exec_hi, -1
    s_branch main_kernel_at1loopa
main_kernel_at1ra2:
    s_cmp_lg_u32 s29, 3
    s_cbranch_scc1 main_kernel_at1ra3
    s_add_u32 s97, s92, 51200
    buffer_load_dwordx4 v[220:223], v124, s[8:11], s97 offen offset:0
    buffer_load_dwordx4 v[224:227], v124, s[8:11], s97 offen offset:1024
    s_mov_b32 exec_hi, 0
    buffer_load_dwordx4 v[228:231], v124, s[8:11], s97 offen offset:2048
    s_mov_b32 exec_hi, -1
    s_add_u32 s97, s92, 61440
    buffer_load_dwordx4 v[232:235], v124, s[8:11], s97 offen offset:0
    buffer_load_dwordx4 v[236:239], v124, s[8:11], s97 offen offset:1024
    s_mov_b32 exec_hi, 0
    buffer_load_dwordx4 v[240:243], v124, s[8:11], s97 offen offset:2048
    s_mov_b32 exec_hi, -1
    s_branch main_kernel_at1loopa
main_kernel_at1ra3:
main_kernel_at1ra:
    s_cmp_lt_u32 s29, 4
    s_cbranch_scc1 main_kernel_at1loopa
main_kernel_at1loop:
    s_setprio 3
    s_waitcnt lgkmcnt(0)
    v_mfma_f32_32x32x16_bf16 v[32:47], v[102:105], v[88:91], v[64:79]
    ds_read_b128 v[96:99], v1 offset:5120
    ds_read_b64 v[100:101], v2 offset:6144
    s_mov_b64 exec, s[30:31]
    ds_read_b128 v[136:139], v3 offset:3840
    ds_read_b128 v[140:143], v3 offset:4480
    s_mov_b64 exec, -1
    v_exp_f32 v16, v16
    v_exp_f32 v17, v17
    v_exp_f32 v18, v18
    v_exp_f32 v19, v19
    v_exp_f32 v20, v20
    v_mfma_f32_32x32x16_bf16 v[48:63], v[156:159], v[84:87], v[48:63]
    v_exp_f32 v21, v21
    v_exp_f32 v22, v22
    v_exp_f32 v23, v23
    v_cvt_pk_bf16_f32 v80, v16, v17
    v_cvt_pk_bf16_f32 v81, v18, v19
    v_cvt_pk_bf16_f32 v82, v20, v21
    v_cvt_pk_bf16_f32 v83, v22, v23
    v_mfma_f32_32x32x8_bf16 v[32:47], v[106:107], v[92:93], v[32:47]
    v_exp_f32 v24, v24
    v_exp_f32 v25, v25
    v_exp_f32 v26, v26
    v_exp_f32 v27, v27
    v_exp_f32 v28, v28
    v_mfma_f32_32x32x16_bf16 v[48:63], v[128:131], v[80:83], v[48:63]
    v_exp_f32 v29, v29
    v_exp_f32 v30, v30
    v_exp_f32 v31, v31
    v_cvt_pk_bf16_f32 v84, v24, v25
    v_cvt_pk_bf16_f32 v85, v26, v27
    v_cvt_pk_bf16_f32 v86, v28, v29
    v_cvt_pk_bf16_f32 v87, v30, v31
    s_waitcnt lgkmcnt(0)
    v_mfma_f32_32x32x16_bf16 v[16:31], v[96:99], v[88:91], v[64:79]
    ds_read_b128 v[102:105], v1 offset:7680
    ds_read_b64 v[106:107], v2 offset:8704
    s_mov_b64 exec, s[30:31]
    ds_read_b128 v[144:147], v3 offset:6400
    ds_read_b128 v[148:151], v3 offset:7040
    s_mov_b64 exec, -1
    v_exp_f32 v32, v32
    v_exp_f32 v33, v33
    v_exp_f32 v34, v34
    v_exp_f32 v35, v35
    v_exp_f32 v36, v36
    v_mfma_f32_32x32x16_bf16 v[48:63], v[132:135], v[84:87], v[48:63]
    v_exp_f32 v37, v37
    v_exp_f32 v38, v38
    v_exp_f32 v39, v39
    v_cvt_pk_bf16_f32 v80, v32, v33
    v_cvt_pk_bf16_f32 v81, v34, v35
    v_cvt_pk_bf16_f32 v82, v36, v37
    v_cvt_pk_bf16_f32 v83, v38, v39
    v_mfma_f32_32x32x8_bf16 v[16:31], v[100:101], v[92:93], v[16:31]
    v_exp_f32 v40, v40
    v_exp_f32 v41, v41
    v_exp_f32 v42, v42
    v_exp_f32 v43, v43
    v_exp_f32 v44, v44
    v_mfma_f32_32x32x16_bf16 v[48:63], v[136:139], v[80:83], v[48:63]
    v_exp_f32 v45, v45
    v_exp_f32 v46, v46
    v_exp_f32 v47, v47
    v_cvt_pk_bf16_f32 v84, v40, v41
    v_cvt_pk_bf16_f32 v85, v42, v43
    v_cvt_pk_bf16_f32 v86, v44, v45
    v_cvt_pk_bf16_f32 v87, v46, v47
    s_setprio 2
    s_waitcnt lgkmcnt(0)
    v_mfma_f32_32x32x16_bf16 v[32:47], v[102:105], v[88:91], v[64:79]
    ds_read_b128 v[96:99], v1 offset:10240
    ds_read_b64 v[100:101], v2 offset:11264
    s_mov_b64 exec, s[30:31]
    ds_read_b128 v[152:155], v3 offset:8960
    ds_read_b128 v[156:159], v3 offset:9600
    s_mov_b64 exec, -1
    v_exp_f32 v16, v16
    v_exp_f32 v17, v17
    v_exp_f32 v18, v18
    v_exp_f32 v19, v19
    v_exp_f32 v20, v20
    v_mfma_f32_32x32x16_bf16 v[48:63], v[140:143], v[84:87], v[48:63]
    v_exp_f32 v21, v21
    v_exp_f32 v22, v22
    v_exp_f32 v23, v23
    v_cvt_pk_bf16_f32 v80, v16, v17
    v_cvt_pk_bf16_f32 v81, v18, v19
    v_cvt_pk_bf16_f32 v82, v20, v21
    v_cvt_pk_bf16_f32 v83, v22, v23
    v_mfma_f32_32x32x8_bf16 v[32:47], v[106:107], v[92:93], v[32:47]
    v_exp_f32 v24, v24
    v_exp_f32 v25, v25
    v_exp_f32 v26, v26
    v_exp_f32 v27, v27
    v_exp_f32 v28, v28
    v_mfma_f32_32x32x16_bf16 v[48:63], v[144:147], v[80:83], v[48:63]
    v_exp_f32 v29, v29
    v_exp_f32 v30, v30
    v_exp_f32 v31, v31
    v_cvt_pk_bf16_f32 v84, v24, v25
    v_cvt_pk_bf16_f32 v85, v26, v27
    v_cvt_pk_bf16_f32 v86, v28, v29
    v_cvt_pk_bf16_f32 v87, v30, v31
    s_waitcnt lgkmcnt(0)
    v_mfma_f32_32x32x16_bf16 v[16:31], v[96:99], v[88:91], v[64:79]
    ds_read_b128 v[102:105], v1 offset:12800
    ds_read_b64 v[106:107], v2 offset:13824
    s_mov_b64 exec, s[30:31]
    ds_read_b128 v[128:131], v3 offset:11520
    ds_read_b128 v[132:135], v3 offset:12160
    s_mov_b64 exec, -1
    v_exp_f32 v32, v32
    v_exp_f32 v33, v33
    v_exp_f32 v34, v34
    v_exp_f32 v35, v35
    v_exp_f32 v36, v36
    v_mfma_f32_32x32x16_bf16 v[48:63], v[148:151], v[84:87], v[48:63]
    v_exp_f32 v37, v37
    v_exp_f32 v38, v38
    v_exp_f32 v39, v39
    v_cvt_pk_bf16_f32 v80, v32, v33
    v_cvt_pk_bf16_f32 v81, v34, v35
    v_cvt_pk_bf16_f32 v82, v36, v37
    v_cvt_pk_bf16_f32 v83, v38, v39
    v_mfma_f32_32x32x8_bf16 v[16:31], v[100:101], v[92:93], v[16:31]
    v_exp_f32 v40, v40
    v_exp_f32 v41, v41
    v_exp_f32 v42, v42
    v_exp_f32 v43, v43
    v_exp_f32 v44, v44
    v_mfma_f32_32x32x16_bf16 v[48:63], v[152:155], v[80:83], v[48:63]
    v_exp_f32 v45, v45
    v_exp_f32 v46, v46
    v_exp_f32 v47, v47
    v_cvt_pk_bf16_f32 v84, v40, v41
    v_cvt_pk_bf16_f32 v85, v42, v43
    v_cvt_pk_bf16_f32 v86, v44, v45
    v_cvt_pk_bf16_f32 v87, v46, v47
    s_setprio 1
    s_waitcnt lgkmcnt(0)
    v_mfma_f32_32x32x16_bf16 v[32:47], v[102:105], v[88:91], v[64:79]
    ds_read_b128 v[96:99], v1 offset:15360
    ds_read_b64 v[100:101], v2 offset:16384
    s_mov_b64 exec, s[30:31]
    ds_read_b128 v[136:139], v3 offset:14080
    ds_read_b128 v[140:143], v3 offset:14720
    s_mov_b64 exec, -1
    v_exp_f32 v16, v16
    v_exp_f32 v17, v17
    v_exp_f32 v18, v18
    v_exp_f32 v19, v19
    v_exp_f32 v20, v20
    v_mfma_f32_32x32x16_bf16 v[48:63], v[156:159], v[84:87], v[48:63]
    v_exp_f32 v21, v21
    v_exp_f32 v22, v22
    v_exp_f32 v23, v23
    v_cvt_pk_bf16_f32 v80, v16, v17
    v_cvt_pk_bf16_f32 v81, v18, v19
    v_cvt_pk_bf16_f32 v82, v20, v21
    v_cvt_pk_bf16_f32 v83, v22, v23
    v_mfma_f32_32x32x8_bf16 v[32:47], v[106:107], v[92:93], v[32:47]
    v_exp_f32 v24, v24
    v_exp_f32 v25, v25
    v_exp_f32 v26, v26
    v_exp_f32 v27, v27
    v_exp_f32 v28, v28
    v_mfma_f32_32x32x16_bf16 v[48:63], v[128:131], v[80:83], v[48:63]
    v_exp_f32 v29, v29
    v_exp_f32 v30, v30
    v_exp_f32 v31, v31
    v_cvt_pk_bf16_f32 v84, v24, v25
    v_cvt_pk_bf16_f32 v85, v26, v27
    v_cvt_pk_bf16_f32 v86, v28, v29
    v_cvt_pk_bf16_f32 v87, v30, v31
    s_waitcnt lgkmcnt(0)
    v_mfma_f32_32x32x16_bf16 v[16:31], v[96:99], v[88:91], v[64:79]
    ds_read_b128 v[102:105], v1 offset:17920
    ds_read_b64 v[106:107], v2 offset:18944
    s_mov_b64 exec, s[30:31]
    ds_read_b128 v[144:147], v3 offset:16640
    ds_read_b128 v[148:151], v3 offset:17280
    s_mov_b64 exec, -1
    v_exp_f32 v32, v32
    v_exp_f32 v33, v33
    v_exp_f32 v34, v34
    v_exp_f32 v35, v35
    v_exp_f32 v36, v36
    v_mfma_f32_32x32x16_bf16 v[48:63], v[132:135], v[84:87], v[48:63]
    v_exp_f32 v37, v37
    v_exp_f32 v38, v38
    v_exp_f32 v39, v39
    v_cvt_pk_bf16_f32 v80, v32, v33
    v_cvt_pk_bf16_f32 v81, v34, v35
    v_cvt_pk_bf16_f32 v82, v36, v37
    v_cvt_pk_bf16_f32 v83, v38, v39
    v_mfma_f32_32x32x8_bf16 v[16:31], v[100:101], v[92:93], v[16:31]
    v_exp_f32 v40, v40
    v_exp_f32 v41, v41
    v_exp_f32 v42, v42
    v_exp_f32 v43, v43
    v_exp_f32 v44, v44
    v_mfma_f32_32x32x16_bf16 v[48:63], v[136:139], v[80:83], v[48:63]
    v_exp_f32 v45, v45
    v_exp_f32 v46, v46
    v_exp_f32 v47, v47
    v_cvt_pk_bf16_f32 v84, v40, v41
    v_cvt_pk_bf16_f32 v85, v42, v43
    v_cvt_pk_bf16_f32 v86, v44, v45
    v_cvt_pk_bf16_f32 v87, v46, v47
    s_setprio 0
    s_waitcnt lgkmcnt(0)
    v_mfma_f32_32x32x16_bf16 v[32:47], v[102:105], v[88:91], v[64:79]
    ds_read_b128 v[96:99], v1 offset:20480
    ds_read_b64 v[100:101], v2 offset:21504
    s_mov_b64 exec, s[30:31]
    ds_read_b128 v[152:155], v3 offset:19200
    ds_read_b128 v[156:159], v3 offset:19840
    s_mov_b64 exec, -1
    v_exp_f32 v16, v16
    v_exp_f32 v17, v17
    v_exp_f32 v18, v18
    v_exp_f32 v19, v19
    v_exp_f32 v20, v20
    v_mfma_f32_32x32x16_bf16 v[48:63], v[140:143], v[84:87], v[48:63]
    v_exp_f32 v21, v21
    v_exp_f32 v22, v22
    v_exp_f32 v23, v23
    v_cvt_pk_bf16_f32 v80, v16, v17
    v_cvt_pk_bf16_f32 v81, v18, v19
    v_cvt_pk_bf16_f32 v82, v20, v21
    v_cvt_pk_bf16_f32 v83, v22, v23
    v_mfma_f32_32x32x8_bf16 v[32:47], v[106:107], v[92:93], v[32:47]
    v_exp_f32 v24, v24
    v_exp_f32 v25, v25
    v_exp_f32 v26, v26
    v_exp_f32 v27, v27
    v_exp_f32 v28, v28
    v_mfma_f32_32x32x16_bf16 v[48:63], v[144:147], v[80:83], v[48:63]
    v_exp_f32 v29, v29
    v_exp_f32 v30, v30
    v_exp_f32 v31, v31
    v_cvt_pk_bf16_f32 v84, v24, v25
    v_cvt_pk_bf16_f32 v85, v26, v27
    v_cvt_pk_bf16_f32 v86, v28, v29
    v_cvt_pk_bf16_f32 v87, v30, v31
    s_waitcnt lgkmcnt(0)
    v_mfma_f32_32x32x16_bf16 v[16:31], v[96:99], v[88:91], v[64:79]
    ds_read_b128 v[102:105], v1 offset:23040
    ds_read_b64 v[106:107], v2 offset:24064
    s_mov_b64 exec, s[30:31]
    ds_read_b128 v[128:131], v3 offset:21760
    ds_read_b128 v[132:135], v3 offset:22400
    s_mov_b64 exec, -1
    v_exp_f32 v32, v32
    v_exp_f32 v33, v33
    v_exp_f32 v34, v34
    v_exp_f32 v35, v35
    v_exp_f32 v36, v36
    v_mfma_f32_32x32x16_bf16 v[48:63], v[148:151], v[84:87], v[48:63]
    v_exp_f32 v37, v37
    v_exp_f32 v38, v38
    v_exp_f32 v39, v39
    v_cvt_pk_bf16_f32 v80, v32, v33
    v_cvt_pk_bf16_f32 v81, v34, v35
    v_cvt_pk_bf16_f32 v82, v36, v37
    v_cvt_pk_bf16_f32 v83, v38, v39
    v_mfma_f32_32x32x8_bf16 v[16:31], v[100:101], v[92:93], v[16:31]
    v_exp_f32 v40, v40
    v_exp_f32 v41, v41
    v_exp_f32 v42, v42
    v_exp_f32 v43, v43
    v_exp_f32 v44, v44
    v_mfma_f32_32x32x16_bf16 v[48:63], v[152:155], v[80:83], v[48:63]
    v_exp_f32 v45, v45
    v_exp_f32 v46, v46
    v_exp_f32 v47, v47
    v_cvt_pk_bf16_f32 v84, v40, v41
    v_cvt_pk_bf16_f32 v85, v42, v43
    v_cvt_pk_bf16_f32 v86, v44, v45
    v_cvt_pk_bf16_f32 v87, v46, v47
    v_add_u32 v1, 20480, v1
    v_add_u32 v2, 20480, v2
    v_add_u32 v3, 20480, v3
    s_add_u32 s29, s29, 1
    s_cmp_ge_u32 s29, 8
    s_cbranch_scc1 main_kernel_at1done
    s_cmp_lg_u32 s28, 0
    s_cbranch_scc1 main_kernel_at1loop
    s_barrier
    s_cmp_lg_u32 s29, 5
    s_cbranch_scc1 main_kernel_at1loop
main_kernel_at1pfb:
    s_lshr_b32 s26, s85, 3
    s_lshl_b32 s26, s26, 3
    s_add_u32 s26, s26, s3
    s_mul_i32 s27, s26, 3200
    s_add_u32 s27, s27, 1048576
    v_lshlrev_b32 v125, 7, v0
    s_mov_b32 exec_hi, 0
    buffer_load_dword v126, v125, s[8:11], s27 offen
    s_mov_b32 exec_hi, -1
    s_mul_i32 s26, s26, 7680
    s_and_b32 s27, s85, 1
    s_mul_i32 s27, s27, 1966080
    s_add_u32 s26, s26, s27
    s_add_u32 s26, s26, 2097152
    buffer_load_dword v127, v125, s[8:11], s26 offen
    s_sub_u32 s26, s26, s27
    s_xor_b32 s27, s27, 1966080
    s_add_u32 s26, s26, s27
    buffer_load_dword v127, v125, s[8:11], s26 offen
    s_branch main_kernel_at1loop
main_kernel_at1done:
    v_mfma_f32_32x32x16_bf16 v[48:63], v[156:159], v[84:87], v[48:63]
    s_waitcnt lgkmcnt(0)
    s_nop 7
    s_nop 3
    v_cmp_gt_f32 vcc, 0x2b800000, v60
    s_cmp_lg_u32 s28, 0
    s_cbranch_scc1 main_kernel_at1fin
    s_cmp_eq_u64 vcc, 0
    s_cbranch_scc1 main_kernel_at1fin
    s_mov_b32 s28, 16
    v_subrev_u32 v1, 163840, v1
    v_subrev_u32 v2, 163840, v2
    v_subrev_u32 v3, 163840, v3
    v_mov_b32 v10, 0xff800000
    v_mov_b32 v12, v1
    v_mov_b32 v13, v2
    s_mov_b32 s29, 0
main_kernel_at1fb:
    ds_read_b128 v[96:99], v12
    ds_read_b64 v[100:101], v13 offset:1024
    s_waitcnt lgkmcnt(0)
    v_mfma_f32_32x32x16_bf16 v[16:31], v[96:99], v[88:91], 0
    v_mfma_f32_32x32x8_bf16 v[16:31], v[100:101], v[92:93], v[16:31]
    v_add_u32 v12, 2560, v12
    v_add_u32 v13, 2560, v13
    s_nop 7
    s_nop 3
    v_max3_f32 v10, v10, v16, v17
    v_max3_f32 v10, v10, v18, v19
    v_max3_f32 v10, v10, v20, v21
    v_max3_f32 v10, v10, v22, v23
    v_max3_f32 v10, v10, v24, v25
    v_max3_f32 v10, v10, v26, v27
    v_max3_f32 v10, v10, v28, v29
    v_max3_f32 v10, v10, v30, v31
    s_add_u32 s29, s29, 1
    s_cmp_lt_u32 s29, 64
    s_cbranch_scc1 main_kernel_at1fb
    v_mov_b32 v11, v10
    s_nop 1
    v_permlane32_swap_b32 v10, v11
    s_nop 1
    v_max_f32 v10, v10, v11
    v_sub_f32 v10, 0, v10
    s_branch main_kernel_at1restart
main_kernel_at1fin:
    s_setprio 0
    v_rcp_f32 v10, v60
    s_add_u32 s23, s22, 20971520
    v_mov_b32 v11, v10
    v_pk_mul_f32 v[48:49], v[48:49], v[10:11]
    v_pk_mul_f32 v[50:51], v[50:51], v[10:11]
    v_cvt_pk_bf16_f32 v48, v48, v49
    v_cvt_pk_bf16_f32 v49, v50, v51
    buffer_store_dwordx2 v[48:49], v4, s[8:11], s23 offen
    v_pk_mul_f32 v[52:53], v[52:53], v[10:11]
    v_pk_mul_f32 v[54:55], v[54:55], v[10:11]
    v_cvt_pk_bf16_f32 v52, v52, v53
    v_cvt_pk_bf16_f32 v53, v54, v55
    buffer_store_dwordx2 v[52:53], v5, s[8:11], s23 offen
    s_mov_b32 exec_hi, 0
    v_pk_mul_f32 v[56:57], v[56:57], v[10:11]
    v_pk_mul_f32 v[58:59], v[58:59], v[10:11]
    v_cvt_pk_bf16_f32 v56, v56, v57
    v_cvt_pk_bf16_f32 v57, v58, v59
    buffer_store_dwordx2 v[56:57], v6, s[8:11], s23 offen
    s_mov_b32 exec_hi, -1
    s_waitcnt vmcnt(0)
    s_barrier
    s_cmp_lg_u32 s3, 0
    s_cbranch_scc1 main_kernel_sig12
    s_add_u32 s44, s58, 48332800
    v_mov_b32 v246, 1
    s_mov_b64 exec, 1
    s_cmp_lg_u32 s84, 0
    s_cbranch_scc1 main_kernel_sig12s
    buffer_store_dword v246, off, s[8:11], s44
    s_branch main_kernel_sig12e
main_kernel_sig12s:
    buffer_wbl2 sc1
    s_waitcnt vmcnt(0)
    buffer_store_dword v246, off, s[8:11], s44 sc1
main_kernel_sig12e:
    s_mov_b64 exec, -1
main_kernel_sig12:
    s_cmp_lt_u32 s3, 4
    s_cbranch_scc1 main_kernel_c2
    s_and_b32 s7, s3, 3
    s_mov_b32 s20, s92
    s_mov_b32 s21, s93
    v_lshlrev_b32 v1, 4, v0
    v_add_u32 v20, s93, v1
    v_add_u32 v21, 0x10000, v20
    s_add_u32 m0, s21, 71680
    s_add_u32 s23, s20, 71680
    buffer_load_dwordx4 v1, s[8:11], s23 offen offset:0 lds
    buffer_load_dwordx4 v1, s[8:11], s23 offen offset:1024 lds
    s_mov_b32 exec_hi, 0
    buffer_load_dwordx4 v1, s[8:11], s23 offen offset:2048 lds
    s_mov_b32 exec_hi, -1
    s_add_u32 m0, s21, 81920
    s_add_u32 s23, s20, 81920
    buffer_load_dwordx4 v1, s[8:11], s23 offen offset:0 lds
    buffer_load_dwordx4 v1, s[8:11], s23 offen offset:1024 lds
    s_mov_b32 exec_hi, 0
    buffer_load_dwordx4 v1, s[8:11], s23 offen offset:2048 lds
    s_mov_b32 exec_hi, -1
    s_add_u32 m0, s21, 92160
    s_add_u32 s23, s20, 92160
    buffer_load_dwordx4 v1, s[8:11], s23 offen offset:0 lds
    buffer_load_dwordx4 v1, s[8:11], s23 offen offset:1024 lds
    s_mov_b32 exec_hi, 0
    buffer_load_dwordx4 v1, s[8:11], s23 offen offset:2048 lds
    s_mov_b32 exec_hi, -1
    ds_write_b128 v20, v[160:163] offset:0
    ds_write_b128 v20, v[164:167] offset:1024
    s_mov_b32 exec_hi, 0
    ds_write_b128 v20, v[168:171] offset:2048
    s_mov_b32 exec_hi, -1
    ds_write_b128 v20, v[172:175] offset:10240
    ds_write_b128 v20, v[176:179] offset:11264
    s_mov_b32 exec_hi, 0
    ds_write_b128 v20, v[180:183] offset:12288
    s_mov_b32 exec_hi, -1
    ds_write_b128 v20, v[184:187] offset:20480
    ds_write_b128 v20, v[188:191] offset:21504
    s_mov_b32 exec_hi, 0
    ds_write_b128 v20, v[192:195] offset:22528
    s_mov_b32 exec_hi, -1
    ds_write_b128 v20, v[196:199] offset:30720
    ds_write_b128 v20, v[200:203] offset:31744
    s_mov_b32 exec_hi, 0
    ds_write_b128 v20, v[204:207] offset:32768
    s_mov_b32 exec_hi, -1
    ds_write_b128 v20, v[208:211] offset:40960
    ds_write_b128 v20, v[212:215] offset:41984
    s_mov_b32 exec_hi, 0
    ds_write_b128 v20, v[216:219] offset:43008
    s_mov_b32 exec_hi, -1
    ds_write_b128 v20, v[220:223] offset:51200
    ds_write_b128 v20, v[224:227] offset:52224
    s_mov_b32 exec_hi, 0
    ds_write_b128 v20, v[228:231] offset:53248
    s_mov_b32 exec_hi, -1
    ds_write_b128 v20, v[232:235] offset:61440
    ds_write_b128 v20, v[236:239] offset:62464
    s_mov_b32 exec_hi, 0
    ds_write_b128 v20, v[240:243] offset:63488
    s_mov_b32 exec_hi, -1
    s_waitcnt lgkmcnt(0)
    s_barrier
    s_barrier
    s_and_b32 s98, s3, 3
    s_mul_i32 s93, s98, 3072
    s_mul_i32 s92, s54, 245760
    s_add_u32 s92, s92, s93
    s_add_u32 s92, s92, 2097152
    s_add_u32 s97, s92, 0
    buffer_load_dwordx4 v[32:35], v1, s[8:11], s97 offen offset:0
    buffer_load_dwordx4 v[36:39], v1, s[8:11], s97 offen offset:1024
    buffer_load_dwordx4 v[40:43], v1, s[8:11], s97 offen offset:2048
    s_add_u32 s97, s92, 12288
    buffer_load_dwordx4 v[44:47], v1, s[8:11], s97 offen offset:0
    buffer_load_dwordx4 v[48:51], v1, s[8:11], s97 offen offset:1024
    buffer_load_dwordx4 v[52:55], v1, s[8:11], s97 offen offset:2048
    s_barrier
    s_add_u32 s97, s92, 24576
    buffer_load_dwordx4 v[56:59], v1, s[8:11], s97 offen offset:0
    buffer_load_dwordx4 v[60:63], v1, s[8:11], s97 offen offset:1024
    buffer_load_dwordx4 v[64:67], v1, s[8:11], s97 offen offset:2048
    s_add_u32 s97, s92, 36864
    buffer_load_dwordx4 v[68:71], v1, s[8:11], s97 offen offset:0
    buffer_load_dwordx4 v[72:75], v1, s[8:11], s97 offen offset:1024
    buffer_load_dwordx4 v[76:79], v1, s[8:11], s97 offen offset:2048
    s_barrier
    s_add_u32 s97, s92, 49152
    buffer_load_dwordx4 v[80:83], v1, s[8:11], s97 offen offset:0
    buffer_load_dwordx4 v[84:87], v1, s[8:11], s97 offen offset:1024
    buffer_load_dwordx4 v[88:91], v1, s[8:11], s97 offen offset:2048
    s_add_u32 s97, s92, 61440
    buffer_load_dwordx4 v[92:95], v1, s[8:11], s97 offen offset:0
    buffer_load_dwordx4 v[96:99], v1, s[8:11], s97 offen offset:1024
    buffer_load_dwordx4 v[100:103], v1, s[8:11], s97 offen offset:2048
    s_waitcnt vmcnt(24)
    s_barrier
    s_add_u32 s97, s92, 73728
    buffer_load_dwordx4 v[104:107], v1, s[8:11], s97 offen offset:0
    buffer_load_dwordx4 v[108:111], v1, s[8:11], s97 offen offset:1024
    buffer_load_dwordx4 v[112:115], v1, s[8:11], s97 offen offset:2048
    s_add_u32 s97, s92, 86016
    buffer_load_dwordx4 v[116:119], v1, s[8:11], s97 offen offset:0
    buffer_load_dwordx4 v[120:123], v1, s[8:11], s97 offen offset:1024
    buffer_load_dwordx4 v[124:127], v1, s[8:11], s97 offen offset:2048
    s_waitcnt vmcnt(27)
    s_waitcnt vmcnt(24)
    s_barrier
    s_barrier
    s_and_b32 s7, s3, 3
    s_mov_b32 s20, s92
    s_mov_b32 s21, s93
    v_lshlrev_b32 v1, 4, v0
    v_add_u32 v20, s93, v1
    v_add_u32 v21, 0x10000, v20
    s_waitcnt vmcnt(21)
    ds_write_b128 v20, v[32:35] offset:0
    ds_write_b128 v20, v[36:39] offset:1024
    ds_write_b128 v20, v[40:43] offset:2048
    s_waitcnt vmcnt(18)
    ds_write_b128 v20, v[44:47] offset:12288
    ds_write_b128 v20, v[48:51] offset:13312
    ds_write_b128 v20, v[52:55] offset:14336
    s_waitcnt vmcnt(15)
    ds_write_b128 v20, v[56:59] offset:24576
    ds_write_b128 v20, v[60:63] offset:25600
    ds_write_b128 v20, v[64:67] offset:26624
    s_waitcnt vmcnt(12)
    ds_write_b128 v20, v[68:71] offset:36864
    ds_write_b128 v20, v[72:75] offset:37888
    ds_write_b128 v20, v[76:79] offset:38912
    s_waitcnt vmcnt(9)
    ds_write_b128 v20, v[80:83] offset:49152
    ds_write_b128 v20, v[84:87] offset:50176
    ds_write_b128 v20, v[88:91] offset:51200
    s_waitcnt vmcnt(6)
    ds_write_b128 v20, v[92:95] offset:61440
    ds_write_b128 v20, v[96:99] offset:62464
    ds_write_b128 v20, v[100:103] offset:63488
    s_waitcnt vmcnt(3)
    ds_write_b128 v21, v[104:107] offset:8192
    ds_write_b128 v21, v[108:111] offset:9216
    ds_write_b128 v21, v[112:115] offset:10240
    s_waitcnt vmcnt(0)
    ds_write_b128 v21, v[116:119] offset:20480
    ds_write_b128 v21, v[120:123] offset:21504
    ds_write_b128 v21, v[124:127] offset:22528
    s_waitcnt lgkmcnt(0)
    s_barrier
    s_lshl_b32 s4, s53, 2
    s_add_u32 s4, s4, s7
    s_mul_i32 s22, s4, 40960
    s_add_u32 s22, s22, 8388608
    v_and_b32 v6, 15, v0
    v_bfe_u32 v7, v0, 4, 1
    v_lshrrev_b32 v8, 5, v0
    v_lshlrev_b32 v6, 4, v6
    v_lshl_add_u32 v6, v8, 8, v6
    v_mul_u32_u24 v4, 20480, v7
    v_add_u32 v4, v4, v6
    s_barrier
    s_lshl_b32 s26, s7, 11
    s_add_u32 s26, s26, 98304
    s_add_u32 m0, s26, 0
    s_add_u32 s23, s22, 0
    buffer_load_dwordx4 v4, s[8:11], s23 offen sc1 lds
    s_add_u32 m0, s26, 1024
    s_add_u32 s23, s22, 512
    buffer_load_dwordx4 v4, s[8:11], s23 offen sc1 lds
    s_add_u32 m0, s26, 8192
    s_add_u32 s23, s22, 1024
    buffer_load_dwordx4 v4, s[8:11], s23 offen sc1 lds
    s_add_u32 m0, s26, 9216
    s_add_u32 s23, s22, 1536
    buffer_load_dwordx4 v4, s[8:11], s23 offen sc1 lds
    s_add_u32 m0, s26, 16384
    s_add_u32 s23, s22, 2048
    buffer_load_dwordx4 v4, s[8:11], s23 offen sc1 lds
    s_add_u32 m0, s26, 17408
    s_add_u32 s23, s22, 2560
    buffer_load_dwordx4 v4, s[8:11], s23 offen sc1 lds
    s_add_u32 m0, s26, 24576
    s_add_u32 s23, s22, 3072
    buffer_load_dwordx4 v4, s[8:11], s23 offen sc1 lds
    s_add_u32 m0, s26, 25600
    s_add_u32 s23, s22, 3584
    buffer_load_dwordx4 v4, s[8:11], s23 offen sc1 lds
    s_add_u32 m0, s26, 32768
    s_add_u32 s23, s22, 4096
    buffer_load_dwordx4 v4, s[8:11], s23 offen sc1 lds
    s_add_u32 m0, s26, 33792
    s_add_u32 s23, s22, 4608
    buffer_load_dwordx4 v4, s[8:11], s23 offen sc1 lds
    s_add_u32 m0, s26, 40960
    s_add_u32 s23, s22, 5120
    buffer_load_dwordx4 v4, s[8:11], s23 offen sc1 lds
    s_add_u32 m0, s26, 41984
    s_add_u32 s23, s22, 5632
    buffer_load_dwordx4 v4, s[8:11], s23 offen sc1 lds
    s_add_u32 m0, s26, 49152
    s_add_u32 s23, s22, 6144
    buffer_load_dwordx4 v4, s[8:11], s23 offen sc1 lds
    s_add_u32 m0, s26, 50176
    s_add_u32 s23, s22, 6656
    buffer_load_dwordx4 v4, s[8:11], s23 offen sc1 lds
    s_add_u32 m0, s26, 57344
    s_add_u32 s23, s22, 7168
    buffer_load_dwordx4 v4, s[8:11], s23 offen sc1 lds
    s_add_u32 m0, s26, 58368
    s_add_u32 s23, s22, 7680
    buffer_load_dwordx4 v4, s[8:11], s23 offen sc1 lds
    s_waitcnt vmcnt(14)
    s_barrier
    s_waitcnt vmcnt(12)
    s_barrier
    s_waitcnt vmcnt(10)
    s_barrier
    s_add_u32 m0, s26, 0
    s_add_u32 s23, s22, 8192
    buffer_load_dwordx4 v4, s[8:11], s23 offen sc1 lds
    s_add_u32 m0, s26, 1024
    s_add_u32 s23, s22, 8704
    buffer_load_dwordx4 v4, s[8:11], s23 offen sc1 lds
    s_add_u32 m0, s21, 0
    s_add_u32 s23, s20, 98304
    buffer_load_dwordx4 v1, s[8:11], s23 offen offset:0 lds
    buffer_load_dwordx4 v1, s[8:11], s23 offen offset:1024 lds
    buffer_load_dwordx4 v1, s[8:11], s23 offen offset:2048 lds
    s_waitcnt vmcnt(13)
    s_barrier
    s_add_u32 m0, s26, 8192
    s_add_u32 s23, s22, 9216
    buffer_load_dwordx4 v4, s[8:11], s23 offen sc1 lds
    s_add_u32 m0, s26, 9216
    s_add_u32 s23, s22, 9728
    buffer_load_dwordx4 v4, s[8:11], s23 offen sc1 lds
    s_add_u32 m0, s21, 12288
    s_add_u32 s23, s20, 110592
    buffer_load_dwordx4 v1, s[8:11], s23 offen offset:0 lds
    buffer_load_dwordx4 v1, s[8:11], s23 offen offset:1024 lds
    buffer_load_dwordx4 v1, s[8:11], s23 offen offset:2048 lds
    s_waitcnt vmcnt(16)
    s_barrier
    s_add_u32 m0, s26, 16384
    s_add_u32 s23, s22, 10240
    buffer_load_dwordx4 v4, s[8:11], s23 offen sc1 lds
    s_add_u32 m0, s26, 17408
    s_add_u32 s23, s22, 10752
    buffer_load_dwordx4 v4, s[8:11], s23 offen sc1 lds
    s_add_u32 m0, s21, 24576
    s_add_u32 s23, s20, 122880
    buffer_load_dwordx4 v1, s[8:11], s23 offen offset:0 lds
    buffer_load_dwordx4 v1, s[8:11], s23 offen offset:1024 lds
    buffer_load_dwordx4 v1, s[8:11], s23 offen offset:2048 lds
    s_waitcnt vmcnt(19)
    s_barrier
    s_add_u32 m0, s26, 24576
    s_add_u32 s23, s22, 11264
    buffer_load_dwordx4 v4, s[8:11], s23 offen sc1 lds
    s_add_u32 m0, s26, 25600
    s_add_u32 s23, s22, 11776
    buffer_load_dwordx4 v4, s[8:11], s23 offen sc1 lds
    s_add_u32 m0, s21, 36864
    s_add_u32 s23, s20, 135168
    buffer_load_dwordx4 v1, s[8:11], s23 offen offset:0 lds
    buffer_load_dwordx4 v1, s[8:11], s23 offen offset:1024 lds
    buffer_load_dwordx4 v1, s[8:11], s23 offen offset:2048 lds
    s_waitcnt vmcnt(22)
    s_barrier
    s_add_u32 m0, s26, 32768
    s_add_u32 s23, s22, 12288
    buffer_load_dwordx4 v4, s[8:11], s23 offen sc1 lds
    s_add_u32 m0, s26, 33792
    s_add_u32 s23, s22, 12800
    buffer_load_dwordx4 v4, s[8:11], s23 offen sc1 lds
    s_add_u32 m0, s21, 49152
    s_add_u32 s23, s20, 147456
    buffer_load_dwordx4 v1, s[8:11], s23 offen offset:0 lds
    buffer_load_dwordx4 v1, s[8:11], s23 offen offset:1024 lds
    buffer_load_dwordx4 v1, s[8:11], s23 offen offset:2048 lds
    s_waitcnt vmcnt(25)
    s_barrier
    s_add_u32 m0, s26, 40960
    s_add_u32 s23, s22, 13312
    buffer_load_dwordx4 v4, s[8:11], s23 offen sc1 lds
    s_add_u32 m0, s26, 41984
    s_add_u32 s23, s22, 13824
    buffer_load_dwordx4 v4, s[8:11], s23 offen sc1 lds
    s_add_u32 m0, s21, 61440
    s_add_u32 s23, s20, 159744
    buffer_load_dwordx4 v1, s[8:11], s23 offen offset:0 lds
    buffer_load_dwordx4 v1, s[8:11], s23 offen offset:1024 lds
    buffer_load_dwordx4 v1, s[8:11], s23 offen offset:2048 lds
    s_waitcnt vmcnt(25)
    s_barrier
    s_add_u32 m0, s26, 49152
    s_add_u32 s23, s22, 14336
    buffer_load_dwordx4 v4, s[8:11], s23 offen sc1 lds
    s_add_u32 m0, s26, 50176
    s_add_u32 s23, s22, 14848
    buffer_load_dwordx4 v4, s[8:11], s23 offen sc1 lds
    s_add_u32 m0, s21, 73728
    s_add_u32 s23, s20, 172032
    buffer_load_dwordx4 v1, s[8:11], s23 offen offset:0 lds
    buffer_load_dwordx4 v1, s[8:11], s23 offen offset:1024 lds
    buffer_load_dwordx4 v1, s[8:11], s23 offen offset:2048 lds
    s_waitcnt vmcnt(25)
    s_barrier
    s_add_u32 m0, s26, 57344
    s_add_u32 s23, s22, 15360
    buffer_load_dwordx4 v4, s[8:11], s23 offen sc1 lds
    s_add_u32 m0, s26, 58368
    s_add_u32 s23, s22, 15872
    buffer_load_dwordx4 v4, s[8:11], s23 offen sc1 lds
    s_add_u32 m0, s21, 86016
    s_add_u32 s23, s20, 184320
    buffer_load_dwordx4 v1, s[8:11], s23 offen offset:0 lds
    buffer_load_dwordx4 v1, s[8:11], s23 offen offset:1024 lds
    buffer_load_dwordx4 v1, s[8:11], s23 offen offset:2048 lds
    s_waitcnt vmcnt(25)
    s_barrier
    s_add_u32 m0, s26, 0
    s_add_u32 s23, s22, 16384
    buffer_load_dwordx4 v4, s[8:11], s23 offen sc1 lds
    s_add_u32 m0, s26, 1024
    s_add_u32 s23, s22, 16896
    buffer_load_dwordx4 v4, s[8:11], s23 offen sc1 lds
    s_add_u32 m0, s21, 0
    s_add_u32 s23, s20, 196608
    buffer_load_dwordx4 v1, s[8:11], s23 offen offset:0 lds
    buffer_load_dwordx4 v1, s[8:11], s23 offen offset:1024 lds
    buffer_load_dwordx4 v1, s[8:11], s23 offen offset:2048 lds
    s_waitcnt vmcnt(25)
    s_barrier
    s_add_u32 m0, s26, 8192
    s_add_u32 s23, s22, 17408
    buffer_load_dwordx4 v4, s[8:11], s23 offen sc1 lds
    s_add_u32 m0, s26, 9216
    s_add_u32 s23, s22, 17920
    buffer_load_dwordx4 v4, s[8:11], s23 offen sc1 lds
    s_add_u32 m0, s21, 12288
    s_add_u32 s23, s20, 208896
    buffer_load_dwordx4 v1, s[8:11], s23 offen offset:0 lds
    buffer_load_dwordx4 v1, s[8:11], s23 offen offset:1024 lds
    buffer_load_dwordx4 v1, s[8:11], s23 offen offset:2048 lds
    s_waitcnt vmcnt(25)
    s_barrier
    s_add_u32 m0, s26, 16384
    s_add_u32 s23, s22, 18432
    buffer_load_dwordx4 v4, s[8:11], s23 offen sc1 lds
    s_add_u32 m0, s26, 17408
    s_add_u32 s23, s22, 18944
    buffer_load_dwordx4 v4, s[8:11], s23 offen sc1 lds
    s_add_u32 m0, s21, 24576
    s_add_u32 s23, s20, 221184
    buffer_load_dwordx4 v1, s[8:11], s23 offen offset:0 lds
    buffer_load_dwordx4 v1, s[8:11], s23 offen offset:1024 lds
    buffer_load_dwordx4 v1, s[8:11], s23 offen offset:2048 lds
    s_waitcnt vmcnt(25)
    s_barrier
    s_add_u32 m0, s26, 24576
    s_add_u32 s23, s22, 19456
    buffer_load_dwordx4 v4, s[8:11], s23 offen sc1 lds
    s_add_u32 m0, s26, 25600
    s_add_u32 s23, s22, 19968
    buffer_load_dwordx4 v4, s[8:11], s23 offen sc1 lds
    s_add_u32 m0, s21, 36864
    s_add_u32 s23, s20, 233472
    buffer_load_dwordx4 v1, s[8:11], s23 offen offset:0 lds
    buffer_load_dwordx4 v1, s[8:11], s23 offen offset:1024 lds
    buffer_load_dwordx4 v1, s[8:11], s23 offen offset:2048 lds
    s_waitcnt vmcnt(25)
    s_barrier
    s_and_b32 s98, s3, 3
    s_mul_i32 s93, s98, 2560
    s_mul_i32 s92, s51, 245760
    s_add_u32 s92, s92, s93
    s_add_u32 s92, s92, 6291456
    s_add_u32 s97, s92, 0
    buffer_load_dwordx4 v[32:35], v1, s[8:11], s97 offen offset:0
    buffer_load_dwordx4 v[36:39], v1, s[8:11], s97 offen offset:1024
    s_mov_b32 exec_hi, 0
    buffer_load_dwordx4 v[40:43], v1, s[8:11], s97 offen offset:2048
    s_mov_b32 exec_hi, -1
    s_add_u32 s97, s92, 10240
    buffer_load_dwordx4 v[44:47], v1, s[8:11], s97 offen offset:0
    buffer_load_dwordx4 v[48:51], v1, s[8:11], s97 offen offset:1024
    s_mov_b32 exec_hi, 0
    buffer_load_dwordx4 v[52:55], v1, s[8:11], s97 offen offset:2048
    s_mov_b32 exec_hi, -1
    s_waitcnt vmcnt(26)
    s_barrier
    s_add_u32 s97, s92, 20480
    buffer_load_dwordx4 v[56:59], v1, s[8:11], s97 offen offset:0
    buffer_load_dwordx4 v[60:63], v1, s[8:11], s97 offen offset:1024
    s_mov_b32 exec_hi, 0
    buffer_load_dwordx4 v[64:67], v1, s[8:11], s97 offen offset:2048
    s_mov_b32 exec_hi, -1
    s_add_u32 s97, s92, 30720
    buffer_load_dwordx4 v[68:71], v1, s[8:11], s97 offen offset:0
    buffer_load_dwordx4 v[72:75], v1, s[8:11], s97 offen offset:1024
    s_mov_b32 exec_hi, 0
    buffer_load_dwordx4 v[76:79], v1, s[8:11], s97 offen offset:2048
    s_mov_b32 exec_hi, -1
    s_waitcnt vmcnt(27)
    s_barrier
    s_add_u32 s97, s92, 40960
    buffer_load_dwordx4 v[80:83], v1, s[8:11], s97 offen offset:0
    buffer_load_dwordx4 v[84:87], v1, s[8:11], s97 offen offset:1024
    s_mov_b32 exec_hi, 0
    buffer_load_dwordx4 v[88:91], v1, s[8:11], s97 offen offset:2048
    s_mov_b32 exec_hi, -1
    s_add_u32 s97, s92, 51200
    buffer_load_dwordx4 v[92:95], v1, s[8:11], s97 offen offset:0
    buffer_load_dwordx4 v[96:99], v1, s[8:11], s97 offen offset:1024
    s_mov_b32 exec_hi, 0
    buffer_load_dwordx4 v[100:103], v1, s[8:11], s97 offen offset:2048
    s_mov_b32 exec_hi, -1
    s_waitcnt vmcnt(28)
    s_barrier
    s_add_u32 s97, s92, 61440
    buffer_load_dwordx4 v[104:107], v1, s[8:11], s97 offen offset:0
    buffer_load_dwordx4 v[108:111], v1, s[8:11], s97 offen offset:1024
    s_mov_b32 exec_hi, 0
    buffer_load_dwordx4 v[112:115], v1, s[8:11], s97 offen offset:2048
    s_mov_b32 exec_hi, -1
    s_add_u32 s97, s92, 71680
    buffer_load_dwordx4 v[116:119], v1, s[8:11], s97 offen offset:0
    buffer_load_dwordx4 v[120:123], v1, s[8:11], s97 offen offset:1024
    s_mov_b32 exec_hi, 0
    buffer_load_dwordx4 v[124:127], v1, s[8:11], s97 offen offset:2048
    s_mov_b32 exec_hi, -1
    s_waitcnt vmcnt(29)
    s_barrier
    s_add_u32 s97, s92, 81920
    buffer_load_dwordx4 v[128:131], v1, s[8:11], s97 offen offset:0
    buffer_load_dwordx4 v[132:135], v1, s[8:11], s97 offen offset:1024
    s_mov_b32 exec_hi, 0
    buffer_load_dwordx4 v[136:139], v1, s[8:11], s97 offen offset:2048
    s_mov_b32 exec_hi, -1
    s_add_u32 s97, s92, 92160
    buffer_load_dwordx4 v[140:143], v1, s[8:11], s97 offen offset:0
    buffer_load_dwordx4 v[144:147], v1, s[8:11], s97 offen offset:1024
    s_mov_b32 exec_hi, 0
    buffer_load_dwordx4 v[148:151], v1, s[8:11], s97 offen offset:2048
    s_mov_b32 exec_hi, -1
    s_waitcnt vmcnt(30)
    s_barrier
    s_add_u32 s97, s92, 102400
    buffer_load_dwordx4 v[152:155], v1, s[8:11], s97 offen offset:0
    buffer_load_dwordx4 v[156:159], v1, s[8:11], s97 offen offset:1024
    s_mov_b32 exec_hi, 0
    buffer_load_dwordx4 v[160:163], v1, s[8:11], s97 offen offset:2048
    s_mov_b32 exec_hi, -1
    s_add_u32 s97, s92, 112640
    buffer_load_dwordx4 v[164:167], v1, s[8:11], s97 offen offset:0
    buffer_load_dwordx4 v[168:171], v1, s[8:11], s97 offen offset:1024
    s_mov_b32 exec_hi, 0
    buffer_load_dwordx4 v[172:175], v1, s[8:11], s97 offen offset:2048
    s_mov_b32 exec_hi, -1
    s_barrier
    s_and_b32 s7, s3, 3
    s_mov_b32 s20, s92
    s_mov_b32 s21, s93
    v_lshlrev_b32 v1, 4, v0
    v_add_u32 v20, s93, v1
    v_add_u32 v21, 0x10000, v20
    s_add_u32 m0, s21, 122880
    s_add_u32 s23, s20, 122880
    buffer_load_dwordx4 v1, s[8:11], s23 offen offset:0 lds
    buffer_load_dwordx4 v1, s[8:11], s23 offen offset:1024 lds
    s_mov_b32 exec_hi, 0
    buffer_load_dwordx4 v1, s[8:11], s23 offen offset:2048 lds
    s_mov_b32 exec_hi, -1
    s_waitcnt vmcnt(36)
    ds_write_b128 v20, v[32:35] offset:0
    ds_write_b128 v20, v[36:39] offset:1024
    s_mov_b32 exec_hi, 0
    ds_write_b128 v20, v[40:43] offset:2048
    s_mov_b32 exec_hi, -1
    s_waitcnt vmcnt(33)
    ds_write_b128 v20, v[44:47] offset:10240
    ds_write_b128 v20, v[48:51] offset:11264
    s_mov_b32 exec_hi, 0
    ds_write_b128 v20, v[52:55] offset:12288
    s_mov_b32 exec_hi, -1
    s_waitcnt vmcnt(30)
    ds_write_b128 v20, v[56:59] offset:20480
    ds_write_b128 v20, v[60:63] offset:21504
    s_mov_b32 exec_hi, 0
    ds_write_b128 v20, v[64:67] offset:22528
    s_mov_b32 exec_hi, -1
    s_waitcnt vmcnt(27)
    ds_write_b128 v20, v[68:71] offset:30720
    ds_write_b128 v20, v[72:75] offset:31744
    s_mov_b32 exec_hi, 0
    ds_write_b128 v20, v[76:79] offset:32768
    s_mov_b32 exec_hi, -1
    s_waitcnt vmcnt(24)
    ds_write_b128 v20, v[80:83] offset:40960
    ds_write_b128 v20, v[84:87] offset:41984
    s_mov_b32 exec_hi, 0
    ds_write_b128 v20, v[88:91] offset:43008
    s_mov_b32 exec_hi, -1
    s_waitcnt vmcnt(21)
    ds_write_b128 v20, v[92:95] offset:51200
    ds_write_b128 v20, v[96:99] offset:52224
    s_mov_b32 exec_hi, 0
    ds_write_b128 v20, v[100:103] offset:53248
    s_mov_b32 exec_hi, -1
    s_waitcnt vmcnt(18)
    ds_write_b128 v20, v[104:107] offset:61440
    ds_write_b128 v20, v[108:111] offset:62464
    s_mov_b32 exec_hi, 0
    ds_write_b128 v20, v[112:115] offset:63488
    s_mov_b32 exec_hi, -1
    s_waitcnt vmcnt(15)
    ds_write_b128 v21, v[116:119] offset:6144
    ds_write_b128 v21, v[120:123] offset:7168
    s_mov_b32 exec_hi, 0
    ds_write_b128 v21, v[124:127] offset:8192
    s_mov_b32 exec_hi, -1
    s_waitcnt vmcnt(12)
    ds_write_b128 v21, v[128:131] offset:16384
    ds_write_b128 v21, v[132:135] offset:17408
    s_mov_b32 exec_hi, 0
    ds_write_b128 v21, v[136:139] offset:18432
    s_mov_b32 exec_hi, -1
    s_waitcnt vmcnt(9)
    ds_write_b128 v21, v[140:143] offset:26624
    ds_write_b128 v21, v[144:147] offset:27648
    s_mov_b32 exec_hi, 0
    ds_write_b128 v21, v[148:151] offset:28672
    s_mov_b32 exec_hi, -1
    s_waitcnt vmcnt(6)
    ds_write_b128 v21, v[152:155] offset:36864
    ds_write_b128 v21, v[156:159] offset:37888
    s_mov_b32 exec_hi, 0
    ds_write_b128 v21, v[160:163] offset:38912
    s_mov_b32 exec_hi, -1
    s_waitcnt vmcnt(3)
    ds_write_b128 v21, v[164:167] offset:47104
    ds_write_b128 v21, v[168:171] offset:48128
    s_mov_b32 exec_hi, 0
    ds_write_b128 v21, v[172:175] offset:49152
    s_mov_b32 exec_hi, -1
    s_waitcnt lgkmcnt(0)
    s_barrier
    s_barrier
    s_barrier
    s_barrier
    s_add_u32 m0, s21, 0
    s_add_u32 s23, s20, 133120
    buffer_load_dwordx4 v1, s[8:11], s23 offen offset:0 lds
    buffer_load_dwordx4 v1, s[8:11], s23 offen offset:1024 lds
    s_mov_b32 exec_hi, 0
    buffer_load_dwordx4 v1, s[8:11], s23 offen offset:2048 lds
    s_mov_b32 exec_hi, -1
    s_barrier
    s_add_u32 m0, s21, 10240
    s_add_u32 s23, s20, 143360
    buffer_load_dwordx4 v1, s[8:11], s23 offen offset:0 lds
    buffer_load_dwordx4 v1, s[8:11], s23 offen offset:1024 lds
    s_mov_b32 exec_hi, 0
    buffer_load_dwordx4 v1, s[8:11], s23 offen offset:2048 lds
    s_mov_b32 exec_hi, -1
    s_add_u32 m0, s21, 20480
    s_add_u32 s23, s20, 153600
    buffer_load_dwordx4 v1, s[8:11], s23 offen offset:0 lds
    buffer_load_dwordx4 v1, s[8:11], s23 offen offset:1024 lds
    s_mov_b32 exec_hi, 0
    buffer_load_dwordx4 v1, s[8:11], s23 offen offset:2048 lds
    s_mov_b32 exec_hi, -1
    s_barrier
    s_add_u32 m0, s21, 30720
    s_add_u32 s23, s20, 163840
    buffer_load_dwordx4 v1, s[8:11], s23 offen offset:0 lds
    buffer_load_dwordx4 v1, s[8:11], s23 offen offset:1024 lds
    s_mov_b32 exec_hi, 0
    buffer_load_dwordx4 v1, s[8:11], s23 offen offset:2048 lds
    s_mov_b32 exec_hi, -1
    s_add_u32 m0, s21, 40960
    s_add_u32 s23, s20, 174080
    buffer_load_dwordx4 v1, s[8:11], s23 offen offset:0 lds
    buffer_load_dwordx4 v1, s[8:11], s23 offen offset:1024 lds
    s_mov_b32 exec_hi, 0
    buffer_load_dwordx4 v1, s[8:11], s23 offen offset:2048 lds
    s_mov_b32 exec_hi, -1
    s_barrier
    s_add_u32 m0, s21, 51200
    s_add_u32 s23, s20, 184320
    buffer_load_dwordx4 v1, s[8:11], s23 offen offset:0 lds
    buffer_load_dwordx4 v1, s[8:11], s23 offen offset:1024 lds
    s_mov_b32 exec_hi, 0
    buffer_load_dwordx4 v1, s[8:11], s23 offen offset:2048 lds
    s_mov_b32 exec_hi, -1
    s_add_u32 m0, s21, 61440
    s_add_u32 s23, s20, 194560
    buffer_load_dwordx4 v1, s[8:11], s23 offen offset:0 lds
    buffer_load_dwordx4 v1, s[8:11], s23 offen offset:1024 lds
    s_mov_b32 exec_hi, 0
    buffer_load_dwordx4 v1, s[8:11], s23 offen offset:2048 lds
    s_mov_b32 exec_hi, -1
    s_barrier
    s_add_u32 m0, s21, 71680
    s_add_u32 s23, s20, 204800
    buffer_load_dwordx4 v1, s[8:11], s23 offen offset:0 lds
    buffer_load_dwordx4 v1, s[8:11], s23 offen offset:1024 lds
    s_mov_b32 exec_hi, 0
    buffer_load_dwordx4 v1, s[8:11], s23 offen offset:2048 lds
    s_mov_b32 exec_hi, -1
    s_add_u32 m0, s21, 81920
    s_add_u32 s23, s20, 215040
    buffer_load_dwordx4 v1, s[8:11], s23 offen offset:0 lds
    buffer_load_dwordx4 v1, s[8:11], s23 offen offset:1024 lds
    s_mov_b32 exec_hi, 0
    buffer_load_dwordx4 v1, s[8:11], s23 offen offset:2048 lds
    s_mov_b32 exec_hi, -1
    s_waitcnt vmcnt(27)
    s_waitcnt vmcnt(24)
    s_barrier
    s_add_u32 m0, s21, 92160
    s_add_u32 s23, s20, 225280
    buffer_load_dwordx4 v1, s[8:11], s23 offen offset:0 lds
    buffer_load_dwordx4 v1, s[8:11], s23 offen offset:1024 lds
    s_mov_b32 exec_hi, 0
    buffer_load_dwordx4 v1, s[8:11], s23 offen offset:2048 lds
    s_mov_b32 exec_hi, -1
    s_add_u32 m0, s21, 102400
    s_add_u32 s23, s20, 235520
    buffer_load_dwordx4 v1, s[8:11], s23 offen offset:0 lds
    buffer_load_dwordx4 v1, s[8:11], s23 offen offset:1024 lds
    s_mov_b32 exec_hi, 0
    buffer_load_dwordx4 v1, s[8:11], s23 offen offset:2048 lds
    s_mov_b32 exec_hi, -1
    s_waitcnt vmcnt(27)
    s_waitcnt vmcnt(24)
    s_barrier
    s_waitcnt vmcnt(21)
    s_waitcnt vmcnt(18)
    s_barrier
    s_waitcnt vmcnt(15)
    s_waitcnt vmcnt(12)
    s_barrier
    s_waitcnt vmcnt(9)
    s_waitcnt vmcnt(6)
    s_barrier
    s_waitcnt vmcnt(3)
    s_waitcnt vmcnt(0)
    s_barrier
    s_barrier
    s_endpgm
main_kernel_c2:
    v_lshlrev_b32 v1, 4, v0
    v_and_b32 v6, 15, v0
    v_lshrrev_b32 v7, 4, v0
    s_and_b32 s7, s3, 1
    s_lshr_b32 s5, s3, 1
    s_lshl_b32 s4, s50, 2
    s_lshl_b32 s20, s7, 1
    s_add_u32 s4, s4, s20
    s_mul_i32 s22, s4, 20480
    s_lshl_b32 s20, s5, 10
    s_add_u32 s22, s22, s20
    s_add_u32 s22, s22, 20971520
    s_add_u32 s4, s4, s5
    s_mul_i32 s20, s5, 5120
    v_add_u32 v2, s20, v1
    v_add_u32 v3, 0x10000, v2
    v_add_u32 v4, 0x20000, v2
    v_add_u32 v5, 20480, v1
    v_lshrrev_b32 v10, 1, v7
    v_and_b32 v11, 1, v7
    v_lshlrev_b32 v8, 8, v10
    v_lshl_add_u32 v8, v6, 4, v8
    v_lshl_add_u32 v9, v11, 9, v8
    v_lshl_add_u32 v8, v11, 3, v8
    s_mul_i32 s24, s4, 20480
    s_mul_i32 s26, s51, 2560
    s_add_u32 s24, s24, s26
    s_add_u32 s25, s24, 8388608
    buffer_load_dwordx2 v[184:185], v8, s[8:11], s25 offen offset:0 sc1
    buffer_load_dwordx2 v[186:187], v8, s[8:11], s25 offen offset:512 sc1
    buffer_load_dwordx2 v[188:189], v8, s[8:11], s25 offen offset:1024 sc1
    buffer_load_dwordx2 v[190:191], v8, s[8:11], s25 offen offset:1536 sc1
    buffer_load_dwordx2 v[192:193], v8, s[8:11], s25 offen offset:2048 sc1
    s_cmp_lg_u32 s3, 0
    s_cbranch_scc1 main_kernel_poll13p
    v_lshlrev_b32 v250, 2, v0
    s_mov_b32 s45, 0x200000
    s_add_u32 s44, s59, 48332800
    s_mov_b64 exec, 255
main_kernel_poll13_0:
    buffer_load_dword v246, v250, s[8:11], s44 offen sc1
    s_waitcnt vmcnt(0)
    v_cmp_ne_u32 vcc, 1, v246
    s_sub_u32 s45, s45, 1
    s_cbranch_scc1 main_kernel_poll13d
    s_cmp_eq_u64 vcc, 0
    s_cbranch_scc0 main_kernel_poll13_0
    s_mov_b64 exec, -1
main_kernel_poll13d:
    s_mov_b64 exec, -1
    s_cmp_eq_u32 s84, 0
    s_cbranch_scc1 main_kernel_poll13p
    buffer_inv sc1
    s_waitcnt vmcnt(0)
main_kernel_poll13p:
    s_barrier
    s_add_u32 s23, s22, 0
    buffer_load_dwordx4 v[24:27], v1, s[8:11], s23 offen sc1
    buffer_load_dwordx4 v[28:31], v5, s[8:11], s23 offen sc1
    s_add_u32 s23, s22, 2048
    buffer_load_dwordx4 v[32:35], v1, s[8:11], s23 offen sc1
    buffer_load_dwordx4 v[36:39], v5, s[8:11], s23 offen sc1
    s_add_u32 s23, s22, 4096
    buffer_load_dwordx4 v[40:43], v1, s[8:11], s23 offen sc1
    buffer_load_dwordx4 v[44:47], v5, s[8:11], s23 offen sc1
    s_add_u32 s23, s22, 6144
    buffer_load_dwordx4 v[48:51], v1, s[8:11], s23 offen sc1
    buffer_load_dwordx4 v[52:55], v5, s[8:11], s23 offen sc1
    s_add_u32 s23, s22, 8192
    buffer_load_dwordx4 v[56:59], v1, s[8:11], s23 offen sc1
    buffer_load_dwordx4 v[60:63], v5, s[8:11], s23 offen sc1
    s_add_u32 s23, s22, 10240
    buffer_load_dwordx4 v[64:67], v1, s[8:11], s23 offen sc1
    buffer_load_dwordx4 v[68:71], v5, s[8:11], s23 offen sc1
    s_add_u32 s23, s22, 12288
    buffer_load_dwordx4 v[72:75], v1, s[8:11], s23 offen sc1
    buffer_load_dwordx4 v[76:79], v5, s[8:11], s23 offen sc1
    s_add_u32 s23, s22, 14336
    buffer_load_dwordx4 v[80:83], v1, s[8:11], s23 offen sc1
    buffer_load_dwordx4 v[84:87], v5, s[8:11], s23 offen sc1
    s_add_u32 s23, s22, 16384
    buffer_load_dwordx4 v[88:91], v1, s[8:11], s23 offen sc1
    buffer_load_dwordx4 v[92:95], v5, s[8:11], s23 offen sc1
    s_add_u32 s23, s22, 18432
    buffer_load_dwordx4 v[96:99], v1, s[8:11], s23 offen sc1
    buffer_load_dwordx4 v[100:103], v5, s[8:11], s23 offen sc1
    v_lshlrev_b32 v244, 7, v0
    s_mov_b64 exec, 1048575
    s_lshl_b32 s26, s4, 10
    s_add_u32 s26, s26, 47185920
    s_mov_b64 exec, 0xff
    buffer_load_dword v245, v244, s[8:11], s26 offen sc1
    s_mov_b64 exec, -1
    s_barrier
    ds_read_b128 v[104:107], v2 offset:0
    ds_read_b128 v[108:111], v2 offset:1024
    ds_read_b128 v[112:115], v2 offset:2048
    ds_read_b128 v[116:119], v2 offset:3072
    ds_read_b128 v[120:123], v2 offset:4096
    s_waitcnt vmcnt(19)
    s_waitcnt lgkmcnt(4)
    v_mfma_f32_16x16x32_bf16 v[144:147], v[104:107], v[24:27], 0
    v_mfma_f32_16x16x32_bf16 v[164:167], v[104:107], v[28:31], 0
    ds_read_b128 v[124:127], v2 offset:10240
    s_waitcnt lgkmcnt(4)
    v_mfma_f32_16x16x32_bf16 v[148:151], v[108:111], v[24:27], 0
    v_mfma_f32_16x16x32_bf16 v[168:171], v[108:111], v[28:31], 0
    ds_read_b128 v[128:131], v2 offset:11264
    s_waitcnt lgkmcnt(4)
    v_mfma_f32_16x16x32_bf16 v[152:155], v[112:115], v[24:27], 0
    v_mfma_f32_16x16x32_bf16 v[172:175], v[112:115], v[28:31], 0
    ds_read_b128 v[132:135], v2 offset:12288
    s_waitcnt lgkmcnt(4)
    v_mfma_f32_16x16x32_bf16 v[156:159], v[116:119], v[24:27], 0
    v_mfma_f32_16x16x32_bf16 v[176:179], v[116:119], v[28:31], 0
    ds_read_b128 v[136:139], v2 offset:13312
    s_waitcnt lgkmcnt(4)
    v_mfma_f32_16x16x32_bf16 v[160:163], v[120:123], v[24:27], 0
    v_mfma_f32_16x16x32_bf16 v[180:183], v[120:123], v[28:31], 0
    ds_read_b128 v[140:143], v2 offset:14336
    s_waitcnt vmcnt(17)
    s_waitcnt lgkmcnt(4)
    v_mfma_f32_16x16x32_bf16 v[144:147], v[124:127], v[32:35], v[144:147]
    v_mfma_f32_16x16x32_bf16 v[164:167], v[124:127], v[36:39], v[164:167]
    s_barrier
    ds_read_b128 v[104:107], v2 offset:20480
    s_waitcnt lgkmcnt(4)
    v_mfma_f32_16x16x32_bf16 v[148:151], v[128:131], v[32:35], v[148:151]
    v_mfma_f32_16x16x32_bf16 v[168:171], v[128:131], v[36:39], v[168:171]
    ds_read_b128 v[108:111], v2 offset:21504
    s_waitcnt lgkmcnt(4)
    v_mfma_f32_16x16x32_bf16 v[152:155], v[132:135], v[32:35], v[152:155]
    v_mfma_f32_16x16x32_bf16 v[172:175], v[132:135], v[36:39], v[172:175]
    ds_read_b128 v[112:115], v2 offset:22528
    s_waitcnt lgkmcnt(4)
    v_mfma_f32_16x16x32_bf16 v[156:159], v[136:139], v[32:35], v[156:159]
    v_mfma_f32_16x16x32_bf16 v[176:179], v[136:139], v[36:39], v[176:179]
    ds_read_b128 v[116:119], v2 offset:23552
    s_waitcnt lgkmcnt(4)
    v_mfma_f32_16x16x32_bf16 v[160:163], v[140:143], v[32:35], v[160:163]
    v_mfma_f32_16x16x32_bf16 v[180:183], v[140:143], v[36:39], v[180:183]
    ds_read_b128 v[120:123], v2 offset:24576
    s_waitcnt vmcnt(15)
    s_waitcnt lgkmcnt(4)
    v_mfma_f32_16x16x32_bf16 v[144:147], v[104:107], v[40:43], v[144:147]
    v_mfma_f32_16x16x32_bf16 v[164:167], v[104:107], v[44:47], v[164:167]
    ds_read_b128 v[124:127], v2 offset:30720
    s_waitcnt lgkmcnt(4)
    v_mfma_f32_16x16x32_bf16 v[148:151], v[108:111], v[40:43], v[148:151]
    v_mfma_f32_16x16x32_bf16 v[168:171], v[108:111], v[44:47], v[168:171]
    ds_read_b128 v[128:131], v2 offset:31744
    s_waitcnt lgkmcnt(4)
    v_mfma_f32_16x16x32_bf16 v[152:155], v[112:115], v[40:43], v[152:155]
    v_mfma_f32_16x16x32_bf16 v[172:175], v[112:115], v[44:47], v[172:175]
    ds_read_b128 v[132:135], v2 offset:32768
    s_waitcnt lgkmcnt(4)
    v_mfma_f32_16x16x32_bf16 v[156:159], v[116:119], v[40:43], v[156:159]
    v_mfma_f32_16x16x32_bf16 v[176:179], v[116:119], v[44:47], v[176:179]
    ds_read_b128 v[136:139], v2 offset:33792
    s_waitcnt lgkmcnt(4)
    v_mfma_f32_16x16x32_bf16 v[160:163], v[120:123], v[40:43], v[160:163]
    v_mfma_f32_16x16x32_bf16 v[180:183], v[120:123], v[44:47], v[180:183]
    ds_read_b128 v[140:143], v2 offset:34816
    s_waitcnt vmcnt(13)
    s_waitcnt lgkmcnt(4)
    v_mfma_f32_16x16x32_bf16 v[144:147], v[124:127], v[48:51], v[144:147]
    v_mfma_f32_16x16x32_bf16 v[164:167], v[124:127], v[52:55], v[164:167]
    s_barrier
    ds_read_b128 v[104:107], v2 offset:40960
    s_waitcnt lgkmcnt(4)
    v_mfma_f32_16x16x32_bf16 v[148:151], v[128:131], v[48:51], v[148:151]
    v_mfma_f32_16x16x32_bf16 v[168:171], v[128:131], v[52:55], v[168:171]
    ds_read_b128 v[108:111], v2 offset:41984
    s_waitcnt lgkmcnt(4)
    v_mfma_f32_16x16x32_bf16 v[152:155], v[132:135], v[48:51], v[152:155]
    v_mfma_f32_16x16x32_bf16 v[172:175], v[132:135], v[52:55], v[172:175]
    ds_read_b128 v[112:115], v2 offset:43008
    s_waitcnt lgkmcnt(4)
    v_mfma_f32_16x16x32_bf16 v[156:159], v[136:139], v[48:51], v[156:159]
    v_mfma_f32_16x16x32_bf16 v[176:179], v[136:139], v[52:55], v[176:179]
    ds_read_b128 v[116:119], v2 offset:44032
    s_waitcnt lgkmcnt(4)
    v_mfma_f32_16x16x32_bf16 v[160:163], v[140:143], v[48:51], v[160:163]
    v_mfma_f32_16x16x32_bf16 v[180:183], v[140:143], v[52:55], v[180:183]
    ds_read_b128 v[120:123], v2 offset:45056
    s_waitcnt vmcnt(11)
    s_waitcnt lgkmcnt(4)
    v_mfma_f32_16x16x32_bf16 v[144:147], v[104:107], v[56:59], v[144:147]
    v_mfma_f32_16x16x32_bf16 v[164:167], v[104:107], v[60:63], v[164:167]
    ds_read_b128 v[124:127], v2 offset:51200
    s_waitcnt lgkmcnt(4)
    v_mfma_f32_16x16x32_bf16 v[148:151], v[108:111], v[56:59], v[148:151]
    v_mfma_f32_16x16x32_bf16 v[168:171], v[108:111], v[60:63], v[168:171]
    ds_read_b128 v[128:131], v2 offset:52224
    s_waitcnt lgkmcnt(4)
    v_mfma_f32_16x16x32_bf16 v[152:155], v[112:115], v[56:59], v[152:155]
    v_mfma_f32_16x16x32_bf16 v[172:175], v[112:115], v[60:63], v[172:175]
    ds_read_b128 v[132:135], v2 offset:53248
    s_waitcnt lgkmcnt(4)
    v_mfma_f32_16x16x32_bf16 v[156:159], v[116:119], v[56:59], v[156:159]
    v_mfma_f32_16x16x32_bf16 v[176:179], v[116:119], v[60:63], v[176:179]
    ds_read_b128 v[136:139], v2 offset:54272
    s_waitcnt lgkmcnt(4)
    v_mfma_f32_16x16x32_bf16 v[160:163], v[120:123], v[56:59], v[160:163]
    v_mfma_f32_16x16x32_bf16 v[180:183], v[120:123], v[60:63], v[180:183]
    ds_read_b128 v[140:143], v2 offset:55296
    s_waitcnt vmcnt(9)
    s_waitcnt lgkmcnt(4)
    v_mfma_f32_16x16x32_bf16 v[144:147], v[124:127], v[64:67], v[144:147]
    v_mfma_f32_16x16x32_bf16 v[164:167], v[124:127], v[68:71], v[164:167]
    s_barrier
    ds_read_b128 v[104:107], v2 offset:61440
    s_waitcnt lgkmcnt(4)
    v_mfma_f32_16x16x32_bf16 v[148:151], v[128:131], v[64:67], v[148:151]
    v_mfma_f32_16x16x32_bf16 v[168:171], v[128:131], v[68:71], v[168:171]
    ds_read_b128 v[108:111], v2 offset:62464
    s_waitcnt lgkmcnt(4)
    v_mfma_f32_16x16x32_bf16 v[152:155], v[132:135], v[64:67], v[152:155]
    v_mfma_f32_16x16x32_bf16 v[172:175], v[132:135], v[68:71], v[172:175]
    ds_read_b128 v[112:115], v2 offset:63488
    s_waitcnt lgkmcnt(4)
    v_mfma_f32_16x16x32_bf16 v[156:159], v[136:139], v[64:67], v[156:159]
    v_mfma_f32_16x16x32_bf16 v[176:179], v[136:139], v[68:71], v[176:179]
    ds_read_b128 v[116:119], v2 offset:64512
    s_waitcnt lgkmcnt(4)
    v_mfma_f32_16x16x32_bf16 v[160:163], v[140:143], v[64:67], v[160:163]
    v_mfma_f32_16x16x32_bf16 v[180:183], v[140:143], v[68:71], v[180:183]
    ds_read_b128 v[120:123], v3 offset:0
    s_waitcnt vmcnt(7)
    s_waitcnt lgkmcnt(4)
    v_mfma_f32_16x16x32_bf16 v[144:147], v[104:107], v[72:75], v[144:147]
    v_mfma_f32_16x16x32_bf16 v[164:167], v[104:107], v[76:79], v[164:167]
    ds_read_b128 v[124:127], v3 offset:6144
    s_waitcnt lgkmcnt(4)
    v_mfma_f32_16x16x32_bf16 v[148:151], v[108:111], v[72:75], v[148:151]
    v_mfma_f32_16x16x32_bf16 v[168:171], v[108:111], v[76:79], v[168:171]
    ds_read_b128 v[128:131], v3 offset:7168
    s_waitcnt lgkmcnt(4)
    v_mfma_f32_16x16x32_bf16 v[152:155], v[112:115], v[72:75], v[152:155]
    v_mfma_f32_16x16x32_bf16 v[172:175], v[112:115], v[76:79], v[172:175]
    ds_read_b128 v[132:135], v3 offset:8192
    s_waitcnt lgkmcnt(4)
    v_mfma_f32_16x16x32_bf16 v[156:159], v[116:119], v[72:75], v[156:159]
    v_mfma_f32_16x16x32_bf16 v[176:179], v[116:119], v[76:79], v[176:179]
    ds_read_b128 v[136:139], v3 offset:9216
    s_waitcnt lgkmcnt(4)
    v_mfma_f32_16x16x32_bf16 v[160:163], v[120:123], v[72:75], v[160:163]
    v_mfma_f32_16x16x32_bf16 v[180:183], v[120:123], v[76:79], v[180:183]
    ds_read_b128 v[140:143], v3 offset:10240
    s_waitcnt vmcnt(5)
    s_waitcnt lgkmcnt(4)
    v_mfma_f32_16x16x32_bf16 v[144:147], v[124:127], v[80:83], v[144:147]
    v_mfma_f32_16x16x32_bf16 v[164:167], v[124:127], v[84:87], v[164:167]
    s_barrier
    ds_read_b128 v[104:107], v3 offset:16384
    s_waitcnt lgkmcnt(4)
    v_mfma_f32_16x16x32_bf16 v[148:151], v[128:131], v[80:83], v[148:151]
    v_mfma_f32_16x16x32_bf16 v[168:171], v[128:131], v[84:87], v[168:171]
    ds_read_b128 v[108:111], v3 offset:17408
    s_waitcnt lgkmcnt(4)
    v_mfma_f32_16x16x32_bf16 v[152:155], v[132:135], v[80:83], v[152:155]
    v_mfma_f32_16x16x32_bf16 v[172:175], v[132:135], v[84:87], v[172:175]
    ds_read_b128 v[112:115], v3 offset:18432
    s_waitcnt lgkmcnt(4)
    v_mfma_f32_16x16x32_bf16 v[156:159], v[136:139], v[80:83], v[156:159]
    v_mfma_f32_16x16x32_bf16 v[176:179], v[136:139], v[84:87], v[176:179]
    ds_read_b128 v[116:119], v3 offset:19456
    s_waitcnt lgkmcnt(4)
    v_mfma_f32_16x16x32_bf16 v[160:163], v[140:143], v[80:83], v[160:163]
    v_mfma_f32_16x16x32_bf16 v[180:183], v[140:143], v[84:87], v[180:183]
    ds_read_b128 v[120:123], v3 offset:20480
    s_waitcnt vmcnt(3)
    s_waitcnt lgkmcnt(4)
    v_mfma_f32_16x16x32_bf16 v[144:147], v[104:107], v[88:91], v[144:147]
    v_mfma_f32_16x16x32_bf16 v[164:167], v[104:107], v[92:95], v[164:167]
    ds_read_b128 v[124:127], v3 offset:26624
    s_waitcnt lgkmcnt(4)
    v_mfma_f32_16x16x32_bf16 v[148:151], v[108:111], v[88:91], v[148:151]
    v_mfma_f32_16x16x32_bf16 v[168:171], v[108:111], v[92:95], v[168:171]
    ds_read_b128 v[128:131], v3 offset:27648
    s_waitcnt lgkmcnt(4)
    v_mfma_f32_16x16x32_bf16 v[152:155], v[112:115], v[88:91], v[152:155]
    v_mfma_f32_16x16x32_bf16 v[172:175], v[112:115], v[92:95], v[172:175]
    ds_read_b128 v[132:135], v3 offset:28672
    s_waitcnt lgkmcnt(4)
    v_mfma_f32_16x16x32_bf16 v[156:159], v[116:119], v[88:91], v[156:159]
    v_mfma_f32_16x16x32_bf16 v[176:179], v[116:119], v[92:95], v[176:179]
    ds_read_b128 v[136:139], v3 offset:29696
    s_waitcnt lgkmcnt(4)
    v_mfma_f32_16x16x32_bf16 v[160:163], v[120:123], v[88:91], v[160:163]
    v_mfma_f32_16x16x32_bf16 v[180:183], v[120:123], v[92:95], v[180:183]
    ds_read_b128 v[140:143], v3 offset:30720
    s_waitcnt vmcnt(1)
    s_waitcnt lgkmcnt(4)
    v_mfma_f32_16x16x32_bf16 v[144:147], v[124:127], v[96:99], v[144:147]
    v_mfma_f32_16x16x32_bf16 v[164:167], v[124:127], v[100:103], v[164:167]
    s_waitcnt lgkmcnt(3)
    v_mfma_f32_16x16x32_bf16 v[148:151], v[128:131], v[96:99], v[148:151]
    v_mfma_f32_16x16x32_bf16 v[168:171], v[128:131], v[100:103], v[168:171]
    s_waitcnt lgkmcnt(2)
    v_mfma_f32_16x16x32_bf16 v[152:155], v[132:135], v[96:99], v[152:155]
    v_mfma_f32_16x16x32_bf16 v[172:175], v[132:135], v[100:103], v[172:175]
    s_waitcnt lgkmcnt(1)
    v_mfma_f32_16x16x32_bf16 v[156:159], v[136:139], v[96:99], v[156:159]
    v_mfma_f32_16x16x32_bf16 v[176:179], v[136:139], v[100:103], v[176:179]
    s_waitcnt lgkmcnt(0)
    v_mfma_f32_16x16x32_bf16 v[160:163], v[140:143], v[96:99], v[160:163]
    v_mfma_f32_16x16x32_bf16 v[180:183], v[140:143], v[100:103], v[180:183]
    s_mul_i32 s20, s3, 5120
    s_xor_b32 s21, s3, 2
    s_mul_i32 s21, s21, 5120
    s_add_u32 s20, s20, 139264
    s_add_u32 s21, s21, 139264
    v_add_u32 v2, s20, v1
    v_add_u32 v3, s21, v1
    s_cmp_eq_u32 s5, 0
    s_cbranch_scc1 main_kernel_kh0_7
    ds_write_b128 v2, v[144:147] offset:0
    ds_write_b128 v2, v[148:151] offset:1024
    ds_write_b128 v2, v[152:155] offset:2048
    ds_write_b128 v2, v[156:159] offset:3072
    ds_write_b128 v2, v[160:163] offset:4096
    s_nop 0
    v_pk_mov_b32 v[144:145], v[164:165], v[164:165] op_sel:[0,1]
    v_pk_mov_b32 v[146:147], v[166:167], v[166:167] op_sel:[0,1]
    v_pk_mov_b32 v[148:149], v[168:169], v[168:169] op_sel:[0,1]
    v_pk_mov_b32 v[150:151], v[170:171], v[170:171] op_sel:[0,1]
    v_pk_mov_b32 v[152:153], v[172:173], v[172:173] op_sel:[0,1]
    v_pk_mov_b32 v[154:155], v[174:175], v[174:175] op_sel:[0,1]
    v_pk_mov_b32 v[156:157], v[176:177], v[176:177] op_sel:[0,1]
    v_pk_mov_b32 v[158:159], v[178:179], v[178:179] op_sel:[0,1]
    v_pk_mov_b32 v[160:161], v[180:181], v[180:181] op_sel:[0,1]
    v_pk_mov_b32 v[162:163], v[182:183], v[182:183] op_sel:[0,1]
    s_branch main_kernel_red_7
main_kernel_kh0_7:
    ds_write_b128 v2, v[164:167] offset:0
    ds_write_b128 v2, v[168:171] offset:1024
    ds_write_b128 v2, v[172:175] offset:2048
    ds_write_b128 v2, v[176:179] offset:3072
    ds_write_b128 v2, v[180:183] offset:4096
main_kernel_red_7:
    s_waitcnt lgkmcnt(0)
    s_barrier
    ds_read_b128 v[164:167], v3 offset:0
    ds_read_b128 v[168:171], v3 offset:1024
    ds_read_b128 v[172:175], v3 offset:2048
    ds_read_b128 v[176:179], v3 offset:3072
    ds_read_b128 v[180:183], v3 offset:4096
    v_lshlrev_b32 v24, 16, v184
    v_and_b32 v25, 0xffff0000, v184
    v_lshlrev_b32 v26, 16, v185
    v_and_b32 v27, 0xffff0000, v185
    v_pk_add_f32 v[144:145], v[24:25], v[144:145]
    v_pk_add_f32 v[146:147], v[26:27], v[146:147]
    v_lshlrev_b32 v28, 16, v186
    v_and_b32 v29, 0xffff0000, v186
    v_lshlrev_b32 v30, 16, v187
    v_and_b32 v31, 0xffff0000, v187
    v_pk_add_f32 v[148:149], v[28:29], v[148:149]
    v_pk_add_f32 v[150:151], v[30:31], v[150:151]
    v_lshlrev_b32 v32, 16, v188
    v_and_b32 v33, 0xffff0000, v188
    v_lshlrev_b32 v34, 16, v189
    v_and_b32 v35, 0xffff0000, v189
    v_pk_add_f32 v[152:153], v[32:33], v[152:153]
    v_pk_add_f32 v[154:155], v[34:35], v[154:155]
    v_lshlrev_b32 v36, 16, v190
    v_and_b32 v37, 0xffff0000, v190
    v_lshlrev_b32 v38, 16, v191
    v_and_b32 v39, 0xffff0000, v191
    v_pk_add_f32 v[156:157], v[36:37], v[156:157]
    v_pk_add_f32 v[158:159], v[38:39], v[158:159]
    v_lshlrev_b32 v40, 16, v192
    v_and_b32 v41, 0xffff0000, v192
    v_lshlrev_b32 v42, 16, v193
    v_and_b32 v43, 0xffff0000, v193
    v_pk_add_f32 v[160:161], v[40:41], v[160:161]
    v_pk_add_f32 v[162:163], v[42:43], v[162:163]
    s_add_u32 s25, s24, 8388608
    s_waitcnt lgkmcnt(4)
    v_pk_add_f32 v[144:145], v[144:145], v[164:165]
    v_pk_add_f32 v[146:147], v[146:147], v[166:167]
    v_cvt_pk_bf16_f32 v104, v144, v145
    v_cvt_pk_bf16_f32 v105, v146, v147
    s_waitcnt lgkmcnt(3)
    v_pk_add_f32 v[148:149], v[148:149], v[168:169]
    v_pk_add_f32 v[150:151], v[150:151], v[170:171]
    v_cvt_pk_bf16_f32 v106, v148, v149
    v_cvt_pk_bf16_f32 v107, v150, v151
    s_nop 1
    v_permlane16_swap_b32 v104, v106
    v_permlane16_swap_b32 v105, v107
    buffer_store_dwordx4 v[104:107], v9, s[8:11], s25 offen offset:0
    s_waitcnt lgkmcnt(2)
    v_pk_add_f32 v[152:153], v[152:153], v[172:173]
    v_pk_add_f32 v[154:155], v[154:155], v[174:175]
    v_cvt_pk_bf16_f32 v108, v152, v153
    v_cvt_pk_bf16_f32 v109, v154, v155
    s_waitcnt lgkmcnt(1)
    v_pk_add_f32 v[156:157], v[156:157], v[176:177]
    v_pk_add_f32 v[158:159], v[158:159], v[178:179]
    v_cvt_pk_bf16_f32 v110, v156, v157
    v_cvt_pk_bf16_f32 v111, v158, v159
    s_nop 1
    v_permlane16_swap_b32 v108, v110
    v_permlane16_swap_b32 v109, v111
    buffer_store_dwordx4 v[108:111], v9, s[8:11], s25 offen offset:1024
    s_waitcnt lgkmcnt(0)
    v_pk_add_f32 v[160:161], v[160:161], v[180:181]
    v_pk_add_f32 v[162:163], v[162:163], v[182:183]
    v_cvt_pk_bf16_f32 v112, v160, v161
    v_cvt_pk_bf16_f32 v113, v162, v163
    buffer_store_dwordx2 v[112:113], v8, s[8:11], s25 offen offset:2048
    v_pk_add_f32 v[10:11], v[144:145], v[146:147]
    v_pk_mul_f32 v[12:13], v[144:145], v[144:145]
    v_pk_fma_f32 v[12:13], v[146:147], v[146:147], v[12:13]
    v_pk_add_f32 v[10:11], v[10:11], v[148:149]
    v_pk_fma_f32 v[12:13], v[148:149], v[148:149], v[12:13]
    v_pk_add_f32 v[10:11], v[10:11], v[150:151]
    v_pk_fma_f32 v[12:13], v[150:151], v[150:151], v[12:13]
    v_pk_add_f32 v[10:11], v[10:11], v[152:153]
    v_pk_fma_f32 v[12:13], v[152:153], v[152:153], v[12:13]
    v_pk_add_f32 v[10:11], v[10:11], v[154:155]
    v_pk_fma_f32 v[12:13], v[154:155], v[154:155], v[12:13]
    v_pk_add_f32 v[10:11], v[10:11], v[156:157]
    v_pk_fma_f32 v[12:13], v[156:157], v[156:157], v[12:13]
    v_pk_add_f32 v[10:11], v[10:11], v[158:159]
    v_pk_fma_f32 v[12:13], v[158:159], v[158:159], v[12:13]
    v_pk_add_f32 v[10:11], v[10:11], v[160:161]
    v_pk_fma_f32 v[12:13], v[160:161], v[160:161], v[12:13]
    v_pk_add_f32 v[10:11], v[10:11], v[162:163]
    v_pk_fma_f32 v[12:13], v[162:163], v[162:163], v[12:13]
    v_add_f32 v10, v10, v11
    v_add_f32 v11, v12, v13
    v_mov_b32 v12, v10
    s_nop 1
    v_permlane32_swap_b32 v10, v12
    s_nop 1
    v_add_f32 v10, v10, v12
    v_mov_b32 v13, v11
    s_nop 1
    v_permlane32_swap_b32 v11, v13
    s_nop 1
    v_add_f32 v11, v11, v13
    v_mov_b32 v12, v10
    s_nop 1
    v_permlane16_swap_b32 v10, v12
    s_nop 1
    v_add_f32 v10, v10, v12
    v_mov_b32 v13, v11
    s_nop 1
    v_permlane16_swap_b32 v11, v13
    s_nop 1
    v_add_f32 v11, v11, v13
    s_lshl_b32 s24, s4, 10
    s_lshl_b32 s25, s51, 3
    s_add_u32 s24, s24, s25
    s_add_u32 s24, s24, 47185920
    v_lshlrev_b32 v12, 6, v6
    s_mov_b64 exec, 0xffff
    buffer_store_dwordx2 v[10:11], v12, s[8:11], s24 offen
    s_mov_b64 exec, -1
    s_waitcnt vmcnt(0)
    s_barrier
    s_cmp_lg_u32 s3, 0
    s_cbranch_scc1 main_kernel_sig14
    s_add_u32 s44, s52, 48349184
    v_mov_b32 v246, 1
    s_mov_b64 exec, 1
    s_cmp_lg_u32 s84, 0
    s_cbranch_scc1 main_kernel_sig14s
    buffer_store_dword v246, off, s[8:11], s44
    s_branch main_kernel_sig14e
main_kernel_sig14s:
    buffer_wbl2 sc1
    s_waitcnt vmcnt(0)
    buffer_store_dword v246, off, s[8:11], s44 sc1
main_kernel_sig14e:
    s_mov_b64 exec, -1
main_kernel_sig14:
    v_lshlrev_b32 v1, 4, v0
    v_and_b32 v6, 15, v0
    v_bfe_u32 v7, v0, 4, 1
    v_lshrrev_b32 v8, 5, v0
    v_lshlrev_b32 v6, 4, v6
    v_lshl_add_u32 v6, v8, 8, v6
    s_and_b32 s7, s3, 1
    s_lshr_b32 s5, s3, 1
    s_lshl_b32 s4, s53, 2
    s_lshl_b32 s20, s7, 1
    s_add_u32 s4, s4, s20
    s_mul_i32 s20, s5, 3072
    v_add_u32 v2, s20, v1
    v_add_u32 v3, 0x10000, v2
    s_lshl_b32 s21, s7, 12
    s_add_u32 s21, s21, 98304
    v_add_u32 v18, s21, v1
    v_mul_u32_u24 v5, 49152, v7
    v_add_u32 v5, v5, v6
    v_and_b32 v9, 31, v0
    v_lshlrev_b32 v9, 6, v9
    v_lshl_add_u32 v9, v8, 5, v9
    s_lshl_b32 s24, s4, 11
    s_add_u32 s24, s24, 47185920
    s_lshl_b32 s26, s53, 8
    s_cmp_lg_u32 s3, 0
    s_cbranch_scc1 main_kernel_poll15p
    v_lshlrev_b32 v250, 2, v0
    s_mov_b32 s45, 0x200000
    s_add_u32 s44, s26, 48349184
    s_mov_b64 exec, 65535
main_kernel_poll15_0:
    buffer_load_dword v246, v250, s[8:11], s44 offen sc1
    s_waitcnt vmcnt(0)
    v_cmp_ne_u32 vcc, 1, v246
    s_sub_u32 s45, s45, 1
    s_cbranch_scc1 main_kernel_poll15d
    s_cmp_eq_u64 vcc, 0
    s_cbranch_scc0 main_kernel_poll15_0
    s_mov_b64 exec, -1
main_kernel_poll15d:
    s_mov_b64 exec, -1
    s_cmp_eq_u32 s84, 0
    s_cbranch_scc1 main_kernel_poll15p
    buffer_inv sc1
    s_waitcnt vmcnt(0)
main_kernel_poll15p:
    s_barrier
    buffer_load_dwordx4 v[24:27], v9, s[8:11], s24 offen offset:0 sc1
    buffer_load_dwordx4 v[28:31], v9, s[8:11], s24 offen offset:16 sc1
    buffer_load_dwordx4 v[32:35], v9, s[8:11], s24 offen offset:2048 sc1
    buffer_load_dwordx4 v[36:39], v9, s[8:11], s24 offen offset:2064 sc1
    s_mul_i32 s24, s4, 98304
    s_mul_i32 s25, s54, 3072
    s_add_u32 s24, s24, s25
    s_mul_i32 s25, s5, 1536
    s_add_u32 s24, s24, s25
    s_add_u32 s24, s24, 33554432
    s_add_u32 s25, s24, 98304
    s_barrier
    ds_read_b128 v[148:151], v18 offset:0
    ds_read_b128 v[152:155], v18 offset:2048
    ds_read_b128 v[136:139], v2 offset:0
    ds_read_b128 v[140:143], v2 offset:1024
    ds_read_b128 v[144:147], v2 offset:2048
    s_waitcnt lgkmcnt(2)
    v_mfma_f32_32x32x16_bf16 v[40:55], v[136:139], v[148:151], 0
    ds_read_b128 v[172:175], v18 offset:1024
    v_mfma_f32_32x32x16_bf16 v[88:103], v[136:139], v[152:155], 0
    ds_read_b128 v[176:179], v18 offset:3072
    s_waitcnt lgkmcnt(3)
    v_mfma_f32_32x32x16_bf16 v[56:71], v[140:143], v[148:151], 0
    ds_read_b128 v[160:163], v2 offset:6144
    v_mfma_f32_32x32x16_bf16 v[104:119], v[140:143], v[152:155], 0
    ds_read_b128 v[164:167], v2 offset:7168
    s_waitcnt lgkmcnt(4)
    v_mfma_f32_32x32x16_bf16 v[72:87], v[144:147], v[148:151], 0
    ds_read_b128 v[168:171], v2 offset:8192
    v_mfma_f32_32x32x16_bf16 v[120:135], v[144:147], v[152:155], 0
    s_waitcnt lgkmcnt(2)
    v_mfma_f32_32x32x16_bf16 v[40:55], v[160:163], v[172:175], v[40:55]
    s_barrier
    ds_read_b128 v[148:151], v18 offset:8192
    v_mfma_f32_32x32x16_bf16 v[88:103], v[160:163], v[176:179], v[88:103]
    ds_read_b128 v[152:155], v18 offset:10240
    s_waitcnt lgkmcnt(3)
    v_mfma_f32_32x32x16_bf16 v[56:71], v[164:167], v[172:175], v[56:71]
    ds_read_b128 v[136:139], v2 offset:12288
    v_mfma_f32_32x32x16_bf16 v[104:119], v[164:167], v[176:179], v[104:119]
    ds_read_b128 v[140:143], v2 offset:13312
    s_waitcnt lgkmcnt(4)
    v_mfma_f32_32x32x16_bf16 v[72:87], v[168:171], v[172:175], v[72:87]
    ds_read_b128 v[144:147], v2 offset:14336
    v_mfma_f32_32x32x16_bf16 v[120:135], v[168:171], v[176:179], v[120:135]
    s_waitcnt lgkmcnt(2)
    v_mfma_f32_32x32x16_bf16 v[40:55], v[136:139], v[148:151], v[40:55]
    ds_read_b128 v[172:175], v18 offset:9216
    v_mfma_f32_32x32x16_bf16 v[88:103], v[136:139], v[152:155], v[88:103]
    ds_read_b128 v[176:179], v18 offset:11264
    s_waitcnt lgkmcnt(3)
    v_mfma_f32_32x32x16_bf16 v[56:71], v[140:143], v[148:151], v[56:71]
    ds_read_b128 v[160:163], v2 offset:18432
    v_mfma_f32_32x32x16_bf16 v[104:119], v[140:143], v[152:155], v[104:119]
    ds_read_b128 v[164:167], v2 offset:19456
    s_waitcnt lgkmcnt(4)
    v_mfma_f32_32x32x16_bf16 v[72:87], v[144:147], v[148:151], v[72:87]
    ds_read_b128 v[168:171], v2 offset:20480
    v_mfma_f32_32x32x16_bf16 v[120:135], v[144:147], v[152:155], v[120:135]
    s_waitcnt lgkmcnt(2)
    v_mfma_f32_32x32x16_bf16 v[40:55], v[160:163], v[172:175], v[40:55]
    s_barrier
    ds_read_b128 v[148:151], v18 offset:16384
    v_mfma_f32_32x32x16_bf16 v[88:103], v[160:163], v[176:179], v[88:103]
    ds_read_b128 v[152:155], v18 offset:18432
    s_waitcnt lgkmcnt(3)
    v_mfma_f32_32x32x16_bf16 v[56:71], v[164:167], v[172:175], v[56:71]
    ds_read_b128 v[136:139], v2 offset:24576
    v_mfma_f32_32x32x16_bf16 v[104:119], v[164:167], v[176:179], v[104:119]
    ds_read_b128 v[140:143], v2 offset:25600
    s_waitcnt lgkmcnt(4)
    v_mfma_f32_32x32x16_bf16 v[72:87], v[168:171], v[172:175], v[72:87]
    ds_read_b128 v[144:147], v2 offset:26624
    v_mfma_f32_32x32x16_bf16 v[120:135], v[168:171], v[176:179], v[120:135]
    s_waitcnt lgkmcnt(2)
    v_mfma_f32_32x32x16_bf16 v[40:55], v[136:139], v[148:151], v[40:55]
    ds_read_b128 v[172:175], v18 offset:17408
    v_mfma_f32_32x32x16_bf16 v[88:103], v[136:139], v[152:155], v[88:103]
    ds_read_b128 v[176:179], v18 offset:19456
    s_waitcnt lgkmcnt(3)
    v_mfma_f32_32x32x16_bf16 v[56:71], v[140:143], v[148:151], v[56:71]
    ds_read_b128 v[160:163], v2 offset:30720
    v_mfma_f32_32x32x16_bf16 v[104:119], v[140:143], v[152:155], v[104:119]
    ds_read_b128 v[164:167], v2 offset:31744
    s_waitcnt lgkmcnt(4)
    v_mfma_f32_32x32x16_bf16 v[72:87], v[144:147], v[148:151], v[72:87]
    ds_read_b128 v[168:171], v2 offset:32768
    v_mfma_f32_32x32x16_bf16 v[120:135], v[144:147], v[152:155], v[120:135]
    s_waitcnt lgkmcnt(2)
    v_mfma_f32_32x32x16_bf16 v[40:55], v[160:163], v[172:175], v[40:55]
    s_barrier
    ds_read_b128 v[148:151], v18 offset:24576
    v_mfma_f32_32x32x16_bf16 v[88:103], v[160:163], v[176:179], v[88:103]
    ds_read_b128 v[152:155], v18 offset:26624
    s_waitcnt lgkmcnt(3)
    v_mfma_f32_32x32x16_bf16 v[56:71], v[164:167], v[172:175], v[56:71]
    ds_read_b128 v[136:139], v2 offset:36864
    v_mfma_f32_32x32x16_bf16 v[104:119], v[164:167], v[176:179], v[104:119]
    ds_read_b128 v[140:143], v2 offset:37888
    s_waitcnt lgkmcnt(4)
    v_mfma_f32_32x32x16_bf16 v[72:87], v[168:171], v[172:175], v[72:87]
    ds_read_b128 v[144:147], v2 offset:38912
    v_mfma_f32_32x32x16_bf16 v[120:135], v[168:171], v[176:179], v[120:135]
    s_waitcnt lgkmcnt(2)
    v_mfma_f32_32x32x16_bf16 v[40:55], v[136:139], v[148:151], v[40:55]
    ds_read_b128 v[172:175], v18 offset:25600
    v_mfma_f32_32x32x16_bf16 v[88:103], v[136:139], v[152:155], v[88:103]
    ds_read_b128 v[176:179], v18 offset:27648
    s_waitcnt lgkmcnt(3)
    v_mfma_f32_32x32x16_bf16 v[56:71], v[140:143], v[148:151], v[56:71]
    ds_read_b128 v[160:163], v2 offset:43008
    v_mfma_f32_32x32x16_bf16 v[104:119], v[140:143], v[152:155], v[104:119]
    ds_read_b128 v[164:167], v2 offset:44032
    s_waitcnt lgkmcnt(4)
    v_mfma_f32_32x32x16_bf16 v[72:87], v[144:147], v[148:151], v[72:87]
    ds_read_b128 v[168:171], v2 offset:45056
    v_mfma_f32_32x32x16_bf16 v[120:135], v[144:147], v[152:155], v[120:135]
    s_waitcnt lgkmcnt(2)
    v_mfma_f32_32x32x16_bf16 v[40:55], v[160:163], v[172:175], v[40:55]
    s_barrier
    ds_read_b128 v[148:151], v18 offset:32768
    v_mfma_f32_32x32x16_bf16 v[88:103], v[160:163], v[176:179], v[88:103]
    ds_read_b128 v[152:155], v18 offset:34816
    s_waitcnt lgkmcnt(3)
    v_mfma_f32_32x32x16_bf16 v[56:71], v[164:167], v[172:175], v[56:71]
    ds_read_b128 v[136:139], v2 offset:49152
    v_mfma_f32_32x32x16_bf16 v[104:119], v[164:167], v[176:179], v[104:119]
    ds_read_b128 v[140:143], v2 offset:50176
    s_waitcnt lgkmcnt(4)
    v_mfma_f32_32x32x16_bf16 v[72:87], v[168:171], v[172:175], v[72:87]
    ds_read_b128 v[144:147], v2 offset:51200
    v_mfma_f32_32x32x16_bf16 v[120:135], v[168:171], v[176:179], v[120:135]
    s_waitcnt lgkmcnt(2)
    v_mfma_f32_32x32x16_bf16 v[40:55], v[136:139], v[148:151], v[40:55]
    ds_read_b128 v[172:175], v18 offset:33792
    v_mfma_f32_32x32x16_bf16 v[88:103], v[136:139], v[152:155], v[88:103]
    ds_read_b128 v[176:179], v18 offset:35840
    s_waitcnt lgkmcnt(3)
    v_mfma_f32_32x32x16_bf16 v[56:71], v[140:143], v[148:151], v[56:71]
    ds_read_b128 v[160:163], v2 offset:55296
    v_mfma_f32_32x32x16_bf16 v[104:119], v[140:143], v[152:155], v[104:119]
    ds_read_b128 v[164:167], v2 offset:56320
    s_waitcnt lgkmcnt(4)
    v_mfma_f32_32x32x16_bf16 v[72:87], v[144:147], v[148:151], v[72:87]
    ds_read_b128 v[168:171], v2 offset:57344
    v_mfma_f32_32x32x16_bf16 v[120:135], v[144:147], v[152:155], v[120:135]
    s_waitcnt lgkmcnt(2)
    v_mfma_f32_32x32x16_bf16 v[40:55], v[160:163], v[172:175], v[40:55]
    s_barrier
    ds_read_b128 v[148:151], v18 offset:40960
    v_mfma_f32_32x32x16_bf16 v[88:103], v[160:163], v[176:179], v[88:103]
    ds_read_b128 v[152:155], v18 offset:43008
    s_waitcnt lgkmcnt(3)
    v_mfma_f32_32x32x16_bf16 v[56:71], v[164:167], v[172:175], v[56:71]
    ds_read_b128 v[136:139], v2 offset:61440
    v_mfma_f32_32x32x16_bf16 v[104:119], v[164:167], v[176:179], v[104:119]
    ds_read_b128 v[140:143], v2 offset:62464
    s_waitcnt lgkmcnt(4)
    v_mfma_f32_32x32x16_bf16 v[72:87], v[168:171], v[172:175], v[72:87]
    ds_read_b128 v[144:147], v2 offset:63488
    v_mfma_f32_32x32x16_bf16 v[120:135], v[168:171], v[176:179], v[120:135]
    s_waitcnt lgkmcnt(2)
    v_mfma_f32_32x32x16_bf16 v[40:55], v[136:139], v[148:151], v[40:55]
    ds_read_b128 v[172:175], v18 offset:41984
    v_mfma_f32_32x32x16_bf16 v[88:103], v[136:139], v[152:155], v[88:103]
    ds_read_b128 v[176:179], v18 offset:44032
    s_waitcnt lgkmcnt(3)
    v_mfma_f32_32x32x16_bf16 v[56:71], v[140:143], v[148:151], v[56:71]
    ds_read_b128 v[160:163], v3 offset:2048
    v_mfma_f32_32x32x16_bf16 v[104:119], v[140:143], v[152:155], v[104:119]
    ds_read_b128 v[164:167], v3 offset:3072
    s_waitcnt lgkmcnt(4)
    v_mfma_f32_32x32x16_bf16 v[72:87], v[144:147], v[148:151], v[72:87]
    ds_read_b128 v[168:171], v3 offset:4096
    v_mfma_f32_32x32x16_bf16 v[120:135], v[144:147], v[152:155], v[120:135]
    s_waitcnt lgkmcnt(2)
    v_mfma_f32_32x32x16_bf16 v[40:55], v[160:163], v[172:175], v[40:55]
    s_barrier
    ds_read_b128 v[148:151], v18 offset:49152
    v_mfma_f32_32x32x16_bf16 v[88:103], v[160:163], v[176:179], v[88:103]
    ds_read_b128 v[152:155], v18 offset:51200
    s_waitcnt lgkmcnt(3)
    v_mfma_f32_32x32x16_bf16 v[56:71], v[164:167], v[172:175], v[56:71]
    ds_read_b128 v[136:139], v3 offset:8192
    v_mfma_f32_32x32x16_bf16 v[104:119], v[164:167], v[176:179], v[104:119]
    ds_read_b128 v[140:143], v3 offset:9216
    s_waitcnt lgkmcnt(4)
    v_mfma_f32_32x32x16_bf16 v[72:87], v[168:171], v[172:175], v[72:87]
    ds_read_b128 v[144:147], v3 offset:10240
    v_mfma_f32_32x32x16_bf16 v[120:135], v[168:171], v[176:179], v[120:135]
    s_waitcnt lgkmcnt(2)
    v_mfma_f32_32x32x16_bf16 v[40:55], v[136:139], v[148:151], v[40:55]
    ds_read_b128 v[172:175], v18 offset:50176
    v_mfma_f32_32x32x16_bf16 v[88:103], v[136:139], v[152:155], v[88:103]
    ds_read_b128 v[176:179], v18 offset:52224
    s_waitcnt lgkmcnt(3)
    v_mfma_f32_32x32x16_bf16 v[56:71], v[140:143], v[148:151], v[56:71]
    ds_read_b128 v[160:163], v3 offset:14336
    v_mfma_f32_32x32x16_bf16 v[104:119], v[140:143], v[152:155], v[104:119]
    ds_read_b128 v[164:167], v3 offset:15360
    s_waitcnt lgkmcnt(4)
    v_mfma_f32_32x32x16_bf16 v[72:87], v[144:147], v[148:151], v[72:87]
    ds_read_b128 v[168:171], v3 offset:16384
    v_mfma_f32_32x32x16_bf16 v[120:135], v[144:147], v[152:155], v[120:135]
    s_waitcnt lgkmcnt(2)
    v_mfma_f32_32x32x16_bf16 v[40:55], v[160:163], v[172:175], v[40:55]
    s_barrier
    ds_read_b128 v[148:151], v18 offset:57344
    v_mfma_f32_32x32x16_bf16 v[88:103], v[160:163], v[176:179], v[88:103]
    ds_read_b128 v[152:155], v18 offset:59392
    s_waitcnt lgkmcnt(3)
    v_mfma_f32_32x32x16_bf16 v[56:71], v[164:167], v[172:175], v[56:71]
    ds_read_b128 v[136:139], v3 offset:20480
    v_mfma_f32_32x32x16_bf16 v[104:119], v[164:167], v[176:179], v[104:119]
    ds_read_b128 v[140:143], v3 offset:21504
    s_waitcnt lgkmcnt(4)
    v_mfma_f32_32x32x16_bf16 v[72:87], v[168:171], v[172:175], v[72:87]
    ds_read_b128 v[144:147], v3 offset:22528
    v_mfma_f32_32x32x16_bf16 v[120:135], v[168:171], v[176:179], v[120:135]
    s_waitcnt lgkmcnt(2)
    v_mfma_f32_32x32x16_bf16 v[40:55], v[136:139], v[148:151], v[40:55]
    ds_read_b128 v[172:175], v18 offset:58368
    v_mfma_f32_32x32x16_bf16 v[88:103], v[136:139], v[152:155], v[88:103]
    ds_read_b128 v[176:179], v18 offset:60416
    s_waitcnt lgkmcnt(3)
    v_mfma_f32_32x32x16_bf16 v[56:71], v[140:143], v[148:151], v[56:71]
    ds_read_b128 v[160:163], v3 offset:26624
    v_mfma_f32_32x32x16_bf16 v[104:119], v[140:143], v[152:155], v[104:119]
    ds_read_b128 v[164:167], v3 offset:27648
    s_waitcnt lgkmcnt(4)
    v_mfma_f32_32x32x16_bf16 v[72:87], v[144:147], v[148:151], v[72:87]
    ds_read_b128 v[168:171], v3 offset:28672
    v_mfma_f32_32x32x16_bf16 v[120:135], v[144:147], v[152:155], v[120:135]
    s_waitcnt lgkmcnt(2)
    v_mfma_f32_32x32x16_bf16 v[40:55], v[160:163], v[172:175], v[40:55]
    s_barrier
    ds_read_b128 v[148:151], v18 offset:0
    v_mfma_f32_32x32x16_bf16 v[88:103], v[160:163], v[176:179], v[88:103]
    ds_read_b128 v[152:155], v18 offset:2048
    s_waitcnt lgkmcnt(3)
    v_mfma_f32_32x32x16_bf16 v[56:71], v[164:167], v[172:175], v[56:71]
    ds_read_b128 v[136:139], v2 offset:0
    v_mfma_f32_32x32x16_bf16 v[104:119], v[164:167], v[176:179], v[104:119]
    ds_read_b128 v[140:143], v2 offset:1024
    s_waitcnt lgkmcnt(4)
    v_mfma_f32_32x32x16_bf16 v[72:87], v[168:171], v[172:175], v[72:87]
    ds_read_b128 v[144:147], v2 offset:2048
    v_mfma_f32_32x32x16_bf16 v[120:135], v[168:171], v[176:179], v[120:135]
    s_waitcnt lgkmcnt(2)
    v_mfma_f32_32x32x16_bf16 v[40:55], v[136:139], v[148:151], v[40:55]
    ds_read_b128 v[172:175], v18 offset:1024
    v_mfma_f32_32x32x16_bf16 v[88:103], v[136:139], v[152:155], v[88:103]
    ds_read_b128 v[176:179], v18 offset:3072
    s_waitcnt lgkmcnt(3)
    v_mfma_f32_32x32x16_bf16 v[56:71], v[140:143], v[148:151], v[56:71]
    ds_read_b128 v[160:163], v2 offset:6144
    v_mfma_f32_32x32x16_bf16 v[104:119], v[140:143], v[152:155], v[104:119]
    ds_read_b128 v[164:167], v2 offset:7168
    s_waitcnt lgkmcnt(4)
    v_mfma_f32_32x32x16_bf16 v[72:87], v[144:147], v[148:151], v[72:87]
    ds_read_b128 v[168:171], v2 offset:8192
    v_mfma_f32_32x32x16_bf16 v[120:135], v[144:147], v[152:155], v[120:135]
    s_waitcnt lgkmcnt(2)
    v_mfma_f32_32x32x16_bf16 v[40:55], v[160:163], v[172:175], v[40:55]
    s_barrier
    ds_read_b128 v[148:151], v18 offset:8192
    v_mfma_f32_32x32x16_bf16 v[88:103], v[160:163], v[176:179], v[88:103]
    ds_read_b128 v[152:155], v18 offset:10240
    s_waitcnt lgkmcnt(3)
    v_mfma_f32_32x32x16_bf16 v[56:71], v[164:167], v[172:175], v[56:71]
    ds_read_b128 v[136:139], v2 offset:12288
    v_mfma_f32_32x32x16_bf16 v[104:119], v[164:167], v[176:179], v[104:119]
    ds_read_b128 v[140:143], v2 offset:13312
    s_waitcnt lgkmcnt(4)
    v_mfma_f32_32x32x16_bf16 v[72:87], v[168:171], v[172:175], v[72:87]
    ds_read_b128 v[144:147], v2 offset:14336
    v_mfma_f32_32x32x16_bf16 v[120:135], v[168:171], v[176:179], v[120:135]
    s_waitcnt lgkmcnt(2)
    v_mfma_f32_32x32x16_bf16 v[40:55], v[136:139], v[148:151], v[40:55]
    ds_read_b128 v[172:175], v18 offset:9216
    v_mfma_f32_32x32x16_bf16 v[88:103], v[136:139], v[152:155], v[88:103]
    ds_read_b128 v[176:179], v18 offset:11264
    s_waitcnt lgkmcnt(3)
    v_mfma_f32_32x32x16_bf16 v[56:71], v[140:143], v[148:151], v[56:71]
    ds_read_b128 v[160:163], v2 offset:18432
    v_mfma_f32_32x32x16_bf16 v[104:119], v[140:143], v[152:155], v[104:119]
    ds_read_b128 v[164:167], v2 offset:19456
    s_waitcnt lgkmcnt(4)
    v_mfma_f32_32x32x16_bf16 v[72:87], v[144:147], v[148:151], v[72:87]
    ds_read_b128 v[168:171], v2 offset:20480
    v_mfma_f32_32x32x16_bf16 v[120:135], v[144:147], v[152:155], v[120:135]
    s_waitcnt lgkmcnt(2)
    v_mfma_f32_32x32x16_bf16 v[40:55], v[160:163], v[172:175], v[40:55]
    s_barrier
    ds_read_b128 v[148:151], v18 offset:16384
    v_mfma_f32_32x32x16_bf16 v[88:103], v[160:163], v[176:179], v[88:103]
    ds_read_b128 v[152:155], v18 offset:18432
    s_waitcnt lgkmcnt(3)
    v_mfma_f32_32x32x16_bf16 v[56:71], v[164:167], v[172:175], v[56:71]
    ds_read_b128 v[136:139], v2 offset:24576
    v_mfma_f32_32x32x16_bf16 v[104:119], v[164:167], v[176:179], v[104:119]
    ds_read_b128 v[140:143], v2 offset:25600
    s_waitcnt lgkmcnt(4)
    v_mfma_f32_32x32x16_bf16 v[72:87], v[168:171], v[172:175], v[72:87]
    ds_read_b128 v[144:147], v2 offset:26624
    v_mfma_f32_32x32x16_bf16 v[120:135], v[168:171], v[176:179], v[120:135]
    s_waitcnt lgkmcnt(2)
    v_mfma_f32_32x32x16_bf16 v[40:55], v[136:139], v[148:151], v[40:55]
    ds_read_b128 v[172:175], v18 offset:17408
    v_mfma_f32_32x32x16_bf16 v[88:103], v[136:139], v[152:155], v[88:103]
    ds_read_b128 v[176:179], v18 offset:19456
    s_waitcnt lgkmcnt(3)
    v_mfma_f32_32x32x16_bf16 v[56:71], v[140:143], v[148:151], v[56:71]
    ds_read_b128 v[160:163], v2 offset:30720
    v_mfma_f32_32x32x16_bf16 v[104:119], v[140:143], v[152:155], v[104:119]
    ds_read_b128 v[164:167], v2 offset:31744
    s_waitcnt lgkmcnt(4)
    v_mfma_f32_32x32x16_bf16 v[72:87], v[144:147], v[148:151], v[72:87]
    ds_read_b128 v[168:171], v2 offset:32768
    v_mfma_f32_32x32x16_bf16 v[120:135], v[144:147], v[152:155], v[120:135]
    s_waitcnt lgkmcnt(2)
    v_mfma_f32_32x32x16_bf16 v[40:55], v[160:163], v[172:175], v[40:55]
    s_barrier
    ds_read_b128 v[148:151], v18 offset:24576
    v_mfma_f32_32x32x16_bf16 v[88:103], v[160:163], v[176:179], v[88:103]
    ds_read_b128 v[152:155], v18 offset:26624
    s_waitcnt lgkmcnt(3)
    v_mfma_f32_32x32x16_bf16 v[56:71], v[164:167], v[172:175], v[56:71]
    ds_read_b128 v[136:139], v2 offset:36864
    v_mfma_f32_32x32x16_bf16 v[104:119], v[164:167], v[176:179], v[104:119]
    ds_read_b128 v[140:143], v2 offset:37888
    s_waitcnt lgkmcnt(4)
    v_mfma_f32_32x32x16_bf16 v[72:87], v[168:171], v[172:175], v[72:87]
    ds_read_b128 v[144:147], v2 offset:38912
    v_mfma_f32_32x32x16_bf16 v[120:135], v[168:171], v[176:179], v[120:135]
    s_waitcnt lgkmcnt(2)
    v_mfma_f32_32x32x16_bf16 v[40:55], v[136:139], v[148:151], v[40:55]
    ds_read_b128 v[172:175], v18 offset:25600
    v_mfma_f32_32x32x16_bf16 v[88:103], v[136:139], v[152:155], v[88:103]
    ds_read_b128 v[176:179], v18 offset:27648
    s_waitcnt lgkmcnt(3)
    v_mfma_f32_32x32x16_bf16 v[56:71], v[140:143], v[148:151], v[56:71]
    ds_read_b128 v[160:163], v2 offset:43008
    v_mfma_f32_32x32x16_bf16 v[104:119], v[140:143], v[152:155], v[104:119]
    ds_read_b128 v[164:167], v2 offset:44032
    s_waitcnt lgkmcnt(4)
    v_mfma_f32_32x32x16_bf16 v[72:87], v[144:147], v[148:151], v[72:87]
    ds_read_b128 v[168:171], v2 offset:45056
    v_mfma_f32_32x32x16_bf16 v[120:135], v[144:147], v[152:155], v[120:135]
    s_waitcnt lgkmcnt(2)
    v_mfma_f32_32x32x16_bf16 v[40:55], v[160:163], v[172:175], v[40:55]
    s_barrier
    ds_read_b128 v[148:151], v18 offset:32768
    v_mfma_f32_32x32x16_bf16 v[88:103], v[160:163], v[176:179], v[88:103]
    ds_read_b128 v[152:155], v18 offset:34816
    s_waitcnt lgkmcnt(3)
    v_mfma_f32_32x32x16_bf16 v[56:71], v[164:167], v[172:175], v[56:71]
    ds_read_b128 v[136:139], v2 offset:49152
    v_mfma_f32_32x32x16_bf16 v[104:119], v[164:167], v[176:179], v[104:119]
    ds_read_b128 v[140:143], v2 offset:50176
    s_waitcnt lgkmcnt(4)
    v_mfma_f32_32x32x16_bf16 v[72:87], v[168:171], v[172:175], v[72:87]
    ds_read_b128 v[144:147], v2 offset:51200
    v_mfma_f32_32x32x16_bf16 v[120:135], v[168:171], v[176:179], v[120:135]
    s_waitcnt lgkmcnt(2)
    v_mfma_f32_32x32x16_bf16 v[40:55], v[136:139], v[148:151], v[40:55]
    ds_read_b128 v[172:175], v18 offset:33792
    v_mfma_f32_32x32x16_bf16 v[88:103], v[136:139], v[152:155], v[88:103]
    ds_read_b128 v[176:179], v18 offset:35840
    s_waitcnt lgkmcnt(3)
    v_mfma_f32_32x32x16_bf16 v[56:71], v[140:143], v[148:151], v[56:71]
    ds_read_b128 v[160:163], v2 offset:55296
    v_mfma_f32_32x32x16_bf16 v[104:119], v[140:143], v[152:155], v[104:119]
    ds_read_b128 v[164:167], v2 offset:56320
    s_waitcnt lgkmcnt(4)
    v_mfma_f32_32x32x16_bf16 v[72:87], v[144:147], v[148:151], v[72:87]
    ds_read_b128 v[168:171], v2 offset:57344
    v_mfma_f32_32x32x16_bf16 v[120:135], v[144:147], v[152:155], v[120:135]
    s_waitcnt lgkmcnt(2)
    v_mfma_f32_32x32x16_bf16 v[40:55], v[160:163], v[172:175], v[40:55]
    s_barrier
    ds_read_b128 v[148:151], v18 offset:40960
    v_mfma_f32_32x32x16_bf16 v[88:103], v[160:163], v[176:179], v[88:103]
    ds_read_b128 v[152:155], v18 offset:43008
    s_waitcnt lgkmcnt(3)
    v_mfma_f32_32x32x16_bf16 v[56:71], v[164:167], v[172:175], v[56:71]
    ds_read_b128 v[136:139], v2 offset:61440
    v_mfma_f32_32x32x16_bf16 v[104:119], v[164:167], v[176:179], v[104:119]
    ds_read_b128 v[140:143], v2 offset:62464
    s_waitcnt lgkmcnt(4)
    v_mfma_f32_32x32x16_bf16 v[72:87], v[168:171], v[172:175], v[72:87]
    ds_read_b128 v[144:147], v2 offset:63488
    v_mfma_f32_32x32x16_bf16 v[120:135], v[168:171], v[176:179], v[120:135]
    s_waitcnt lgkmcnt(2)
    v_mfma_f32_32x32x16_bf16 v[40:55], v[136:139], v[148:151], v[40:55]
    ds_read_b128 v[172:175], v18 offset:41984
    v_mfma_f32_32x32x16_bf16 v[88:103], v[136:139], v[152:155], v[88:103]
    ds_read_b128 v[176:179], v18 offset:44032
    s_waitcnt lgkmcnt(3)
    v_mfma_f32_32x32x16_bf16 v[56:71], v[140:143], v[148:151], v[56:71]
    ds_read_b128 v[160:163], v3 offset:2048
    v_mfma_f32_32x32x16_bf16 v[104:119], v[140:143], v[152:155], v[104:119]
    ds_read_b128 v[164:167], v3 offset:3072
    s_waitcnt lgkmcnt(4)
    v_mfma_f32_32x32x16_bf16 v[72:87], v[144:147], v[148:151], v[72:87]
    ds_read_b128 v[168:171], v3 offset:4096
    v_mfma_f32_32x32x16_bf16 v[120:135], v[144:147], v[152:155], v[120:135]
    s_waitcnt lgkmcnt(2)
    v_mfma_f32_32x32x16_bf16 v[40:55], v[160:163], v[172:175], v[40:55]
    s_barrier
    ds_read_b128 v[148:151], v18 offset:49152
    v_mfma_f32_32x32x16_bf16 v[88:103], v[160:163], v[176:179], v[88:103]
    ds_read_b128 v[152:155], v18 offset:51200
    s_waitcnt lgkmcnt(3)
    v_mfma_f32_32x32x16_bf16 v[56:71], v[164:167], v[172:175], v[56:71]
    ds_read_b128 v[136:139], v3 offset:8192
    v_mfma_f32_32x32x16_bf16 v[104:119], v[164:167], v[176:179], v[104:119]
    ds_read_b128 v[140:143], v3 offset:9216
    s_waitcnt lgkmcnt(4)
    v_mfma_f32_32x32x16_bf16 v[72:87], v[168:171], v[172:175], v[72:87]
    ds_read_b128 v[144:147], v3 offset:10240
    v_mfma_f32_32x32x16_bf16 v[120:135], v[168:171], v[176:179], v[120:135]
    s_waitcnt lgkmcnt(2)
    v_mfma_f32_32x32x16_bf16 v[40:55], v[136:139], v[148:151], v[40:55]
    ds_read_b128 v[172:175], v18 offset:50176
    v_mfma_f32_32x32x16_bf16 v[88:103], v[136:139], v[152:155], v[88:103]
    ds_read_b128 v[176:179], v18 offset:52224
    s_waitcnt lgkmcnt(3)
    v_mfma_f32_32x32x16_bf16 v[56:71], v[140:143], v[148:151], v[56:71]
    ds_read_b128 v[160:163], v3 offset:14336
    v_mfma_f32_32x32x16_bf16 v[104:119], v[140:143], v[152:155], v[104:119]
    ds_read_b128 v[164:167], v3 offset:15360
    s_waitcnt lgkmcnt(4)
    v_mfma_f32_32x32x16_bf16 v[72:87], v[144:147], v[148:151], v[72:87]
    ds_read_b128 v[168:171], v3 offset:16384
    v_mfma_f32_32x32x16_bf16 v[120:135], v[144:147], v[152:155], v[120:135]
    s_waitcnt lgkmcnt(2)
    v_mfma_f32_32x32x16_bf16 v[40:55], v[160:163], v[172:175], v[40:55]
    s_barrier
    ds_read_b128 v[148:151], v18 offset:57344
    v_mfma_f32_32x32x16_bf16 v[88:103], v[160:163], v[176:179], v[88:103]
    ds_read_b128 v[152:155], v18 offset:59392
    s_waitcnt lgkmcnt(3)
    v_mfma_f32_32x32x16_bf16 v[56:71], v[164:167], v[172:175], v[56:71]
    ds_read_b128 v[136:139], v3 offset:20480
    v_mfma_f32_32x32x16_bf16 v[104:119], v[164:167], v[176:179], v[104:119]
    ds_read_b128 v[140:143], v3 offset:21504
    s_waitcnt lgkmcnt(4)
    v_mfma_f32_32x32x16_bf16 v[72:87], v[168:171], v[172:175], v[72:87]
    ds_read_b128 v[144:147], v3 offset:22528
    v_mfma_f32_32x32x16_bf16 v[120:135], v[168:171], v[176:179], v[120:135]
    s_waitcnt lgkmcnt(2)
    v_mfma_f32_32x32x16_bf16 v[40:55], v[136:139], v[148:151], v[40:55]
    ds_read_b128 v[172:175], v18 offset:58368
    v_mfma_f32_32x32x16_bf16 v[88:103], v[136:139], v[152:155], v[88:103]
    ds_read_b128 v[176:179], v18 offset:60416
    s_waitcnt lgkmcnt(3)
    v_mfma_f32_32x32x16_bf16 v[56:71], v[140:143], v[148:151], v[56:71]
    ds_read_b128 v[160:163], v3 offset:26624
    v_mfma_f32_32x32x16_bf16 v[104:119], v[140:143], v[152:155], v[104:119]
    ds_read_b128 v[164:167], v3 offset:27648
    s_waitcnt lgkmcnt(4)
    v_mfma_f32_32x32x16_bf16 v[72:87], v[144:147], v[148:151], v[72:87]
    ds_read_b128 v[168:171], v3 offset:28672
    v_mfma_f32_32x32x16_bf16 v[120:135], v[144:147], v[152:155], v[120:135]
    s_waitcnt lgkmcnt(2)
    v_mfma_f32_32x32x16_bf16 v[40:55], v[160:163], v[172:175], v[40:55]
    s_barrier
    ds_read_b128 v[148:151], v18 offset:0
    v_mfma_f32_32x32x16_bf16 v[88:103], v[160:163], v[176:179], v[88:103]
    ds_read_b128 v[152:155], v18 offset:2048
    s_waitcnt lgkmcnt(3)
    v_mfma_f32_32x32x16_bf16 v[56:71], v[164:167], v[172:175], v[56:71]
    ds_read_b128 v[136:139], v2 offset:0
    v_mfma_f32_32x32x16_bf16 v[104:119], v[164:167], v[176:179], v[104:119]
    ds_read_b128 v[140:143], v2 offset:1024
    s_waitcnt lgkmcnt(4)
    v_mfma_f32_32x32x16_bf16 v[72:87], v[168:171], v[172:175], v[72:87]
    ds_read_b128 v[144:147], v2 offset:2048
    v_mfma_f32_32x32x16_bf16 v[120:135], v[168:171], v[176:179], v[120:135]
    s_waitcnt lgkmcnt(2)
    v_mfma_f32_32x32x16_bf16 v[40:55], v[136:139], v[148:151], v[40:55]
    ds_read_b128 v[172:175], v18 offset:1024
    v_mfma_f32_32x32x16_bf16 v[88:103], v[136:139], v[152:155], v[88:103]
    ds_read_b128 v[176:179], v18 offset:3072
    s_waitcnt lgkmcnt(3)
    v_mfma_f32_32x32x16_bf16 v[56:71], v[140:143], v[148:151], v[56:71]
    ds_read_b128 v[160:163], v2 offset:6144
    v_mfma_f32_32x32x16_bf16 v[104:119], v[140:143], v[152:155], v[104:119]
    ds_read_b128 v[164:167], v2 offset:7168
    s_waitcnt lgkmcnt(4)
    v_mfma_f32_32x32x16_bf16 v[72:87], v[144:147], v[148:151], v[72:87]
    ds_read_b128 v[168:171], v2 offset:8192
    v_mfma_f32_32x32x16_bf16 v[120:135], v[144:147], v[152:155], v[120:135]
    s_waitcnt lgkmcnt(2)
    v_mfma_f32_32x32x16_bf16 v[40:55], v[160:163], v[172:175], v[40:55]
    s_barrier
    ds_read_b128 v[148:151], v18 offset:8192
    v_mfma_f32_32x32x16_bf16 v[88:103], v[160:163], v[176:179], v[88:103]
    ds_read_b128 v[152:155], v18 offset:10240
    s_waitcnt lgkmcnt(3)
    v_mfma_f32_32x32x16_bf16 v[56:71], v[164:167], v[172:175], v[56:71]
    ds_read_b128 v[136:139], v2 offset:12288
    v_mfma_f32_32x32x16_bf16 v[104:119], v[164:167], v[176:179], v[104:119]
    ds_read_b128 v[140:143], v2 offset:13312
    s_waitcnt lgkmcnt(4)
    v_mfma_f32_32x32x16_bf16 v[72:87], v[168:171], v[172:175], v[72:87]
    ds_read_b128 v[144:147], v2 offset:14336
    v_mfma_f32_32x32x16_bf16 v[120:135], v[168:171], v[176:179], v[120:135]
    s_waitcnt lgkmcnt(2)
    v_mfma_f32_32x32x16_bf16 v[40:55], v[136:139], v[148:151], v[40:55]
    ds_read_b128 v[172:175], v18 offset:9216
    v_mfma_f32_32x32x16_bf16 v[88:103], v[136:139], v[152:155], v[88:103]
    ds_read_b128 v[176:179], v18 offset:11264
    s_waitcnt lgkmcnt(3)
    v_mfma_f32_32x32x16_bf16 v[56:71], v[140:143], v[148:151], v[56:71]
    ds_read_b128 v[160:163], v2 offset:18432
    v_mfma_f32_32x32x16_bf16 v[104:119], v[140:143], v[152:155], v[104:119]
    ds_read_b128 v[164:167], v2 offset:19456
    s_waitcnt lgkmcnt(4)
    v_mfma_f32_32x32x16_bf16 v[72:87], v[144:147], v[148:151], v[72:87]
    ds_read_b128 v[168:171], v2 offset:20480
    v_mfma_f32_32x32x16_bf16 v[120:135], v[144:147], v[152:155], v[120:135]
    s_waitcnt lgkmcnt(2)
    v_mfma_f32_32x32x16_bf16 v[40:55], v[160:163], v[172:175], v[40:55]
    s_barrier
    ds_read_b128 v[148:151], v18 offset:16384
    v_mfma_f32_32x32x16_bf16 v[88:103], v[160:163], v[176:179], v[88:103]
    ds_read_b128 v[152:155], v18 offset:18432
    s_waitcnt lgkmcnt(3)
    v_mfma_f32_32x32x16_bf16 v[56:71], v[164:167], v[172:175], v[56:71]
    ds_read_b128 v[136:139], v2 offset:24576
    v_mfma_f32_32x32x16_bf16 v[104:119], v[164:167], v[176:179], v[104:119]
    ds_read_b128 v[140:143], v2 offset:25600
    s_waitcnt lgkmcnt(4)
    v_mfma_f32_32x32x16_bf16 v[72:87], v[168:171], v[172:175], v[72:87]
    ds_read_b128 v[144:147], v2 offset:26624
    v_mfma_f32_32x32x16_bf16 v[120:135], v[168:171], v[176:179], v[120:135]
    s_waitcnt lgkmcnt(2)
    v_mfma_f32_32x32x16_bf16 v[40:55], v[136:139], v[148:151], v[40:55]
    ds_read_b128 v[172:175], v18 offset:17408
    v_mfma_f32_32x32x16_bf16 v[88:103], v[136:139], v[152:155], v[88:103]
    ds_read_b128 v[176:179], v18 offset:19456
    s_waitcnt lgkmcnt(3)
    v_mfma_f32_32x32x16_bf16 v[56:71], v[140:143], v[148:151], v[56:71]
    ds_read_b128 v[160:163], v2 offset:30720
    v_mfma_f32_32x32x16_bf16 v[104:119], v[140:143], v[152:155], v[104:119]
    ds_read_b128 v[164:167], v2 offset:31744
    s_waitcnt lgkmcnt(4)
    v_mfma_f32_32x32x16_bf16 v[72:87], v[144:147], v[148:151], v[72:87]
    ds_read_b128 v[168:171], v2 offset:32768
    v_mfma_f32_32x32x16_bf16 v[120:135], v[144:147], v[152:155], v[120:135]
    s_waitcnt lgkmcnt(2)
    v_mfma_f32_32x32x16_bf16 v[40:55], v[160:163], v[172:175], v[40:55]
    s_barrier
    ds_read_b128 v[148:151], v18 offset:24576
    v_mfma_f32_32x32x16_bf16 v[88:103], v[160:163], v[176:179], v[88:103]
    ds_read_b128 v[152:155], v18 offset:26624
    s_waitcnt lgkmcnt(3)
    v_mfma_f32_32x32x16_bf16 v[56:71], v[164:167], v[172:175], v[56:71]
    ds_read_b128 v[136:139], v2 offset:36864
    v_mfma_f32_32x32x16_bf16 v[104:119], v[164:167], v[176:179], v[104:119]
    ds_read_b128 v[140:143], v2 offset:37888
    s_waitcnt lgkmcnt(4)
    v_mfma_f32_32x32x16_bf16 v[72:87], v[168:171], v[172:175], v[72:87]
    ds_read_b128 v[144:147], v2 offset:38912
    v_mfma_f32_32x32x16_bf16 v[120:135], v[168:171], v[176:179], v[120:135]
    s_waitcnt lgkmcnt(2)
    v_mfma_f32_32x32x16_bf16 v[40:55], v[136:139], v[148:151], v[40:55]
    ds_read_b128 v[172:175], v18 offset:25600
    v_mfma_f32_32x32x16_bf16 v[88:103], v[136:139], v[152:155], v[88:103]
    ds_read_b128 v[176:179], v18 offset:27648
    s_waitcnt lgkmcnt(3)
    v_mfma_f32_32x32x16_bf16 v[56:71], v[140:143], v[148:151], v[56:71]
    ds_read_b128 v[160:163], v2 offset:43008
    v_mfma_f32_32x32x16_bf16 v[104:119], v[140:143], v[152:155], v[104:119]
    ds_read_b128 v[164:167], v2 offset:44032
    s_waitcnt lgkmcnt(4)
    v_mfma_f32_32x32x16_bf16 v[72:87], v[144:147], v[148:151], v[72:87]
    ds_read_b128 v[168:171], v2 offset:45056
    v_mfma_f32_32x32x16_bf16 v[120:135], v[144:147], v[152:155], v[120:135]
    s_waitcnt lgkmcnt(2)
    v_mfma_f32_32x32x16_bf16 v[40:55], v[160:163], v[172:175], v[40:55]
    v_mfma_f32_32x32x16_bf16 v[88:103], v[160:163], v[176:179], v[88:103]
    s_waitcnt lgkmcnt(1)
    v_mfma_f32_32x32x16_bf16 v[56:71], v[164:167], v[172:175], v[56:71]
    v_mfma_f32_32x32x16_bf16 v[104:119], v[164:167], v[176:179], v[104:119]
    s_waitcnt lgkmcnt(0)
    v_mfma_f32_32x32x16_bf16 v[72:87], v[168:171], v[172:175], v[72:87]
    v_mfma_f32_32x32x16_bf16 v[120:135], v[168:171], v[176:179], v[120:135]
    s_waitcnt lgkmcnt(0)
    s_barrier
    s_waitcnt vmcnt(0)
    v_pk_add_f32 v[24:25], v[24:25], v[26:27]
    v_pk_add_f32 v[28:29], v[28:29], v[30:31]
    v_pk_add_f32 v[24:25], v[24:25], v[28:29]
    v_mov_b32 v26, v24
    s_nop 1
    v_permlane32_swap_b32 v24, v26
    s_nop 1
    v_add_f32 v24, v24, v26
    v_mov_b32 v27, v25
    s_nop 1
    v_permlane32_swap_b32 v25, v27
    s_nop 1
    v_add_f32 v25, v25, v27
    v_mul_f32 v24, 0x3acccccd, v24
    v_mul_f32 v26, 0x3acccccd, v25
    v_fma_f32 v26, -v24, v24, v26
    v_add_f32 v26, 0x3727c5ac, v26
    v_rsq_f32 v28, v26
    v_mov_b32 v27, v26
    v_mul_f32 v24, 0xc0135761, v28
    v_mul_f32 v28, v28, v28
    v_mov_b32 v25, v24
    v_mul_f32 v28, v28, v24
    v_mul_f32 v28, 0x3d372713, v28
    v_mov_b32 v29, v28
    v_pk_add_f32 v[32:33], v[32:33], v[34:35]
    v_pk_add_f32 v[36:37], v[36:37], v[38:39]
    v_pk_add_f32 v[32:33], v[32:33], v[36:37]
    v_mov_b32 v34, v32
    s_nop 1
    v_permlane32_swap_b32 v32, v34
    s_nop 1
    v_add_f32 v32, v32, v34
    v_mov_b32 v35, v33
    s_nop 1
    v_permlane32_swap_b32 v33, v35
    s_nop 1
    v_add_f32 v33, v33, v35
    v_mul_f32 v32, 0x3acccccd, v32
    v_mul_f32 v34, 0x3acccccd, v33
    v_fma_f32 v34, -v32, v32, v34
    v_add_f32 v34, 0x3727c5ac, v34
    v_rsq_f32 v36, v34
    v_mov_b32 v35, v34
    v_mul_f32 v32, 0xc0135761, v36
    v_mul_f32 v36, v36, v36
    v_mov_b32 v33, v32
    v_mul_f32 v36, v36, v32
    v_mul_f32 v36, 0x3d372713, v36
    v_mov_b32 v37, v36
    v_pk_mul_f32 v[136:137], v[40:41], v[40:41]
    v_pk_mul_f32 v[138:139], v[42:43], v[42:43]
    v_pk_mul_f32 v[140:141], v[44:45], v[44:45]
    v_pk_mul_f32 v[142:143], v[46:47], v[46:47]
    v_pk_fma_f32 v[136:137], v[136:137], v[28:29], v[24:25]
    v_pk_fma_f32 v[138:139], v[138:139], v[28:29], v[24:25]
    v_pk_fma_f32 v[140:141], v[140:141], v[28:29], v[24:25]
    v_pk_fma_f32 v[142:143], v[142:143], v[28:29], v[24:25]
    v_pk_mul_f32 v[136:137], v[136:137], v[40:41]
    v_pk_mul_f32 v[138:139], v[138:139], v[42:43]
    v_pk_mul_f32 v[140:141], v[140:141], v[44:45]
    v_pk_mul_f32 v[142:143], v[142:143], v[46:47]
    v_exp_f32 v136, v136
    v_exp_f32 v137, v137
    v_exp_f32 v138, v138
    v_exp_f32 v139, v139
    v_exp_f32 v140, v140
    v_exp_f32 v141, v141
    v_exp_f32 v142, v142
    v_exp_f32 v143, v143
    v_pk_mul_f32 v[144:145], v[40:41], v[48:49]
    v_pk_mul_f32 v[146:147], v[42:43], v[50:51]
    v_pk_mul_f32 v[148:149], v[44:45], v[52:53]
    v_pk_mul_f32 v[150:151], v[46:47], v[54:55]
    v_pk_fma_f32 v[136:137], v[136:137], v[26:27], v[26:27]
    v_pk_fma_f32 v[138:139], v[138:139], v[26:27], v[26:27]
    v_pk_fma_f32 v[140:141], v[140:141], v[26:27], v[26:27]
    v_pk_fma_f32 v[142:143], v[142:143], v[26:27], v[26:27]
    v_rcp_f32 v136, v136
    v_rcp_f32 v137, v137
    v_rcp_f32 v138, v138
    v_rcp_f32 v139, v139
    v_rcp_f32 v140, v140
    v_rcp_f32 v141, v141
    v_rcp_f32 v142, v142
    v_rcp_f32 v143, v143
    s_nop 0
    v_pk_mul_f32 v[136:137], v[136:137], v[144:145]
    v_pk_mul_f32 v[138:139], v[138:139], v[146:147]
    v_pk_mul_f32 v[140:141], v[140:141], v[148:149]
    v_pk_mul_f32 v[142:143], v[142:143], v[150:151]
    v_cvt_pk_bf16_f32 v152, v136, v137
    v_cvt_pk_bf16_f32 v153, v138, v139
    v_cvt_pk_bf16_f32 v154, v140, v141
    v_cvt_pk_bf16_f32 v155, v142, v143
    buffer_store_dwordx4 v[152:155], v5, s[8:11], s24 offen offset:0 sc1
    v_pk_mul_f32 v[160:161], v[56:57], v[56:57]
    v_pk_mul_f32 v[162:163], v[58:59], v[58:59]
    v_pk_mul_f32 v[164:165], v[60:61], v[60:61]
    v_pk_mul_f32 v[166:167], v[62:63], v[62:63]
    v_pk_fma_f32 v[160:161], v[160:161], v[28:29], v[24:25]
    v_pk_fma_f32 v[162:163], v[162:163], v[28:29], v[24:25]
    v_pk_fma_f32 v[164:165], v[164:165], v[28:29], v[24:25]
    v_pk_fma_f32 v[166:167], v[166:167], v[28:29], v[24:25]
    v_pk_mul_f32 v[160:161], v[160:161], v[56:57]
    v_pk_mul_f32 v[162:163], v[162:163], v[58:59]
    v_pk_mul_f32 v[164:165], v[164:165], v[60:61]
    v_pk_mul_f32 v[166:167], v[166:167], v[62:63]
    v_exp_f32 v160, v160
    v_exp_f32 v161, v161
    v_exp_f32 v162, v162
    v_exp_f32 v163, v163
    v_exp_f32 v164, v164
    v_exp_f32 v165, v165
    v_exp_f32 v166, v166
    v_exp_f32 v167, v167
    v_pk_mul_f32 v[168:169], v[56:57], v[64:65]
    v_pk_mul_f32 v[170:171], v[58:59], v[66:67]
    v_pk_mul_f32 v[172:173], v[60:61], v[68:69]
    v_pk_mul_f32 v[174:175], v[62:63], v[70:71]
    v_pk_fma_f32 v[160:161], v[160:161], v[26:27], v[26:27]
    v_pk_fma_f32 v[162:163], v[162:163], v[26:27], v[26:27]
    v_pk_fma_f32 v[164:165], v[164:165], v[26:27], v[26:27]
    v_pk_fma_f32 v[166:167], v[166:167], v[26:27], v[26:27]
    v_rcp_f32 v160, v160
    v_rcp_f32 v161, v161
    v_rcp_f32 v162, v162
    v_rcp_f32 v163, v163
    v_rcp_f32 v164, v164
    v_rcp_f32 v165, v165
    v_rcp_f32 v166, v166
    v_rcp_f32 v167, v167
    s_nop 0
    v_pk_mul_f32 v[160:161], v[160:161], v[168:169]
    v_pk_mul_f32 v[162:163], v[162:163], v[170:171]
    v_pk_mul_f32 v[164:165], v[164:165], v[172:173]
    v_pk_mul_f32 v[166:167], v[166:167], v[174:175]
    v_cvt_pk_bf16_f32 v176, v160, v161
    v_cvt_pk_bf16_f32 v177, v162, v163
    v_cvt_pk_bf16_f32 v178, v164, v165
    v_cvt_pk_bf16_f32 v179, v166, v167
    buffer_store_dwordx4 v[176:179], v5, s[8:11], s24 offen offset:512 sc1
    v_pk_mul_f32 v[136:137], v[72:73], v[72:73]
    v_pk_mul_f32 v[138:139], v[74:75], v[74:75]
    v_pk_mul_f32 v[140:141], v[76:77], v[76:77]
    v_pk_mul_f32 v[142:143], v[78:79], v[78:79]
    v_pk_fma_f32 v[136:137], v[136:137], v[28:29], v[24:25]
    v_pk_fma_f32 v[138:139], v[138:139], v[28:29], v[24:25]
    v_pk_fma_f32 v[140:141], v[140:141], v[28:29], v[24:25]
    v_pk_fma_f32 v[142:143], v[142:143], v[28:29], v[24:25]
    v_pk_mul_f32 v[136:137], v[136:137], v[72:73]
    v_pk_mul_f32 v[138:139], v[138:139], v[74:75]
    v_pk_mul_f32 v[140:141], v[140:141], v[76:77]
    v_pk_mul_f32 v[142:143], v[142:143], v[78:79]
    v_exp_f32 v136, v136
    v_exp_f32 v137, v137
    v_exp_f32 v138, v138
    v_exp_f32 v139, v139
    v_exp_f32 v140, v140
    v_exp_f32 v141, v141
    v_exp_f32 v142, v142
    v_exp_f32 v143, v143
    v_pk_mul_f32 v[144:145], v[72:73], v[80:81]
    v_pk_mul_f32 v[146:147], v[74:75], v[82:83]
    v_pk_mul_f32 v[148:149], v[76:77], v[84:85]
    v_pk_mul_f32 v[150:151], v[78:79], v[86:87]
    v_pk_fma_f32 v[136:137], v[136:137], v[26:27], v[26:27]
    v_pk_fma_f32 v[138:139], v[138:139], v[26:27], v[26:27]
    v_pk_fma_f32 v[140:141], v[140:141], v[26:27], v[26:27]
    v_pk_fma_f32 v[142:143], v[142:143], v[26:27], v[26:27]
    v_rcp_f32 v136, v136
    v_rcp_f32 v137, v137
    v_rcp_f32 v138, v138
    v_rcp_f32 v139, v139
    v_rcp_f32 v140, v140
    v_rcp_f32 v141, v141
    v_rcp_f32 v142, v142
    v_rcp_f32 v143, v143
    s_nop 0
    v_pk_mul_f32 v[136:137], v[136:137], v[144:145]
    v_pk_mul_f32 v[138:139], v[138:139], v[146:147]
    v_pk_mul_f32 v[140:141], v[140:141], v[148:149]
    v_pk_mul_f32 v[142:143], v[142:143], v[150:151]
    v_cvt_pk_bf16_f32 v152, v136, v137
    v_cvt_pk_bf16_f32 v153, v138, v139
    v_cvt_pk_bf16_f32 v154, v140, v141
    v_cvt_pk_bf16_f32 v155, v142, v143
    buffer_store_dwordx4 v[152:155], v5, s[8:11], s24 offen offset:1024 sc1
    v_pk_mul_f32 v[160:161], v[88:89], v[88:89]
    v_pk_mul_f32 v[162:163], v[90:91], v[90:91]
    v_pk_mul_f32 v[164:165], v[92:93], v[92:93]
    v_pk_mul_f32 v[166:167], v[94:95], v[94:95]
    v_pk_fma_f32 v[160:161], v[160:161], v[36:37], v[32:33]
    v_pk_fma_f32 v[162:163], v[162:163], v[36:37], v[32:33]
    v_pk_fma_f32 v[164:165], v[164:165], v[36:37], v[32:33]
    v_pk_fma_f32 v[166:167], v[166:167], v[36:37], v[32:33]
    v_pk_mul_f32 v[160:161], v[160:161], v[88:89]
    v_pk_mul_f32 v[162:163], v[162:163], v[90:91]
    v_pk_mul_f32 v[164:165], v[164:165], v[92:93]
    v_pk_mul_f32 v[166:167], v[166:167], v[94:95]
    v_exp_f32 v160, v160
    v_exp_f32 v161, v161
    v_exp_f32 v162, v162
    v_exp_f32 v163, v163
    v_exp_f32 v164, v164
    v_exp_f32 v165, v165
    v_exp_f32 v166, v166
    v_exp_f32 v167, v167
    v_pk_mul_f32 v[168:169], v[88:89], v[96:97]
    v_pk_mul_f32 v[170:171], v[90:91], v[98:99]
    v_pk_mul_f32 v[172:173], v[92:93], v[100:101]
    v_pk_mul_f32 v[174:175], v[94:95], v[102:103]
    v_pk_fma_f32 v[160:161], v[160:161], v[34:35], v[34:35]
    v_pk_fma_f32 v[162:163], v[162:163], v[34:35], v[34:35]
    v_pk_fma_f32 v[164:165], v[164:165], v[34:35], v[34:35]
    v_pk_fma_f32 v[166:167], v[166:167], v[34:35], v[34:35]
    v_rcp_f32 v160, v160
    v_rcp_f32 v161, v161
    v_rcp_f32 v162, v162
    v_rcp_f32 v163, v163
    v_rcp_f32 v164, v164
    v_rcp_f32 v165, v165
    v_rcp_f32 v166, v166
    v_rcp_f32 v167, v167
    s_nop 0
    v_pk_mul_f32 v[160:161], v[160:161], v[168:169]
    v_pk_mul_f32 v[162:163], v[162:163], v[170:171]
    v_pk_mul_f32 v[164:165], v[164:165], v[172:173]
    v_pk_mul_f32 v[166:167], v[166:167], v[174:175]
    v_cvt_pk_bf16_f32 v176, v160, v161
    v_cvt_pk_bf16_f32 v177, v162, v163
    v_cvt_pk_bf16_f32 v178, v164, v165
    v_cvt_pk_bf16_f32 v179, v166, v167
    buffer_store_dwordx4 v[176:179], v5, s[8:11], s25 offen offset:0 sc1
    v_pk_mul_f32 v[136:137], v[104:105], v[104:105]
    v_pk_mul_f32 v[138:139], v[106:107], v[106:107]
    v_pk_mul_f32 v[140:141], v[108:109], v[108:109]
    v_pk_mul_f32 v[142:143], v[110:111], v[110:111]
    v_pk_fma_f32 v[136:137], v[136:137], v[36:37], v[32:33]
    v_pk_fma_f32 v[138:139], v[138:139], v[36:37], v[32:33]
    v_pk_fma_f32 v[140:141], v[140:141], v[36:37], v[32:33]
    v_pk_fma_f32 v[142:143], v[142:143], v[36:37], v[32:33]
    v_pk_mul_f32 v[136:137], v[136:137], v[104:105]
    v_pk_mul_f32 v[138:139], v[138:139], v[106:107]
    v_pk_mul_f32 v[140:141], v[140:141], v[108:109]
    v_pk_mul_f32 v[142:143], v[142:143], v[110:111]
    v_exp_f32 v136, v136
    v_exp_f32 v137, v137
    v_exp_f32 v138, v138
    v_exp_f32 v139, v139
    v_exp_f32 v140, v140
    v_exp_f32 v141, v141
    v_exp_f32 v142, v142
    v_exp_f32 v143, v143
    v_pk_mul_f32 v[144:145], v[104:105], v[112:113]
    v_pk_mul_f32 v[146:147], v[106:107], v[114:115]
    v_pk_mul_f32 v[148:149], v[108:109], v[116:117]
    v_pk_mul_f32 v[150:151], v[110:111], v[118:119]
    v_pk_fma_f32 v[136:137], v[136:137], v[34:35], v[34:35]
    v_pk_fma_f32 v[138:139], v[138:139], v[34:35], v[34:35]
    v_pk_fma_f32 v[140:141], v[140:141], v[34:35], v[34:35]
    v_pk_fma_f32 v[142:143], v[142:143], v[34:35], v[34:35]
    v_rcp_f32 v136, v136
    v_rcp_f32 v137, v137
    v_rcp_f32 v138, v138
    v_rcp_f32 v139, v139
    v_rcp_f32 v140, v140
    v_rcp_f32 v141, v141
    v_rcp_f32 v142, v142
    v_rcp_f32 v143, v143
    s_nop 0
    v_pk_mul_f32 v[136:137], v[136:137], v[144:145]
    v_pk_mul_f32 v[138:139], v[138:139], v[146:147]
    v_pk_mul_f32 v[140:141], v[140:141], v[148:149]
    v_pk_mul_f32 v[142:143], v[142:143], v[150:151]
    v_cvt_pk_bf16_f32 v152, v136, v137
    v_cvt_pk_bf16_f32 v153, v138, v139
    v_cvt_pk_bf16_f32 v154, v140, v141
    v_cvt_pk_bf16_f32 v155, v142, v143
    buffer_store_dwordx4 v[152:155], v5, s[8:11], s25 offen offset:512 sc1
    v_pk_mul_f32 v[160:161], v[120:121], v[120:121]
    v_pk_mul_f32 v[162:163], v[122:123], v[122:123]
    v_pk_mul_f32 v[164:165], v[124:125], v[124:125]
    v_pk_mul_f32 v[166:167], v[126:127], v[126:127]
    v_pk_fma_f32 v[160:161], v[160:161], v[36:37], v[32:33]
    v_pk_fma_f32 v[162:163], v[162:163], v[36:37], v[32:33]
    v_pk_fma_f32 v[164:165], v[164:165], v[36:37], v[32:33]
    v_pk_fma_f32 v[166:167], v[166:167], v[36:37], v[32:33]
    v_pk_mul_f32 v[160:161], v[160:161], v[120:121]
    v_pk_mul_f32 v[162:163], v[162:163], v[122:123]
    v_pk_mul_f32 v[164:165], v[164:165], v[124:125]
    v_pk_mul_f32 v[166:167], v[166:167], v[126:127]
    v_exp_f32 v160, v160
    v_exp_f32 v161, v161
    v_exp_f32 v162, v162
    v_exp_f32 v163, v163
    v_exp_f32 v164, v164
    v_exp_f32 v165, v165
    v_exp_f32 v166, v166
    v_exp_f32 v167, v167
    v_pk_mul_f32 v[168:169], v[120:121], v[128:129]
    v_pk_mul_f32 v[170:171], v[122:123], v[130:131]
    v_pk_mul_f32 v[172:173], v[124:125], v[132:133]
    v_pk_mul_f32 v[174:175], v[126:127], v[134:135]
    v_pk_fma_f32 v[160:161], v[160:161], v[34:35], v[34:35]
    v_pk_fma_f32 v[162:163], v[162:163], v[34:35], v[34:35]
    v_pk_fma_f32 v[164:165], v[164:165], v[34:35], v[34:35]
    v_pk_fma_f32 v[166:167], v[166:167], v[34:35], v[34:35]
    v_rcp_f32 v160, v160
    v_rcp_f32 v161, v161
    v_rcp_f32 v162, v162
    v_rcp_f32 v163, v163
    v_rcp_f32 v164, v164
    v_rcp_f32 v165, v165
    v_rcp_f32 v166, v166
    v_rcp_f32 v167, v167
    s_nop 0
    v_pk_mul_f32 v[160:161], v[160:161], v[168:169]
    v_pk_mul_f32 v[162:163], v[162:163], v[170:171]
    v_pk_mul_f32 v[164:165], v[164:165], v[172:173]
    v_pk_mul_f32 v[166:167], v[166:167], v[174:175]
    v_cvt_pk_bf16_f32 v176, v160, v161
    v_cvt_pk_bf16_f32 v177, v162, v163
    v_cvt_pk_bf16_f32 v178, v164, v165
    v_cvt_pk_bf16_f32 v179, v166, v167
    buffer_store_dwordx4 v[176:179], v5, s[8:11], s25 offen offset:1024 sc1
    s_waitcnt vmcnt(0)
    s_barrier
    s_cmp_lg_u32 s3, 0
    s_cbranch_scc1 main_kernel_sig16
    s_add_u32 s44, s55, 48365568
    v_mov_b32 v246, 1
    s_mov_b64 exec, 1
    s_cmp_lg_u32 s84, 0
    s_cbranch_scc1 main_kernel_sig16s
    buffer_store_dword v246, off, s[8:11], s44
    s_branch main_kernel_sig16e
main_kernel_sig16s:
    buffer_wbl2 sc1
    s_waitcnt vmcnt(0)
    buffer_store_dword v246, off, s[8:11], s44 sc1
main_kernel_sig16e:
    s_mov_b64 exec, -1
main_kernel_sig16:
    v_lshlrev_b32 v1, 4, v0
    v_and_b32 v6, 15, v0
    v_lshrrev_b32 v7, 4, v0
    s_and_b32 s7, s3, 1
    s_lshr_b32 s5, s3, 1
    s_lshl_b32 s4, s50, 2
    s_lshl_b32 s20, s7, 1
    s_add_u32 s4, s4, s20
    s_mul_i32 s22, s4, 49152
    s_lshl_b32 s20, s5, 10
    s_add_u32 s22, s22, s20
    s_add_u32 s22, s22, 33554432
    s_add_u32 s4, s4, s5
    s_mul_i32 s20, s5, 5120
    v_add_u32 v2, s20, v1
    v_add_u32 v3, 0x10000, v2
    v_add_u32 v4, 0x20000, v2
    v_add_u32 v5, 49152, v1
    v_lshrrev_b32 v10, 1, v7
    v_and_b32 v11, 1, v7
    v_lshlrev_b32 v8, 8, v10
    v_lshl_add_u32 v8, v6, 4, v8
    v_lshl_add_u32 v9, v11, 9, v8
    v_lshl_add_u32 v8, v11, 3, v8
    s_mul_i32 s24, s4, 20480
    s_mul_i32 s26, s51, 2560
    s_add_u32 s24, s24, s26
    s_add_u32 s25, s24, 8388608
    buffer_load_dwordx2 v[232:233], v8, s[8:11], s25 offen offset:0 sc1
    buffer_load_dwordx2 v[234:235], v8, s[8:11], s25 offen offset:512 sc1
    buffer_load_dwordx2 v[236:237], v8, s[8:11], s25 offen offset:1024 sc1
    buffer_load_dwordx2 v[238:239], v8, s[8:11], s25 offen offset:1536 sc1
    buffer_load_dwordx2 v[240:241], v8, s[8:11], s25 offen offset:2048 sc1
    s_lshr_b32 s26, s50, 1
    s_lshl_b32 s26, s26, 8
    s_cmp_lg_u32 s3, 0
    s_cbranch_scc1 main_kernel_poll17p
    v_lshlrev_b32 v250, 2, v0
    s_mov_b32 s45, 0x200000
    s_add_u32 s44, s26, 48365568
    s_mov_b64 exec, 65535
main_kernel_poll17_0:
    buffer_load_dword v246, v250, s[8:11], s44 offen sc1
    s_waitcnt vmcnt(0)
    v_cmp_ne_u32 vcc, 1, v246
    s_sub_u32 s45, s45, 1
    s_cbranch_scc1 main_kernel_poll17d
    s_cmp_eq_u64 vcc, 0
    s_cbranch_scc0 main_kernel_poll17_0
    s_mov_b64 exec, -1
main_kernel_poll17d:
    s_mov_b64 exec, -1
    s_cmp_eq_u32 s84, 0
    s_cbranch_scc1 main_kernel_poll17p
    buffer_inv sc1
    s_waitcnt vmcnt(0)
main_kernel_poll17p:
    s_barrier
    s_add_u32 s23, s22, 0
    buffer_load_dwordx4 v[24:27], v1, s[8:11], s23 offen sc1
    buffer_load_dwordx4 v[28:31], v5, s[8:11], s23 offen sc1
    s_add_u32 s23, s22, 2048
    buffer_load_dwordx4 v[32:35], v1, s[8:11], s23 offen sc1
    buffer_load_dwordx4 v[36:39], v5, s[8:11], s23 offen sc1
    s_add_u32 s23, s22, 4096
    buffer_load_dwordx4 v[40:43], v1, s[8:11], s23 offen sc1
    buffer_load_dwordx4 v[44:47], v5, s[8:11], s23 offen sc1
    s_add_u32 s23, s22, 6144
    buffer_load_dwordx4 v[48:51], v1, s[8:11], s23 offen sc1
    buffer_load_dwordx4 v[52:55], v5, s[8:11], s23 offen sc1
    s_add_u32 s23, s22, 8192
    buffer_load_dwordx4 v[56:59], v1, s[8:11], s23 offen sc1
    buffer_load_dwordx4 v[60:63], v5, s[8:11], s23 offen sc1
    s_add_u32 s23, s22, 10240
    buffer_load_dwordx4 v[64:67], v1, s[8:11], s23 offen sc1
    buffer_load_dwordx4 v[68:71], v5, s[8:11], s23 offen sc1
    s_add_u32 s23, s22, 12288
    buffer_load_dwordx4 v[72:75], v1, s[8:11], s23 offen sc1
    buffer_load_dwordx4 v[76:79], v5, s[8:11], s23 offen sc1
    s_add_u32 s23, s22, 14336
    buffer_load_dwordx4 v[80:83], v1, s[8:11], s23 offen sc1
    buffer_load_dwordx4 v[84:87], v5, s[8:11], s23 offen sc1
    s_add_u32 s23, s22, 16384
    buffer_load_dwordx4 v[88:91], v1, s[8:11], s23 offen sc1
    buffer_load_dwordx4 v[92:95], v5, s[8:11], s23 offen sc1
    s_add_u32 s23, s22, 18432
    buffer_load_dwordx4 v[96:99], v1, s[8:11], s23 offen sc1
    buffer_load_dwordx4 v[100:103], v5, s[8:11], s23 offen sc1
    s_add_u32 s23, s22, 20480
    buffer_load_dwordx4 v[104:107], v1, s[8:11], s23 offen sc1
    buffer_load_dwordx4 v[108:111], v5, s[8:11], s23 offen sc1
    s_add_u32 s23, s22, 22528
    buffer_load_dwordx4 v[112:115], v1, s[8:11], s23 offen sc1
    buffer_load_dwordx4 v[116:119], v5, s[8:11], s23 offen sc1
    s_add_u32 s23, s22, 24576
    buffer_load_dwordx4 v[120:123], v1, s[8:11], s23 offen sc1
    buffer_load_dwordx4 v[124:127], v5, s[8:11], s23 offen sc1
    s_add_u32 s23, s22, 26624
    buffer_load_dwordx4 v[128:131], v1, s[8:11], s23 offen sc1
    buffer_load_dwordx4 v[132:135], v5, s[8:11], s23 offen sc1
    s_add_u32 s23, s22, 28672
    buffer_load_dwordx4 v[136:139], v1, s[8:11], s23 offen sc1
    buffer_load_dwordx4 v[140:143], v5, s[8:11], s23 offen sc1
    s_add_u32 s23, s22, 30720
    buffer_load_dwordx4 v[144:147], v1, s[8:11], s23 offen sc1
    buffer_load_dwordx4 v[148:151], v5, s[8:11], s23 offen sc1
    s_barrier
    ds_read_b128 v[152:155], v2 offset:0
    ds_read_b128 v[156:159], v2 offset:1024
    ds_read_b128 v[160:163], v2 offset:2048
    ds_read_b128 v[164:167], v2 offset:3072
    ds_read_b128 v[168:171], v2 offset:4096
    s_waitcnt vmcnt(30)
    s_waitcnt lgkmcnt(4)
    v_mfma_f32_16x16x32_bf16 v[192:195], v[152:155], v[24:27], 0
    v_mfma_f32_16x16x32_bf16 v[212:215], v[152:155], v[28:31], 0
    ds_read_b128 v[172:175], v2 offset:10240
    s_waitcnt lgkmcnt(4)
    v_mfma_f32_16x16x32_bf16 v[196:199], v[156:159], v[24:27], 0
    v_mfma_f32_16x16x32_bf16 v[216:219], v[156:159], v[28:31], 0
    ds_read_b128 v[176:179], v2 offset:11264
    s_waitcnt lgkmcnt(4)
    v_mfma_f32_16x16x32_bf16 v[200:203], v[160:163], v[24:27], 0
    v_mfma_f32_16x16x32_bf16 v[220:223], v[160:163], v[28:31], 0
    ds_read_b128 v[180:183], v2 offset:12288
    s_waitcnt lgkmcnt(4)
    v_mfma_f32_16x16x32_bf16 v[204:207], v[164:167], v[24:27], 0
    v_mfma_f32_16x16x32_bf16 v[224:227], v[164:167], v[28:31], 0
    ds_read_b128 v[184:187], v2 offset:13312
    s_waitcnt lgkmcnt(4)
    v_mfma_f32_16x16x32_bf16 v[208:211], v[168:171], v[24:27], 0
    v_mfma_f32_16x16x32_bf16 v[228:231], v[168:171], v[28:31], 0
    ds_read_b128 v[188:191], v2 offset:14336
    s_add_u32 s23, s22, 32768
    buffer_load_dwordx4 v[24:27], v1, s[8:11], s23 offen sc1
    buffer_load_dwordx4 v[28:31], v5, s[8:11], s23 offen sc1
    s_waitcnt vmcnt(30)
    s_waitcnt lgkmcnt(4)
    v_mfma_f32_16x16x32_bf16 v[192:195], v[172:175], v[32:35], v[192:195]
    v_mfma_f32_16x16x32_bf16 v[212:215], v[172:175], v[36:39], v[212:215]
    s_barrier
    ds_read_b128 v[152:155], v2 offset:20480
    s_waitcnt lgkmcnt(4)
    v_mfma_f32_16x16x32_bf16 v[196:199], v[176:179], v[32:35], v[196:199]
    v_mfma_f32_16x16x32_bf16 v[216:219], v[176:179], v[36:39], v[216:219]
    ds_read_b128 v[156:159], v2 offset:21504
    s_waitcnt lgkmcnt(4)
    v_mfma_f32_16x16x32_bf16 v[200:203], v[180:183], v[32:35], v[200:203]
    v_mfma_f32_16x16x32_bf16 v[220:223], v[180:183], v[36:39], v[220:223]
    ds_read_b128 v[160:163], v2 offset:22528
    s_waitcnt lgkmcnt(4)
    v_mfma_f32_16x16x32_bf16 v[204:207], v[184:187], v[32:35], v[204:207]
    v_mfma_f32_16x16x32_bf16 v[224:227], v[184:187], v[36:39], v[224:227]
    ds_read_b128 v[164:167], v2 offset:23552
    s_waitcnt lgkmcnt(4)
    v_mfma_f32_16x16x32_bf16 v[208:211], v[188:191], v[32:35], v[208:211]
    v_mfma_f32_16x16x32_bf16 v[228:231], v[188:191], v[36:39], v[228:231]
    ds_read_b128 v[168:171], v2 offset:24576
    s_add_u32 s23, s22, 34816
    buffer_load_dwordx4 v[32:35], v1, s[8:11], s23 offen sc1
    buffer_load_dwordx4 v[36:39], v5, s[8:11], s23 offen sc1
    s_waitcnt vmcnt(30)
    s_waitcnt lgkmcnt(4)
    v_mfma_f32_16x16x32_bf16 v[192:195], v[152:155], v[40:43], v[192:195]
    v_mfma_f32_16x16x32_bf16 v[212:215], v[152:155], v[44:47], v[212:215]
    ds_read_b128 v[172:175], v2 offset:30720
    s_waitcnt lgkmcnt(4)
    v_mfma_f32_16x16x32_bf16 v[196:199], v[156:159], v[40:43], v[196:199]
    v_mfma_f32_16x16x32_bf16 v[216:219], v[156:159], v[44:47], v[216:219]
    ds_read_b128 v[176:179], v2 offset:31744
    s_waitcnt lgkmcnt(4)
    v_mfma_f32_16x16x32_bf16 v[200:203], v[160:163], v[40:43], v[200:203]
    v_mfma_f32_16x16x32_bf16 v[220:223], v[160:163], v[44:47], v[220:223]
    ds_read_b128 v[180:183], v2 offset:32768
    s_waitcnt lgkmcnt(4)
    v_mfma_f32_16x16x32_bf16 v[204:207], v[164:167], v[40:43], v[204:207]
    v_mfma_f32_16x16x32_bf16 v[224:227], v[164:167], v[44:47], v[224:227]
    ds_read_b128 v[184:187], v2 offset:33792
    s_waitcnt lgkmcnt(4)
    v_mfma_f32_16x16x32_bf16 v[208:211], v[168:171], v[40:43], v[208:211]
    v_mfma_f32_16x16x32_bf16 v[228:231], v[168:171], v[44:47], v[228:231]
    ds_read_b128 v[188:191], v2 offset:34816
    s_add_u32 s23, s22, 36864
    buffer_load_dwordx4 v[40:43], v1, s[8:11], s23 offen sc1
    buffer_load_dwordx4 v[44:47], v5, s[8:11], s23 offen sc1
    s_waitcnt vmcnt(30)
    s_waitcnt lgkmcnt(4)
    v_mfma_f32_16x16x32_bf16 v[192:195], v[172:175], v[48:51], v[192:195]
    v_mfma_f32_16x16x32_bf16 v[212:215], v[172:175], v[52:55], v[212:215]
    s_barrier
    ds_read_b128 v[152:155], v2 offset:40960
    s_waitcnt lgkmcnt(4)
    v_mfma_f32_16x16x32_bf16 v[196:199], v[176:179], v[48:51], v[196:199]
    v_mfma_f32_16x16x32_bf16 v[216:219], v[176:179], v[52:55], v[216:219]
    ds_read_b128 v[156:159], v2 offset:41984
    s_waitcnt lgkmcnt(4)
    v_mfma_f32_16x16x32_bf16 v[200:203], v[180:183], v[48:51], v[200:203]
    v_mfma_f32_16x16x32_bf16 v[220:223], v[180:183], v[52:55], v[220:223]
    ds_read_b128 v[160:163], v2 offset:43008
    s_waitcnt lgkmcnt(4)
    v_mfma_f32_16x16x32_bf16 v[204:207], v[184:187], v[48:51], v[204:207]
    v_mfma_f32_16x16x32_bf16 v[224:227], v[184:187], v[52:55], v[224:227]
    ds_read_b128 v[164:167], v2 offset:44032
    s_waitcnt lgkmcnt(4)
    v_mfma_f32_16x16x32_bf16 v[208:211], v[188:191], v[48:51], v[208:211]
    v_mfma_f32_16x16x32_bf16 v[228:231], v[188:191], v[52:55], v[228:231]
    ds_read_b128 v[168:171], v2 offset:45056
    s_add_u32 s23, s22, 38912
    buffer_load_dwordx4 v[48:51], v1, s[8:11], s23 offen sc1
    buffer_load_dwordx4 v[52:55], v5, s[8:11], s23 offen sc1
    s_waitcnt vmcnt(30)
    s_waitcnt lgkmcnt(4)
    v_mfma_f32_16x16x32_bf16 v[192:195], v[152:155], v[56:59], v[192:195]
    v_mfma_f32_16x16x32_bf16 v[212:215], v[152:155], v[60:63], v[212:215]
    ds_read_b128 v[172:175], v2 offset:51200
    s_waitcnt lgkmcnt(4)
    v_mfma_f32_16x16x32_bf16 v[196:199], v[156:159], v[56:59], v[196:199]
    v_mfma_f32_16x16x32_bf16 v[216:219], v[156:159], v[60:63], v[216:219]
    ds_read_b128 v[176:179], v2 offset:52224
    s_waitcnt lgkmcnt(4)
    v_mfma_f32_16x16x32_bf16 v[200:203], v[160:163], v[56:59], v[200:203]
    v_mfma_f32_16x16x32_bf16 v[220:223], v[160:163], v[60:63], v[220:223]
    ds_read_b128 v[180:183], v2 offset:53248
    s_waitcnt lgkmcnt(4)
    v_mfma_f32_16x16x32_bf16 v[204:207], v[164:167], v[56:59], v[204:207]
    v_mfma_f32_16x16x32_bf16 v[224:227], v[164:167], v[60:63], v[224:227]
    ds_read_b128 v[184:187], v2 offset:54272
    s_waitcnt lgkmcnt(4)
    v_mfma_f32_16x16x32_bf16 v[208:211], v[168:171], v[56:59], v[208:211]
    v_mfma_f32_16x16x32_bf16 v[228:231], v[168:171], v[60:63], v[228:231]
    ds_read_b128 v[188:191], v2 offset:55296
    s_add_u32 s23, s22, 40960
    buffer_load_dwordx4 v[56:59], v1, s[8:11], s23 offen sc1
    buffer_load_dwordx4 v[60:63], v5, s[8:11], s23 offen sc1
    s_waitcnt vmcnt(30)
    s_waitcnt lgkmcnt(4)
    v_mfma_f32_16x16x32_bf16 v[192:195], v[172:175], v[64:67], v[192:195]
    v_mfma_f32_16x16x32_bf16 v[212:215], v[172:175], v[68:71], v[212:215]
    s_barrier
    ds_read_b128 v[152:155], v2 offset:61440
    s_waitcnt lgkmcnt(4)
    v_mfma_f32_16x16x32_bf16 v[196:199], v[176:179], v[64:67], v[196:199]
    v_mfma_f32_16x16x32_bf16 v[216:219], v[176:179], v[68:71], v[216:219]
    ds_read_b128 v[156:159], v2 offset:62464
    s_waitcnt lgkmcnt(4)
    v_mfma_f32_16x16x32_bf16 v[200:203], v[180:183], v[64:67], v[200:203]
    v_mfma_f32_16x16x32_bf16 v[220:223], v[180:183], v[68:71], v[220:223]
    ds_read_b128 v[160:163], v2 offset:63488
    s_waitcnt lgkmcnt(4)
    v_mfma_f32_16x16x32_bf16 v[204:207], v[184:187], v[64:67], v[204:207]
    v_mfma_f32_16x16x32_bf16 v[224:227], v[184:187], v[68:71], v[224:227]
    ds_read_b128 v[164:167], v2 offset:64512
    s_waitcnt lgkmcnt(4)
    v_mfma_f32_16x16x32_bf16 v[208:211], v[188:191], v[64:67], v[208:211]
    v_mfma_f32_16x16x32_bf16 v[228:231], v[188:191], v[68:71], v[228:231]
    ds_read_b128 v[168:171], v3 offset:0
    s_add_u32 s23, s22, 43008
    buffer_load_dwordx4 v[64:67], v1, s[8:11], s23 offen sc1
    buffer_load_dwordx4 v[68:71], v5, s[8:11], s23 offen sc1
    s_waitcnt vmcnt(30)
    s_waitcnt lgkmcnt(4)
    v_mfma_f32_16x16x32_bf16 v[192:195], v[152:155], v[72:75], v[192:195]
    v_mfma_f32_16x16x32_bf16 v[212:215], v[152:155], v[76:79], v[212:215]
    ds_read_b128 v[172:175], v3 offset:6144
    s_waitcnt lgkmcnt(4)
    v_mfma_f32_16x16x32_bf16 v[196:199], v[156:159], v[72:75], v[196:199]
    v_mfma_f32_16x16x32_bf16 v[216:219], v[156:159], v[76:79], v[216:219]
    ds_read_b128 v[176:179], v3 offset:7168
    s_waitcnt lgkmcnt(4)
    v_mfma_f32_16x16x32_bf16 v[200:203], v[160:163], v[72:75], v[200:203]
    v_mfma_f32_16x16x32_bf16 v[220:223], v[160:163], v[76:79], v[220:223]
    ds_read_b128 v[180:183], v3 offset:8192
    s_waitcnt lgkmcnt(4)
    v_mfma_f32_16x16x32_bf16 v[204:207], v[164:167], v[72:75], v[204:207]
    v_mfma_f32_16x16x32_bf16 v[224:227], v[164:167], v[76:79], v[224:227]
    ds_read_b128 v[184:187], v3 offset:9216
    s_waitcnt lgkmcnt(4)
    v_mfma_f32_16x16x32_bf16 v[208:211], v[168:171], v[72:75], v[208:211]
    v_mfma_f32_16x16x32_bf16 v[228:231], v[168:171], v[76:79], v[228:231]
    ds_read_b128 v[188:191], v3 offset:10240
    s_add_u32 s23, s22, 45056
    buffer_load_dwordx4 v[72:75], v1, s[8:11], s23 offen sc1
    buffer_load_dwordx4 v[76:79], v5, s[8:11], s23 offen sc1
    s_waitcnt vmcnt(30)
    s_waitcnt lgkmcnt(4)
    v_mfma_f32_16x16x32_bf16 v[192:195], v[172:175], v[80:83], v[192:195]
    v_mfma_f32_16x16x32_bf16 v[212:215], v[172:175], v[84:87], v[212:215]
    s_barrier
    ds_read_b128 v[152:155], v3 offset:16384
    s_waitcnt lgkmcnt(4)
    v_mfma_f32_16x16x32_bf16 v[196:199], v[176:179], v[80:83], v[196:199]
    v_mfma_f32_16x16x32_bf16 v[216:219], v[176:179], v[84:87], v[216:219]
    ds_read_b128 v[156:159], v3 offset:17408
    s_waitcnt lgkmcnt(4)
    v_mfma_f32_16x16x32_bf16 v[200:203], v[180:183], v[80:83], v[200:203]
    v_mfma_f32_16x16x32_bf16 v[220:223], v[180:183], v[84:87], v[220:223]
    ds_read_b128 v[160:163], v3 offset:18432
    s_waitcnt lgkmcnt(4)
    v_mfma_f32_16x16x32_bf16 v[204:207], v[184:187], v[80:83], v[204:207]
    v_mfma_f32_16x16x32_bf16 v[224:227], v[184:187], v[84:87], v[224:227]
    ds_read_b128 v[164:167], v3 offset:19456
    s_waitcnt lgkmcnt(4)
    v_mfma_f32_16x16x32_bf16 v[208:211], v[188:191], v[80:83], v[208:211]
    v_mfma_f32_16x16x32_bf16 v[228:231], v[188:191], v[84:87], v[228:231]
    ds_read_b128 v[168:171], v3 offset:20480
    s_add_u32 s23, s22, 47104
    buffer_load_dwordx4 v[80:83], v1, s[8:11], s23 offen sc1
    buffer_load_dwordx4 v[84:87], v5, s[8:11], s23 offen sc1
    s_waitcnt vmcnt(30)
    s_waitcnt lgkmcnt(4)
    v_mfma_f32_16x16x32_bf16 v[192:195], v[152:155], v[88:91], v[192:195]
    v_mfma_f32_16x16x32_bf16 v[212:215], v[152:155], v[92:95], v[212:215]
    ds_read_b128 v[172:175], v3 offset:26624
    s_waitcnt lgkmcnt(4)
    v_mfma_f32_16x16x32_bf16 v[196:199], v[156:159], v[88:91], v[196:199]
    v_mfma_f32_16x16x32_bf16 v[216:219], v[156:159], v[92:95], v[216:219]
    ds_read_b128 v[176:179], v3 offset:27648
    s_waitcnt lgkmcnt(4)
    v_mfma_f32_16x16x32_bf16 v[200:203], v[160:163], v[88:91], v[200:203]
    v_mfma_f32_16x16x32_bf16 v[220:223], v[160:163], v[92:95], v[220:223]
    ds_read_b128 v[180:183], v3 offset:28672
    s_waitcnt lgkmcnt(4)
    v_mfma_f32_16x16x32_bf16 v[204:207], v[164:167], v[88:91], v[204:207]
    v_mfma_f32_16x16x32_bf16 v[224:227], v[164:167], v[92:95], v[224:227]
    ds_read_b128 v[184:187], v3 offset:29696
    s_waitcnt lgkmcnt(4)
    v_mfma_f32_16x16x32_bf16 v[208:211], v[168:171], v[88:91], v[208:211]
    v_mfma_f32_16x16x32_bf16 v[228:231], v[168:171], v[92:95], v[228:231]
    ds_read_b128 v[188:191], v3 offset:30720
    s_waitcnt vmcnt(28)
    s_waitcnt lgkmcnt(4)
    v_mfma_f32_16x16x32_bf16 v[192:195], v[172:175], v[96:99], v[192:195]
    v_mfma_f32_16x16x32_bf16 v[212:215], v[172:175], v[100:103], v[212:215]
    s_barrier
    ds_read_b128 v[152:155], v3 offset:36864
    s_waitcnt lgkmcnt(4)
    v_mfma_f32_16x16x32_bf16 v[196:199], v[176:179], v[96:99], v[196:199]
    v_mfma_f32_16x16x32_bf16 v[216:219], v[176:179], v[100:103], v[216:219]
    ds_read_b128 v[156:159], v3 offset:37888
    s_waitcnt lgkmcnt(4)
    v_mfma_f32_16x16x32_bf16 v[200:203], v[180:183], v[96:99], v[200:203]
    v_mfma_f32_16x16x32_bf16 v[220:223], v[180:183], v[100:103], v[220:223]
    ds_read_b128 v[160:163], v3 offset:38912
    s_waitcnt lgkmcnt(4)
    v_mfma_f32_16x16x32_bf16 v[204:207], v[184:187], v[96:99], v[204:207]
    v_mfma_f32_16x16x32_bf16 v[224:227], v[184:187], v[100:103], v[224:227]
    ds_read_b128 v[164:167], v3 offset:39936
    s_waitcnt lgkmcnt(4)
    v_mfma_f32_16x16x32_bf16 v[208:211], v[188:191], v[96:99], v[208:211]
    v_mfma_f32_16x16x32_bf16 v[228:231], v[188:191], v[100:103], v[228:231]
    ds_read_b128 v[168:171], v3 offset:40960
    s_waitcnt vmcnt(26)
    s_waitcnt lgkmcnt(4)
    v_mfma_f32_16x16x32_bf16 v[192:195], v[152:155], v[104:107], v[192:195]
    v_mfma_f32_16x16x32_bf16 v[212:215], v[152:155], v[108:111], v[212:215]
    ds_read_b128 v[172:175], v3 offset:47104
    s_waitcnt lgkmcnt(4)
    v_mfma_f32_16x16x32_bf16 v[196:199], v[156:159], v[104:107], v[196:199]
    v_mfma_f32_16x16x32_bf16 v[216:219], v[156:159], v[108:111], v[216:219]
    ds_read_b128 v[176:179], v3 offset:48128
    s_waitcnt lgkmcnt(4)
    v_mfma_f32_16x16x32_bf16 v[200:203], v[160:163], v[104:107], v[200:203]
    v_mfma_f32_16x16x32_bf16 v[220:223], v[160:163], v[108:111], v[220:223]
    ds_read_b128 v[180:183], v3 offset:49152
    s_waitcnt lgkmcnt(4)
    v_mfma_f32_16x16x32_bf16 v[204:207], v[164:167], v[104:107], v[204:207]
    v_mfma_f32_16x16x32_bf16 v[224:227], v[164:167], v[108:111], v[224:227]
    ds_read_b128 v[184:187], v3 offset:50176
    s_waitcnt lgkmcnt(4)
    v_mfma_f32_16x16x32_bf16 v[208:211], v[168:171], v[104:107], v[208:211]
    v_mfma_f32_16x16x32_bf16 v[228:231], v[168:171], v[108:111], v[228:231]
    ds_read_b128 v[188:191], v3 offset:51200
    s_waitcnt vmcnt(24)
    s_waitcnt lgkmcnt(4)
    v_mfma_f32_16x16x32_bf16 v[192:195], v[172:175], v[112:115], v[192:195]
    v_mfma_f32_16x16x32_bf16 v[212:215], v[172:175], v[116:119], v[212:215]
    s_barrier
    ds_read_b128 v[152:155], v3 offset:57344
    s_waitcnt lgkmcnt(4)
    v_mfma_f32_16x16x32_bf16 v[196:199], v[176:179], v[112:115], v[196:199]
    v_mfma_f32_16x16x32_bf16 v[216:219], v[176:179], v[116:119], v[216:219]
    ds_read_b128 v[156:159], v3 offset:58368
    s_waitcnt lgkmcnt(4)
    v_mfma_f32_16x16x32_bf16 v[200:203], v[180:183], v[112:115], v[200:203]
    v_mfma_f32_16x16x32_bf16 v[220:223], v[180:183], v[116:119], v[220:223]
    ds_read_b128 v[160:163], v3 offset:59392
    s_waitcnt lgkmcnt(4)
    v_mfma_f32_16x16x32_bf16 v[204:207], v[184:187], v[112:115], v[204:207]
    v_mfma_f32_16x16x32_bf16 v[224:227], v[184:187], v[116:119], v[224:227]
    ds_read_b128 v[164:167], v3 offset:60416
    s_waitcnt lgkmcnt(4)
    v_mfma_f32_16x16x32_bf16 v[208:211], v[188:191], v[112:115], v[208:211]
    v_mfma_f32_16x16x32_bf16 v[228:231], v[188:191], v[116:119], v[228:231]
    ds_read_b128 v[168:171], v3 offset:61440
    s_waitcnt vmcnt(22)
    s_waitcnt lgkmcnt(4)
    v_mfma_f32_16x16x32_bf16 v[192:195], v[152:155], v[120:123], v[192:195]
    v_mfma_f32_16x16x32_bf16 v[212:215], v[152:155], v[124:127], v[212:215]
    ds_read_b128 v[172:175], v2 offset:0
    s_waitcnt lgkmcnt(4)
    v_mfma_f32_16x16x32_bf16 v[196:199], v[156:159], v[120:123], v[196:199]
    v_mfma_f32_16x16x32_bf16 v[216:219], v[156:159], v[124:127], v[216:219]
    ds_read_b128 v[176:179], v2 offset:1024
    s_waitcnt lgkmcnt(4)
    v_mfma_f32_16x16x32_bf16 v[200:203], v[160:163], v[120:123], v[200:203]
    v_mfma_f32_16x16x32_bf16 v[220:223], v[160:163], v[124:127], v[220:223]
    ds_read_b128 v[180:183], v2 offset:2048
    s_waitcnt lgkmcnt(4)
    v_mfma_f32_16x16x32_bf16 v[204:207], v[164:167], v[120:123], v[204:207]
    v_mfma_f32_16x16x32_bf16 v[224:227], v[164:167], v[124:127], v[224:227]
    ds_read_b128 v[184:187], v2 offset:3072
    s_waitcnt lgkmcnt(4)
    v_mfma_f32_16x16x32_bf16 v[208:211], v[168:171], v[120:123], v[208:211]
    v_mfma_f32_16x16x32_bf16 v[228:231], v[168:171], v[124:127], v[228:231]
    ds_read_b128 v[188:191], v2 offset:4096
    s_waitcnt vmcnt(20)
    s_waitcnt lgkmcnt(4)
    v_mfma_f32_16x16x32_bf16 v[192:195], v[172:175], v[128:131], v[192:195]
    v_mfma_f32_16x16x32_bf16 v[212:215], v[172:175], v[132:135], v[212:215]
    s_barrier
    ds_read_b128 v[152:155], v2 offset:10240
    s_waitcnt lgkmcnt(4)
    v_mfma_f32_16x16x32_bf16 v[196:199], v[176:179], v[128:131], v[196:199]
    v_mfma_f32_16x16x32_bf16 v[216:219], v[176:179], v[132:135], v[216:219]
    ds_read_b128 v[156:159], v2 offset:11264
    s_waitcnt lgkmcnt(4)
    v_mfma_f32_16x16x32_bf16 v[200:203], v[180:183], v[128:131], v[200:203]
    v_mfma_f32_16x16x32_bf16 v[220:223], v[180:183], v[132:135], v[220:223]
    ds_read_b128 v[160:163], v2 offset:12288
    s_waitcnt lgkmcnt(4)
    v_mfma_f32_16x16x32_bf16 v[204:207], v[184:187], v[128:131], v[204:207]
    v_mfma_f32_16x16x32_bf16 v[224:227], v[184:187], v[132:135], v[224:227]
    ds_read_b128 v[164:167], v2 offset:13312
    s_waitcnt lgkmcnt(4)
    v_mfma_f32_16x16x32_bf16 v[208:211], v[188:191], v[128:131], v[208:211]
    v_mfma_f32_16x16x32_bf16 v[228:231], v[188:191], v[132:135], v[228:231]
    ds_read_b128 v[168:171], v2 offset:14336
    s_waitcnt vmcnt(18)
    s_waitcnt lgkmcnt(4)
    v_mfma_f32_16x16x32_bf16 v[192:195], v[152:155], v[136:139], v[192:195]
    v_mfma_f32_16x16x32_bf16 v[212:215], v[152:155], v[140:143], v[212:215]
    ds_read_b128 v[172:175], v2 offset:20480
    s_waitcnt lgkmcnt(4)
    v_mfma_f32_16x16x32_bf16 v[196:199], v[156:159], v[136:139], v[196:199]
    v_mfma_f32_16x16x32_bf16 v[216:219], v[156:159], v[140:143], v[216:219]
    ds_read_b128 v[176:179], v2 offset:21504
    s_waitcnt lgkmcnt(4)
    v_mfma_f32_16x16x32_bf16 v[200:203], v[160:163], v[136:139], v[200:203]
    v_mfma_f32_16x16x32_bf16 v[220:223], v[160:163], v[140:143], v[220:223]
    ds_read_b128 v[180:183], v2 offset:22528
    s_waitcnt lgkmcnt(4)
    v_mfma_f32_16x16x32_bf16 v[204:207], v[164:167], v[136:139], v[204:207]
    v_mfma_f32_16x16x32_bf16 v[224:227], v[164:167], v[140:143], v[224:227]
    ds_read_b128 v[184:187], v2 offset:23552
    s_waitcnt lgkmcnt(4)
    v_mfma_f32_16x16x32_bf16 v[208:211], v[168:171], v[136:139], v[208:211]
    v_mfma_f32_16x16x32_bf16 v[228:231], v[168:171], v[140:143], v[228:231]
    ds_read_b128 v[188:191], v2 offset:24576
    s_waitcnt vmcnt(16)
    s_waitcnt lgkmcnt(4)
    v_mfma_f32_16x16x32_bf16 v[192:195], v[172:175], v[144:147], v[192:195]
    v_mfma_f32_16x16x32_bf16 v[212:215], v[172:175], v[148:151], v[212:215]
    s_barrier
    ds_read_b128 v[152:155], v2 offset:30720
    s_waitcnt lgkmcnt(4)
    v_mfma_f32_16x16x32_bf16 v[196:199], v[176:179], v[144:147], v[196:199]
    v_mfma_f32_16x16x32_bf16 v[216:219], v[176:179], v[148:151], v[216:219]
    ds_read_b128 v[156:159], v2 offset:31744
    s_waitcnt lgkmcnt(4)
    v_mfma_f32_16x16x32_bf16 v[200:203], v[180:183], v[144:147], v[200:203]
    v_mfma_f32_16x16x32_bf16 v[220:223], v[180:183], v[148:151], v[220:223]
    ds_read_b128 v[160:163], v2 offset:32768
    s_waitcnt lgkmcnt(4)
    v_mfma_f32_16x16x32_bf16 v[204:207], v[184:187], v[144:147], v[204:207]
    v_mfma_f32_16x16x32_bf16 v[224:227], v[184:187], v[148:151], v[224:227]
    ds_read_b128 v[164:167], v2 offset:33792
    s_waitcnt lgkmcnt(4)
    v_mfma_f32_16x16x32_bf16 v[208:211], v[188:191], v[144:147], v[208:211]
    v_mfma_f32_16x16x32_bf16 v[228:231], v[188:191], v[148:151], v[228:231]
    ds_read_b128 v[168:171], v2 offset:34816
    s_waitcnt vmcnt(14)
    s_waitcnt lgkmcnt(4)
    v_mfma_f32_16x16x32_bf16 v[192:195], v[152:155], v[24:27], v[192:195]
    v_mfma_f32_16x16x32_bf16 v[212:215], v[152:155], v[28:31], v[212:215]
    ds_read_b128 v[172:175], v2 offset:40960
    s_waitcnt lgkmcnt(4)
    v_mfma_f32_16x16x32_bf16 v[196:199], v[156:159], v[24:27], v[196:199]
    v_mfma_f32_16x16x32_bf16 v[216:219], v[156:159], v[28:31], v[216:219]
    ds_read_b128 v[176:179], v2 offset:41984
    s_waitcnt lgkmcnt(4)
    v_mfma_f32_16x16x32_bf16 v[200:203], v[160:163], v[24:27], v[200:203]
    v_mfma_f32_16x16x32_bf16 v[220:223], v[160:163], v[28:31], v[220:223]
    ds_read_b128 v[180:183], v2 offset:43008
    s_waitcnt lgkmcnt(4)
    v_mfma_f32_16x16x32_bf16 v[204:207], v[164:167], v[24:27], v[204:207]
    v_mfma_f32_16x16x32_bf16 v[224:227], v[164:167], v[28:31], v[224:227]
    ds_read_b128 v[184:187], v2 offset:44032
    s_waitcnt lgkmcnt(4)
    v_mfma_f32_16x16x32_bf16 v[208:211], v[168:171], v[24:27], v[208:211]
    v_mfma_f32_16x16x32_bf16 v[228:231], v[168:171], v[28:31], v[228:231]
    ds_read_b128 v[188:191], v2 offset:45056
    s_waitcnt vmcnt(12)
    s_waitcnt lgkmcnt(4)
    v_mfma_f32_16x16x32_bf16 v[192:195], v[172:175], v[32:35], v[192:195]
    v_mfma_f32_16x16x32_bf16 v[212:215], v[172:175], v[36:39], v[212:215]
    s_barrier
    ds_read_b128 v[152:155], v2 offset:51200
    s_waitcnt lgkmcnt(4)
    v_mfma_f32_16x16x32_bf16 v[196:199], v[176:179], v[32:35], v[196:199]
    v_mfma_f32_16x16x32_bf16 v[216:219], v[176:179], v[36:39], v[216:219]
    ds_read_b128 v[156:159], v2 offset:52224
    s_waitcnt lgkmcnt(4)
    v_mfma_f32_16x16x32_bf16 v[200:203], v[180:183], v[32:35], v[200:203]
    v_mfma_f32_16x16x32_bf16 v[220:223], v[180:183], v[36:39], v[220:223]
    ds_read_b128 v[160:163], v2 offset:53248
    s_waitcnt lgkmcnt(4)
    v_mfma_f32_16x16x32_bf16 v[204:207], v[184:187], v[32:35], v[204:207]
    v_mfma_f32_16x16x32_bf16 v[224:227], v[184:187], v[36:39], v[224:227]
    ds_read_b128 v[164:167], v2 offset:54272
    s_waitcnt lgkmcnt(4)
    v_mfma_f32_16x16x32_bf16 v[208:211], v[188:191], v[32:35], v[208:211]
    v_mfma_f32_16x16x32_bf16 v[228:231], v[188:191], v[36:39], v[228:231]
    ds_read_b128 v[168:171], v2 offset:55296
    s_waitcnt vmcnt(10)
    s_waitcnt lgkmcnt(4)
    v_mfma_f32_16x16x32_bf16 v[192:195], v[152:155], v[40:43], v[192:195]
    v_mfma_f32_16x16x32_bf16 v[212:215], v[152:155], v[44:47], v[212:215]
    ds_read_b128 v[172:175], v2 offset:61440
    s_waitcnt lgkmcnt(4)
    v_mfma_f32_16x16x32_bf16 v[196:199], v[156:159], v[40:43], v[196:199]
    v_mfma_f32_16x16x32_bf16 v[216:219], v[156:159], v[44:47], v[216:219]
    ds_read_b128 v[176:179], v2 offset:62464
    s_waitcnt lgkmcnt(4)
    v_mfma_f32_16x16x32_bf16 v[200:203], v[160:163], v[40:43], v[200:203]
    v_mfma_f32_16x16x32_bf16 v[220:223], v[160:163], v[44:47], v[220:223]
    ds_read_b128 v[180:183], v2 offset:63488
    s_waitcnt lgkmcnt(4)
    v_mfma_f32_16x16x32_bf16 v[204:207], v[164:167], v[40:43], v[204:207]
    v_mfma_f32_16x16x32_bf16 v[224:227], v[164:167], v[44:47], v[224:227]
    ds_read_b128 v[184:187], v2 offset:64512
    s_waitcnt lgkmcnt(4)
    v_mfma_f32_16x16x32_bf16 v[208:211], v[168:171], v[40:43], v[208:211]
    v_mfma_f32_16x16x32_bf16 v[228:231], v[168:171], v[44:47], v[228:231]
    ds_read_b128 v[188:191], v3 offset:0
    s_waitcnt vmcnt(8)
    s_waitcnt lgkmcnt(4)
    v_mfma_f32_16x16x32_bf16 v[192:195], v[172:175], v[48:51], v[192:195]
    v_mfma_f32_16x16x32_bf16 v[212:215], v[172:175], v[52:55], v[212:215]
    s_barrier
    ds_read_b128 v[152:155], v3 offset:6144
    s_waitcnt lgkmcnt(4)
    v_mfma_f32_16x16x32_bf16 v[196:199], v[176:179], v[48:51], v[196:199]
    v_mfma_f32_16x16x32_bf16 v[216:219], v[176:179], v[52:55], v[216:219]
    ds_read_b128 v[156:159], v3 offset:7168
    s_waitcnt lgkmcnt(4)
    v_mfma_f32_16x16x32_bf16 v[200:203], v[180:183], v[48:51], v[200:203]
    v_mfma_f32_16x16x32_bf16 v[220:223], v[180:183], v[52:55], v[220:223]
    ds_read_b128 v[160:163], v3 offset:8192
    s_waitcnt lgkmcnt(4)
    v_mfma_f32_16x16x32_bf16 v[204:207], v[184:187], v[48:51], v[204:207]
    v_mfma_f32_16x16x32_bf16 v[224:227], v[184:187], v[52:55], v[224:227]
    ds_read_b128 v[164:167], v3 offset:9216
    s_waitcnt lgkmcnt(4)
    v_mfma_f32_16x16x32_bf16 v[208:211], v[188:191], v[48:51], v[208:211]
    v_mfma_f32_16x16x32_bf16 v[228:231], v[188:191], v[52:55], v[228:231]
    ds_read_b128 v[168:171], v3 offset:10240
    s_waitcnt vmcnt(6)
    s_waitcnt lgkmcnt(4)
    v_mfma_f32_16x16x32_bf16 v[192:195], v[152:155], v[56:59], v[192:195]
    v_mfma_f32_16x16x32_bf16 v[212:215], v[152:155], v[60:63], v[212:215]
    ds_read_b128 v[172:175], v3 offset:16384
    s_waitcnt lgkmcnt(4)
    v_mfma_f32_16x16x32_bf16 v[196:199], v[156:159], v[56:59], v[196:199]
    v_mfma_f32_16x16x32_bf16 v[216:219], v[156:159], v[60:63], v[216:219]
    ds_read_b128 v[176:179], v3 offset:17408
    s_waitcnt lgkmcnt(4)
    v_mfma_f32_16x16x32_bf16 v[200:203], v[160:163], v[56:59], v[200:203]
    v_mfma_f32_16x16x32_bf16 v[220:223], v[160:163], v[60:63], v[220:223]
    ds_read_b128 v[180:183], v3 offset:18432
    s_waitcnt lgkmcnt(4)
    v_mfma_f32_16x16x32_bf16 v[204:207], v[164:167], v[56:59], v[204:207]
    v_mfma_f32_16x16x32_bf16 v[224:227], v[164:167], v[60:63], v[224:227]
    ds_read_b128 v[184:187], v3 offset:19456
    s_waitcnt lgkmcnt(4)
    v_mfma_f32_16x16x32_bf16 v[208:211], v[168:171], v[56:59], v[208:211]
    v_mfma_f32_16x16x32_bf16 v[228:231], v[168:171], v[60:63], v[228:231]
    ds_read_b128 v[188:191], v3 offset:20480
    s_waitcnt vmcnt(4)
    s_waitcnt lgkmcnt(4)
    v_mfma_f32_16x16x32_bf16 v[192:195], v[172:175], v[64:67], v[192:195]
    v_mfma_f32_16x16x32_bf16 v[212:215], v[172:175], v[68:71], v[212:215]
    s_barrier
    ds_read_b128 v[152:155], v3 offset:26624
    s_waitcnt lgkmcnt(4)
    v_mfma_f32_16x16x32_bf16 v[196:199], v[176:179], v[64:67], v[196:199]
    v_mfma_f32_16x16x32_bf16 v[216:219], v[176:179], v[68:71], v[216:219]
    ds_read_b128 v[156:159], v3 offset:27648
    s_waitcnt lgkmcnt(4)
    v_mfma_f32_16x16x32_bf16 v[200:203], v[180:183], v[64:67], v[200:203]
    v_mfma_f32_16x16x32_bf16 v[220:223], v[180:183], v[68:71], v[220:223]
    ds_read_b128 v[160:163], v3 offset:28672
    s_waitcnt lgkmcnt(4)
    v_mfma_f32_16x16x32_bf16 v[204:207], v[184:187], v[64:67], v[204:207]
    v_mfma_f32_16x16x32_bf16 v[224:227], v[184:187], v[68:71], v[224:227]
    ds_read_b128 v[164:167], v3 offset:29696
    s_waitcnt lgkmcnt(4)
    v_mfma_f32_16x16x32_bf16 v[208:211], v[188:191], v[64:67], v[208:211]
    v_mfma_f32_16x16x32_bf16 v[228:231], v[188:191], v[68:71], v[228:231]
    ds_read_b128 v[168:171], v3 offset:30720
    s_waitcnt vmcnt(2)
    s_waitcnt lgkmcnt(4)
    v_mfma_f32_16x16x32_bf16 v[192:195], v[152:155], v[72:75], v[192:195]
    v_mfma_f32_16x16x32_bf16 v[212:215], v[152:155], v[76:79], v[212:215]
    ds_read_b128 v[172:175], v3 offset:36864
    s_waitcnt lgkmcnt(4)
    v_mfma_f32_16x16x32_bf16 v[196:199], v[156:159], v[72:75], v[196:199]
    v_mfma_f32_16x16x32_bf16 v[216:219], v[156:159], v[76:79], v[216:219]
    ds_read_b128 v[176:179], v3 offset:37888
    s_waitcnt lgkmcnt(4)
    v_mfma_f32_16x16x32_bf16 v[200:203], v[160:163], v[72:75], v[200:203]
    v_mfma_f32_16x16x32_bf16 v[220:223], v[160:163], v[76:79], v[220:223]
    ds_read_b128 v[180:183], v3 offset:38912
    s_waitcnt lgkmcnt(4)
    v_mfma_f32_16x16x32_bf16 v[204:207], v[164:167], v[72:75], v[204:207]
    v_mfma_f32_16x16x32_bf16 v[224:227], v[164:167], v[76:79], v[224:227]
    ds_read_b128 v[184:187], v3 offset:39936
    s_waitcnt lgkmcnt(4)
    v_mfma_f32_16x16x32_bf16 v[208:211], v[168:171], v[72:75], v[208:211]
    v_mfma_f32_16x16x32_bf16 v[228:231], v[168:171], v[76:79], v[228:231]
    ds_read_b128 v[188:191], v3 offset:40960
    s_waitcnt vmcnt(0)
    s_waitcnt lgkmcnt(4)
    v_mfma_f32_16x16x32_bf16 v[192:195], v[172:175], v[80:83], v[192:195]
    v_mfma_f32_16x16x32_bf16 v[212:215], v[172:175], v[84:87], v[212:215]
    s_waitcnt lgkmcnt(3)
    v_mfma_f32_16x16x32_bf16 v[196:199], v[176:179], v[80:83], v[196:199]
    v_mfma_f32_16x16x32_bf16 v[216:219], v[176:179], v[84:87], v[216:219]
    s_waitcnt lgkmcnt(2)
    v_mfma_f32_16x16x32_bf16 v[200:203], v[180:183], v[80:83], v[200:203]
    v_mfma_f32_16x16x32_bf16 v[220:223], v[180:183], v[84:87], v[220:223]
    s_waitcnt lgkmcnt(1)
    v_mfma_f32_16x16x32_bf16 v[204:207], v[184:187], v[80:83], v[204:207]
    v_mfma_f32_16x16x32_bf16 v[224:227], v[184:187], v[84:87], v[224:227]
    s_waitcnt lgkmcnt(0)
    v_mfma_f32_16x16x32_bf16 v[208:211], v[188:191], v[80:83], v[208:211]
    v_mfma_f32_16x16x32_bf16 v[228:231], v[188:191], v[84:87], v[228:231]
    s_mul_i32 s20, s3, 5120
    s_xor_b32 s21, s3, 2
    s_mul_i32 s21, s21, 5120
    s_add_u32 s20, s20, 139264
    s_add_u32 s21, s21, 139264
    v_add_u32 v2, s20, v1
    v_add_u32 v3, s21, v1
    s_cmp_eq_u32 s5, 0
    s_cbranch_scc1 main_kernel_kh0_9
    ds_write_b128 v2, v[192:195] offset:0
    ds_write_b128 v2, v[196:199] offset:1024
    ds_write_b128 v2, v[200:203] offset:2048
    ds_write_b128 v2, v[204:207] offset:3072
    ds_write_b128 v2, v[208:211] offset:4096
    s_nop 0
    v_pk_mov_b32 v[192:193], v[212:213], v[212:213] op_sel:[0,1]
    v_pk_mov_b32 v[194:195], v[214:215], v[214:215] op_sel:[0,1]
    v_pk_mov_b32 v[196:197], v[216:217], v[216:217] op_sel:[0,1]
    v_pk_mov_b32 v[198:199], v[218:219], v[218:219] op_sel:[0,1]
    v_pk_mov_b32 v[200:201], v[220:221], v[220:221] op_sel:[0,1]
    v_pk_mov_b32 v[202:203], v[222:223], v[222:223] op_sel:[0,1]
    v_pk_mov_b32 v[204:205], v[224:225], v[224:225] op_sel:[0,1]
    v_pk_mov_b32 v[206:207], v[226:227], v[226:227] op_sel:[0,1]
    v_pk_mov_b32 v[208:209], v[228:229], v[228:229] op_sel:[0,1]
    v_pk_mov_b32 v[210:211], v[230:231], v[230:231] op_sel:[0,1]
    s_branch main_kernel_red_9
main_kernel_kh0_9:
    ds_write_b128 v2, v[212:215] offset:0
    ds_write_b128 v2, v[216:219] offset:1024
    ds_write_b128 v2, v[220:223] offset:2048
    ds_write_b128 v2, v[224:227] offset:3072
    ds_write_b128 v2, v[228:231] offset:4096
main_kernel_red_9:
    s_waitcnt lgkmcnt(0)
    s_barrier
    ds_read_b128 v[212:215], v3 offset:0
    ds_read_b128 v[216:219], v3 offset:1024
    ds_read_b128 v[220:223], v3 offset:2048
    ds_read_b128 v[224:227], v3 offset:3072
    ds_read_b128 v[228:231], v3 offset:4096
    v_lshlrev_b32 v24, 16, v232
    v_and_b32 v25, 0xffff0000, v232
    v_lshlrev_b32 v26, 16, v233
    v_and_b32 v27, 0xffff0000, v233
    v_pk_add_f32 v[192:193], v[24:25], v[192:193]
    v_pk_add_f32 v[194:195], v[26:27], v[194:195]
    v_lshlrev_b32 v28, 16, v234
    v_and_b32 v29, 0xffff0000, v234
    v_lshlrev_b32 v30, 16, v235
    v_and_b32 v31, 0xffff0000, v235
    v_pk_add_f32 v[196:197], v[28:29], v[196:197]
    v_pk_add_f32 v[198:199], v[30:31], v[198:199]
    v_lshlrev_b32 v32, 16, v236
    v_and_b32 v33, 0xffff0000, v236
    v_lshlrev_b32 v34, 16, v237
    v_and_b32 v35, 0xffff0000, v237
    v_pk_add_f32 v[200:201], v[32:33], v[200:201]
    v_pk_add_f32 v[202:203], v[34:35], v[202:203]
    v_lshlrev_b32 v36, 16, v238
    v_and_b32 v37, 0xffff0000, v238
    v_lshlrev_b32 v38, 16, v239
    v_and_b32 v39, 0xffff0000, v239
    v_pk_add_f32 v[204:205], v[36:37], v[204:205]
    v_pk_add_f32 v[206:207], v[38:39], v[206:207]
    v_lshlrev_b32 v40, 16, v240
    v_and_b32 v41, 0xffff0000, v240
    v_lshlrev_b32 v42, 16, v241
    v_and_b32 v43, 0xffff0000, v241
    v_pk_add_f32 v[208:209], v[40:41], v[208:209]
    v_pk_add_f32 v[210:211], v[42:43], v[210:211]
    s_mul_i32 s25, s4, 20480
    s_mul_i32 s26, s51, 160
    s_add_u32 s25, s25, s26
    v_mul_u32_u24 v8, 1280, v6
    v_lshl_add_u32 v9, v11, 5, v8
    v_lshl_add_u32 v9, v10, 4, v9
    v_lshl_add_u32 v8, v7, 3, v8
    s_waitcnt lgkmcnt(4)
    v_pk_add_f32 v[192:193], v[192:193], v[212:213]
    v_pk_add_f32 v[194:195], v[194:195], v[214:215]
    v_cvt_pk_bf16_f32 v152, v192, v193
    v_cvt_pk_bf16_f32 v153, v194, v195
    s_waitcnt lgkmcnt(3)
    v_pk_add_f32 v[196:197], v[196:197], v[216:217]
    v_pk_add_f32 v[198:199], v[198:199], v[218:219]
    v_cvt_pk_bf16_f32 v154, v196, v197
    v_cvt_pk_bf16_f32 v155, v198, v199
    s_nop 1
    v_permlane16_swap_b32 v152, v154
    v_permlane16_swap_b32 v153, v155
    buffer_store_dwordx4 v[152:155], v9, s[16:19], s25 offen offset:0
    s_waitcnt lgkmcnt(2)
    v_pk_add_f32 v[200:201], v[200:201], v[220:221]
    v_pk_add_f32 v[202:203], v[202:203], v[222:223]
    v_cvt_pk_bf16_f32 v156, v200, v201
    v_cvt_pk_bf16_f32 v157, v202, v203
    s_waitcnt lgkmcnt(1)
    v_pk_add_f32 v[204:205], v[204:205], v[224:225]
    v_pk_add_f32 v[206:207], v[206:207], v[226:227]
    v_cvt_pk_bf16_f32 v158, v204, v205
    v_cvt_pk_bf16_f32 v159, v206, v207
    s_nop 1
    v_permlane16_swap_b32 v156, v158
    v_permlane16_swap_b32 v157, v159
    buffer_store_dwordx4 v[156:159], v9, s[16:19], s25 offen offset:64
    s_waitcnt lgkmcnt(0)
    v_pk_add_f32 v[208:209], v[208:209], v[228:229]
    v_pk_add_f32 v[210:211], v[210:211], v[230:231]
    v_cvt_pk_bf16_f32 v160, v208, v209
    v_cvt_pk_bf16_f32 v161, v210, v211
    buffer_store_dwordx2 v[160:161], v8, s[16:19], s25 offen offset:128
    s_endpgm
main_kernel_j2:
main_kernel_end:
    s_endpgm
.section .rodata,"a"
.p2align 6
.amdhsa_kernel main_kernel
  .amdhsa_next_free_vgpr 256
  .amdhsa_next_free_sgpr 102
  .amdhsa_accum_offset 256
  .amdhsa_group_segment_fixed_size 0
  .amdhsa_kernarg_size 96
  .amdhsa_user_sgpr_count 2
  .amdhsa_user_sgpr_kernarg_segment_ptr 1
  .amdhsa_system_sgpr_workgroup_id_x 1
.end_amdhsa_kernel
.text
.fill 2560, 4, 0xbf810000
```
